```python
import torch

def _softmax(x, axis=-1):
    return torch.softmax(x, dim=axis)
def _gelu(x):
    return torch.nn.functional.gelu(x, approximate="tanh")
def _silu(x):
    return torch.nn.functional.silu(x)
def _sigmoid(x):
    return torch.sigmoid(x)
def _layernorm(x, axis=-1, eps=1e-5):
    m = x.mean(dim=axis, keepdim=True)
    v = x.var(dim=axis, keepdim=True, unbiased=False)
    return (x - m) / torch.sqrt(v + eps)
def _scatter_add(tgt, idx, src, axis=0):
    return tgt.clone().index_add_(axis, idx, src)
def _segment_sum(src, seg, n):
    out = torch.zeros((n,) + src.shape[1:], dtype=src.dtype)
    return out.index_add_(0, seg, src)
def _pad(x, pw):
    flat = tuple(v for pair in reversed(pw) for v in pair)
    return torch.nn.functional.pad(x, flat)

kernel_name = 'recurrent_scan__linear_kernel_hedgehog__dense_activation_relu__prompt'

def setup_inputs():

    _w = (lambda a: (lambda t: t.to(torch.bfloat16) if t.is_floating_point() else t)(torch.as_tensor(a)))
    def _A_setup():
        B, S, D, H = 1, 2048, 576, 32
        Dh = D // H
        return {
            "x": _w((lambda *s: torch.randn(*s, dtype=torch.bfloat16) * 0.05)(B, S, D)),
            "wqkv": _w((lambda *s: torch.randn(*s, dtype=torch.bfloat16) * 0.2)(D, 3 * D)),
            "w_phi": _w((lambda *s: torch.randn(*s, dtype=torch.bfloat16) * 0.2)(H, Dh, Dh) * (Dh ** -0.5)),
            "wo": _w((lambda *s: torch.randn(*s, dtype=torch.bfloat16) * 0.05)(D, D)),
        }
    _A_in = _A_setup()

    def _B_setup():
        B, S, D, Dff = 1, 2048, 576, 4608
        return {
            "x": _w((lambda *s: torch.randn(*s, dtype=torch.bfloat16) * 0.05)(B, S, D)),
            "w1": _w((lambda *s: torch.randn(*s, dtype=torch.bfloat16) * 0.05)(D, Dff)),
            "w2": _w((lambda *s: torch.randn(*s, dtype=torch.bfloat16) * 0.05)(Dff, D)),
        }
    _B_in = _B_setup()

    return {
        "A_x": _A_in["x"],
        "A_wqkv": _A_in["wqkv"],
        "A_w_phi": _A_in["w_phi"],
        "A_wo": _A_in["wo"],
        "B_x": _B_in["x"],
        "B_w1": _B_in["w1"],
        "B_w2": _B_in["w2"],
    }

def reference(A_x, A_wqkv, A_w_phi, A_wo, B_x, B_w1, B_w2):
    def _A_ref(x, wqkv, w_phi, wo):
        B, S, D = x.shape
        H = 32; Dh = D // H
        qkv = (lambda x, *d: x.permute(*d))((x @ wqkv).reshape(B, S, 3, H, Dh), 2, 0, 3, 1, 4)
        q, k, v = qkv[0], qkv[1], qkv[2]
        pq = torch.einsum("bhsd,hdf->bhsf", q, w_phi)
        pk = torch.einsum("bhsd,hdf->bhsf", k, w_phi)
        phi_q = torch.concatenate([_softmax(pq, axis=-1), _softmax(-pq, axis=-1)], axis=-1)
        phi_k = torch.concatenate([_softmax(pk, axis=-1), _softmax(-pk, axis=-1)], axis=-1)
        kv = torch.einsum("bhsf,bhsd->bhfd", phi_k, v)
        z  = torch.einsum("bhsf->bhf", phi_k)
        num = torch.einsum("bhqf,bhfd->bhqd", phi_q, kv)
        den = torch.einsum("bhqf,bhf->bhq", phi_q, z)[..., None] + 1e-6
        o = num / den
        return (lambda x, *d: x.permute(*d))(o, 0, 2, 1, 3).reshape(B, S, D) @ wo

    def _B_ref(x, w1, w2):
        h = torch.einsum("bsd,df->bsf", x, w1)
        zero = torch.zeros_like(h)
        h = torch.maximum(h, zero)
        return torch.einsum("bsf,fd->bsd", h, w2)

    x = A_x
    xn = _layernorm(x, axis=-1)
    s = _A_ref(xn, A_wqkv, A_w_phi, A_wo)
    g = _silu(_B_ref(xn, B_w1, B_w2))
    return x + s * g
```

```asm
; @launch grid=(256,1,1) block=(256,1,1) lds=163840
.amdgcn_target "amdgcn-amd-amdhsa--gfx950"
.text
.globl recurrent_scan__linear_kernel_hedgehog__dense_activation_relu__prompt_kernel
.p2align 12
.p2align 8
.type recurrent_scan__linear_kernel_hedgehog__dense_activation_relu__prompt_kernel,@function
recurrent_scan__linear_kernel_hedgehog__dense_activation_relu__prompt_kernel:
  s_cmp_ge_u32 s2, 256
  s_cbranch_scc1 L_end
  s_load_dwordx16 s[40:55], s[0:1], 0
  s_load_dwordx4 s[56:59], s[0:1], 64
  s_getpc_b64 s[84:85]
L_here:
  s_lshr_b32 s3, s2, 3
  v_lshrrev_b32 v58, 6, v0
  v_lshl_add_u32 v58, s3, 2, v58
  v_and_b32 v59, 3, v0
  v_lshl_add_u32 v58, v58, 2, v59
  v_lshlrev_b32 v58, 7, v58
  v_min_u32 v58, L_end-L_here, v58
  v_mov_b32 v59, s85
  v_add_co_u32 v58, vcc, s84, v58
  s_nop 1
  v_addc_co_u32 v59, vcc, 0, v59, vcc
  global_load_dword a255, v[58:59], off
  v_lshrrev_b32 v1, 6, v0
  v_and_b32 v0, 63, v0
  v_readfirstlane_b32 s64, v1
  s_and_b32 s61, s2, 3
  s_bfe_u32 s3, s2, 0x10002
  s_lshr_b32 s60, s2, 5
  s_lshl1_add_u32 s60, s60, s3
  s_add_u32 s60, s60, 14
  s_and_b32 s60, s60, 15
  s_bfe_u32 s62, s2, 0x20003
  s_lshl2_add_u32 s63, s61, s62
  s_mul_i32 s65, s64, 9216
  v_lshrrev_b32 v44, 4, v0
  v_and_b32 v45, 15, v0
  v_bfe_u32 v46, v0, 2, 2
  v_and_b32 v47, 3, v0
  v_lshlrev_b32 v1, 4, v0
  v_lshrrev_b32 v14, 3, v0
  v_mul_u32_u24 v14, 1152, v14
  v_and_b32 v52, 7, v0
  v_xor_b32 v15, v52, v44
  v_lshl_add_u32 v14, v15, 4, v14
  v_xor_b32 v15, 64, v14
  s_mul_i32 s88, s60, 147456
  s_mul_i32 s84, s64, 36864
  s_add_u32 s88, s88, s84
  s_mov_b32 s6, 2359296
  s_mov_b32 s7, 0x20000
  s_lshr_b32 s84, s2, 3
  s_lshl2_add_u32 s84, s84, s64
  s_mul_i32 s84, s84, 9
  s_mul_i32 s85, s61, 2304
  v_lshrrev_b32 v48, 1, v0
  v_add_u32 v48, s84, v48
  v_mul_u32_u24 v49, 1152, v48
  v_lshrrev_b32 v48, 1, v48
  v_mul_u32_u24 v48, 6912, v48
  v_and_b32 v50, 1, v0
  v_mul_u32_u24 v50, 640, v50
  v_add3_u32 v5, v48, v49, v50
  v_add_u32 v5, s85, v5
  v_cmp_gt_u32 vcc, 18, v0
  s_nop 1
  v_cndmask_b32 v5, 1073741824, v5, vcc
  v_accvgpr_write_b32 a197, v5
  s_lshl2_add_u32 s84, s2, s64
  s_mul_i32 s84, s84, 243
  s_lshr_b32 s84, s84, 4
  v_min_u32 v7, 15, v0
  v_add_lshl_u32 v7, v7, s84, 7
  s_and_b32 s84, s61, 1
  s_lshr_b32 s85, s61, 1
  s_lshl_b32 s86, s85, 6
  v_xor_b32 v14, s86, v14
  v_xor_b32 v15, 64, v14
  s_lshl_b32 s86, s84, 9
  s_mul_i32 s87, s85, 9216
  s_add_u32 s88, s88, s86
  s_add_u32 s88, s88, s87
  s_lshl3_add_u32 s83, s86, s65
  s_lshl2_add_u32 s83, s87, s83
  s_mul_i32 s84, s84, 1152
  s_sub_u32 s66, 640, s84
  v_lshrrev_b32 v48, 3, v45
  v_mul_u32_u24 v48, 36864, v48
  v_and_b32 v49, 7, v45
  v_lshl_add_u32 v48, v49, 7, v48
  v_lshrrev_b32 v49, 1, v45
  v_xor_b32 v49, v49, v44
  v_lshl_add_u32 v48, v49, 4, v48
  v_add_u32 v29, s65, v48
  v_xor_b32 v30, 64, v29
  s_mov_b32 s72, 0x100001
  s_mov_b32 s73, 0x10000100
  s_mov_b32 s74, 0x200002
  s_mov_b32 s75, 0x20000200
  s_mov_b32 s76, 0x400004
  s_mov_b32 s77, 0x40000400
  s_mov_b32 s78, 0x800008
  s_mov_b32 s79, 0x80000800
  v_mov_b32 v248, 0x3f803f80
  v_mov_b32 v249, 0x3f803f80
  v_mov_b32 v250, 0x3f803f80
  v_mov_b32 v251, 0x3f803f80
  v_mov_b32 v252, 1.0
  v_mov_b32 v253, 0x3f80
  v_cndmask_b32 v49, 0, v253, s[72:73]
  v_cndmask_b32 v49, v49, v252, s[74:75]
  v_cndmask_b32 v50, 0, v253, s[76:77]
  v_cndmask_b32 v50, v50, v252, s[78:79]
  v_accvgpr_write_b32 a248, 0
  v_accvgpr_write_b32 a249, 0
  v_accvgpr_write_b32 a250, v49
  v_accvgpr_write_b32 a251, v50
  v_accvgpr_write_b32 a252, 0
  v_accvgpr_write_b32 a253, 0
  s_and_b32 s84, s64, 1
  s_lshr_b32 s85, s64, 1
  s_lshl_b32 s86, s84, 4
  s_lshl2_add_u32 s86, s85, s86
  s_lshl_b32 s85, s85, 5
  s_lshl2_add_u32 s85, s84, s85
  s_and_b32 s84, s63, 1
  s_mov_b32 s22, 5308416
  s_mov_b32 s23, 0x20000
  s_mov_b32 s10, 1990656
  s_mov_b32 s11, 0x20000
  s_waitcnt lgkmcnt(0)
  s_mov_b32 s4, s40
  s_mov_b32 s5, s41
  s_mov_b32 s20, s50
  s_mov_b32 s21, s51
  s_mov_b32 s8, s42
  s_mov_b32 s9, s43
  s_load_dword s67, s[58:59], 0
  s_add_u32 m0, s83, 0
  s_nop 0
  buffer_load_dwordx4 v14, s[4:7], s88 offen lds
  s_mov_b32 s12, s44
  s_mov_b32 s13, s45
  s_mov_b32 s14, 20736
  s_mov_b32 s15, 0x20000
  s_mov_b32 s36, s58
  s_mov_b32 s37, s59
  s_mov_b32 s38, 268435456
  s_mov_b32 s39, 0x20000
  s_mov_b32 s32, s56
  s_mov_b32 s33, s57
  s_mov_b32 s34, 256
  s_mov_b32 s35, 0x20000
  s_mov_b32 s28, s54
  s_mov_b32 s29, s55
  s_add_u32 s48, s88, 18432
  s_add_u32 s49, s83, 73728
  s_add_u32 m0, s83, 896
  s_nop 0
  buffer_load_dwordx4 v14, s[4:7], s88 offen offset:128 lds
  s_mov_b32 s30, 2359296
  s_mov_b32 s31, 0x20000
  s_mov_b32 s18, 663552
  s_mov_b32 s19, 0x20000
  s_cmp_le_u32 s60, 8
  s_cselect_b32 s16, s52, s46
  s_cselect_b32 s17, s53, s47
  s_cmov_b32 s18, 5308416
  s_cmp_ge_u32 s60, 14
  s_cmov_b32 s16, s42
  s_cmov_b32 s17, s43
  s_cmov_b32 s18, 1990656
  s_lshl_b32 s87, s84, 6
  s_xor_b32 s84, s84, 1
  s_add_u32 m0, s83, 1792
  s_nop 0
  buffer_load_dwordx4 v14, s[4:7], s88 offen offset:256 lds
  s_lshl_b32 s84, s84, 9
  s_movk_i32 s96, 9216
  s_mul_i32 s68, s63, 576
  v_bfe_u32 v48, v0, 3, 2
  v_lshrrev_b32 v49, 5, v0
  v_lshl_add_u32 v48, v49, 3, v48
  v_add_u32 v48, s86, v48
  v_lshlrev_b32 v49, 1, v44
  v_xor_b32 v49, v49, v52
  v_lshl_add_u32 v49, v49, 4, s87
  v_mad_u32_u24 v12, v48, s96, v49
  v_lshl_add_u32 v48, v44, 3, v46
  v_add_u32 v48, s85, v48
  s_add_u32 m0, s83, 2688
  v_and_b32 v49, 1, v44
  buffer_load_dwordx4 v14, s[4:7], s88 offen offset:384 lds
  v_lshlrev_b32 v49, 1, v49
  v_xor_b32 v49, v49, v47
  v_lshl_add_u32 v49, v49, 4, s84
  v_mad_u32_u24 v13, v48, s96, v49
  s_lshl_b32 s84, s64, 7
  s_lshl_b32 s94, s64, 9
  s_mul_i32 s95, s63, 1296
  v_add_u32 v48, s84, v0
  v_mul_u32_u24 v49, 6554, v48
  v_lshrrev_b32 v49, 16, v49
  v_mad_i32_i24 v50, v49, -10, v48
  v_mul_u32_u24 v53, 36, v49
  v_lshl_add_u32 v53, v50, 2, v53
  v_cmp_gt_u32 vcc, 9, v50
  s_add_u32 m0, s83, 3584
  s_nop 0
  v_cndmask_b32 v53, 1073741824, v53, vcc
  buffer_load_dwordx4 v14, s[4:7], s88 offen offset:512 lds
  v_cmp_gt_u32 vcc, 36, v49
  s_nop 1
  v_cndmask_b32 v53, 1073741824, v53, vcc
  v_add_u32 v48, 64, v48
  v_mul_u32_u24 v49, 6554, v48
  v_lshrrev_b32 v49, 16, v49
  v_mad_i32_i24 v50, v49, -10, v48
  v_mul_u32_u24 v54, 36, v49
  v_lshl_add_u32 v54, v50, 2, v54
  v_cmp_gt_u32 vcc, 9, v50
  s_nop 1
  v_cndmask_b32 v54, 1073741824, v54, vcc
  v_cmp_gt_u32 vcc, 36, v49
  s_nop 1
  v_cndmask_b32 v54, 1073741824, v54, vcc
  s_and_b32 s84, s64, 1
  s_lshl_b32 s85, s84, 3
  buffer_load_dword a200, v5, s[20:23], 0 offen
  s_lshl_b32 s84, s84, 4
  s_lshr_b32 s86, s64, 1
  s_lshl2_add_u32 s84, s86, s84
  s_lshl_b32 s86, s60, 5
  s_add_u32 s84, s84, s86
  s_mul_i32 s84, s84, 3456
  s_mul_i32 s86, s63, 72
  s_add_u32 s89, s84, s86
  s_lshl_b32 s90, s64, 11
  s_movk_i32 s86, 3456
  v_add_u32 v48, s85, v44
  v_xor_b32 v48, v48, v45
  v_and_b32 v49, 3, v48
  v_min_u32 v50, 2, v49
  s_add_u32 s88, s88, s66
  s_lshl3_add_u32 s83, s66, s83
  s_add_u32 m0, s83, 0
  s_nop 0
  buffer_load_dwordx4 v14, s[4:7], s88 offen lds
  v_mul_u32_u24 v50, 1152, v50
  v_add_u32 v50, 64, v50
  v_cmp_eq_u32 vcc, 2, v49
  v_subrev_u32 v51, 32, v50
  s_nop 0
  v_cndmask_b32 v50, v50, v51, vcc
  v_cmp_eq_u32 vcc, 3, v49
  v_add_u32 v51, 4, v50
  s_nop 0
  v_cndmask_b32 v50, v50, v51, vcc
  v_lshrrev_b32 v48, 2, v48
  v_mul_u32_u24 v51, 1152, v48
  v_lshl_add_u32 v51, v49, 4, v51
  v_lshrrev_b32 v52, 1, v49
  v_lshl_add_u32 v52, v52, 2, v51
  v_cmp_eq_u32 vcc, 2, v48
  s_add_u32 m0, s83, 896
  s_nop 0
  v_cndmask_b32 v51, v51, v52, vcc
  buffer_load_dwordx4 v14, s[4:7], s88 offen offset:128 lds
  v_cmp_eq_u32 vcc, 3, v48
  s_nop 1
  v_cndmask_b32 v51, v51, v50, vcc
  v_mad_u32_u24 v55, v44, s86, v51
  v_xor_b32 v48, 1, v48
  v_mul_u32_u24 v51, 1152, v48
  v_lshl_add_u32 v51, v49, 4, v51
  v_lshrrev_b32 v52, 1, v49
  v_lshl_add_u32 v52, v52, 2, v51
  v_cmp_eq_u32 vcc, 2, v48
  s_nop 1
  v_cndmask_b32 v51, v51, v52, vcc
  v_cmp_eq_u32 vcc, 3, v48
  s_nop 1
  v_cndmask_b32 v51, v51, v50, vcc
  v_mad_u32_u24 v56, v44, s86, v51
  s_add_u32 m0, s83, 1792
  v_add_u32 v56, 26624, v56
  buffer_load_dwordx4 v14, s[4:7], s88 offen offset:256 lds
  v_and_b32 v49, 1, v44
  v_lshl_add_u32 v48, v49, 2, v46
  v_lshrrev_b32 v50, 1, v48
  v_lshlrev_b32 v50, 5, v50
  v_lshl_add_u32 v50, v48, 7, v50
  v_lshl_add_u32 v50, v47, 3, v50
  v_lshrrev_b32 v51, 1, v44
  v_mul_u32_u24 v51, 9216, v51
  v_add_u32 v2, v50, v51
  v_xor_b32 v3, 32, v2
  v_xor_b32 v8, 64, v2
  v_xor_b32 v9, 96, v2
  v_lshrrev_b32 v48, 2, v0
  s_add_u32 m0, s83, 2688
  v_lshlrev_b32 v50, 6, v48
  buffer_load_dwordx4 v14, s[4:7], s88 offen offset:384 lds
  v_lshl_add_u32 v50, v49, 5, v50
  v_lshl_add_u32 v10, v47, 3, v50
  v_xor_b32 v11, 32, v10
  v_add_u32 v4, 55296, v1
  v_mul_u32_u24 v48, 288, v48
  s_add_u32 s84, s65, 110592
  v_add_u32 v48, s84, v48
  v_lshl_add_u32 v17, v47, 4, v48
  v_lshl_add_u32 v18, v47, 3, v48
  v_add_u32 v18, 256, v18
  s_mov_b32 s84, 0
  s_mov_b32 s85, 0
  s_mov_b32 s86, 0
  s_cmp_eq_u32 s60, 9
  s_cmov_b32 s84, 2
  s_xor_b32 s40, s61, 2
  s_lshr_b32 s40, s40, 1
  s_mul_i32 s40, s40, 9216
  s_lshl2_add_u32 s41, s40, s65
  s_mul_i32 s50, s60, 147456
  s_lshl2_add_u32 s50, s65, s50
  s_add_u32 s40, s40, s50
  s_add_u32 m0, s41, 0
  s_nop 0
  buffer_load_dwordx4 v15, s[4:7], s40 offen lds
  s_cmp_eq_u32 s60, 10
  s_cmov_b32 s84, 20
  s_cmov_b32 s85, 68
  s_cmov_b32 s86, 16
  s_cmp_ge_u32 s60, 14
  s_cselect_b64 s[96:97], -1, 0
  s_movk_i32 s87, 1152
  s_mov_b32 s3, -18
  v_mov_b32 v57, 1073741824
  v_mul_u32_u24 v49, 3641, v0
  v_lshrrev_b32 v49, 16, v49
  v_mad_i32_i24 v50, v49, s3, v0
  v_lshrrev_b32 v52, 4, v49
  s_add_u32 m0, s41, 896
  v_mad_u32_u24 v51, v52, s84, v49
  buffer_load_dwordx4 v15, s[4:7], s40 offen offset:128 lds
  v_bfe_u32 v52, v49, 2, 2
  v_mad_u32_u24 v51, v52, s85, v51
  v_bfe_u32 v52, v49, 1, 1
  v_mad_u32_u24 v51, v52, s86, v51
  v_lshlrev_b32 v50, 4, v50
  v_mad_u32_u24 v51, v51, s87, v50
  v_cndmask_b32 v51, v51, v55, s[96:97]
  v_accvgpr_write_b32 a188, v51
  v_add_u32 v48, 64, v0
  v_mul_u32_u24 v49, 3641, v48
  v_lshrrev_b32 v49, 16, v49
  v_mad_i32_i24 v50, v49, s3, v48
  v_lshrrev_b32 v52, 4, v49
  s_add_u32 m0, s41, 1792
  v_mad_u32_u24 v51, v52, s84, v49
  buffer_load_dwordx4 v15, s[4:7], s40 offen offset:256 lds
  v_bfe_u32 v52, v49, 2, 2
  v_mad_u32_u24 v51, v52, s85, v51
  v_bfe_u32 v52, v49, 1, 1
  v_mad_u32_u24 v51, v52, s86, v51
  v_subrev_u32 v50, 64, v50
  v_lshlrev_b32 v50, 4, v50
  v_mad_u32_u24 v51, v51, s87, v50
  v_cndmask_b32 v51, v51, v56, s[96:97]
  v_accvgpr_write_b32 a189, v51
  v_add_u32 v48, 128, v0
  v_mul_u32_u24 v49, 3641, v48
  v_lshrrev_b32 v49, 16, v49
  v_mad_i32_i24 v50, v49, s3, v48
  s_add_u32 m0, s41, 2688
  v_lshrrev_b32 v52, 4, v49
  buffer_load_dwordx4 v15, s[4:7], s40 offen offset:384 lds
  v_mad_u32_u24 v51, v52, s84, v49
  v_bfe_u32 v52, v49, 2, 2
  v_mad_u32_u24 v51, v52, s85, v51
  v_bfe_u32 v52, v49, 1, 1
  v_mad_u32_u24 v51, v52, s86, v51
  v_subrev_u32 v50, 128, v50
  v_lshlrev_b32 v50, 4, v50
  v_mad_u32_u24 v51, v51, s87, v50
  v_cndmask_b32 v51, v51, v57, s[96:97]
  v_accvgpr_write_b32 a190, v51
  v_add_u32 v48, 192, v0
  v_mul_u32_u24 v49, 3641, v48
  v_lshrrev_b32 v49, 16, v49
  s_add_u32 m0, s41, 3584
  v_mad_i32_i24 v50, v49, s3, v48
  buffer_load_dwordx4 v15, s[4:7], s40 offen offset:512 lds
  v_lshrrev_b32 v52, 4, v49
  v_mad_u32_u24 v51, v52, s84, v49
  v_bfe_u32 v52, v49, 2, 2
  v_mad_u32_u24 v51, v52, s85, v51
  v_bfe_u32 v52, v49, 1, 1
  v_mad_u32_u24 v51, v52, s86, v51
  v_subrev_u32 v50, 192, v50
  v_lshlrev_b32 v50, 4, v50
  v_mad_u32_u24 v51, v51, s87, v50
  v_cndmask_b32 v51, v51, v57, s[96:97]
  v_accvgpr_write_b32 a191, v51
  v_add_u32 v48, 256, v0
  v_mul_u32_u24 v49, 3641, v48
  s_add_u32 m0, s41, 4480
  v_lshrrev_b32 v49, 16, v49
  buffer_load_dwordx4 v15, s[4:7], s40 offen offset:640 lds
  v_mad_i32_i24 v50, v49, s3, v48
  v_lshrrev_b32 v52, 4, v49
  v_mad_u32_u24 v51, v52, s84, v49
  v_bfe_u32 v52, v49, 2, 2
  v_mad_u32_u24 v51, v52, s85, v51
  v_bfe_u32 v52, v49, 1, 1
  v_mad_u32_u24 v51, v52, s86, v51
  v_lshlrev_b32 v50, 4, v50
  v_mad_u32_u24 v51, v51, s87, v50
  v_cndmask_b32 v51, v51, v57, s[96:97]
  v_accvgpr_write_b32 a192, v51
  v_add_u32 v48, 320, v0
  v_mul_u32_u24 v49, 3641, v48
  s_add_u32 m0, s41, 5376
  v_lshrrev_b32 v49, 16, v49
  buffer_load_dwordx4 v15, s[4:7], s40 offen offset:768 lds
  v_mad_i32_i24 v50, v49, s3, v48
  v_lshrrev_b32 v52, 4, v49
  v_mad_u32_u24 v51, v52, s84, v49
  v_bfe_u32 v52, v49, 2, 2
  v_mad_u32_u24 v51, v52, s85, v51
  v_bfe_u32 v52, v49, 1, 1
  v_mad_u32_u24 v51, v52, s86, v51
  v_subrev_u32 v50, 64, v50
  v_lshlrev_b32 v50, 4, v50
  v_mad_u32_u24 v51, v51, s87, v50
  v_cndmask_b32 v51, v51, v57, s[96:97]
  v_accvgpr_write_b32 a193, v51
  v_add_u32 v48, 384, v0
  s_add_u32 m0, s41, 6272
  v_mul_u32_u24 v49, 3641, v48
  buffer_load_dwordx4 v15, s[4:7], s40 offen offset:896 lds
  v_lshrrev_b32 v49, 16, v49
  v_mad_i32_i24 v50, v49, s3, v48
  v_lshrrev_b32 v52, 4, v49
  v_mad_u32_u24 v51, v52, s84, v49
  v_bfe_u32 v52, v49, 2, 2
  v_mad_u32_u24 v51, v52, s85, v51
  v_bfe_u32 v52, v49, 1, 1
  v_mad_u32_u24 v51, v52, s86, v51
  v_subrev_u32 v50, 128, v50
  v_lshlrev_b32 v50, 4, v50
  v_mad_u32_u24 v51, v51, s87, v50
  v_cndmask_b32 v51, v51, v57, s[96:97]
  v_accvgpr_write_b32 a194, v51
  s_add_u32 m0, s41, 7168
  v_add_u32 v48, 448, v0
  buffer_load_dwordx4 v15, s[4:7], s40 offen offset:1024 lds
  v_mul_u32_u24 v49, 3641, v48
  v_lshrrev_b32 v49, 16, v49
  v_mad_i32_i24 v50, v49, s3, v48
  v_lshrrev_b32 v52, 4, v49
  v_mad_u32_u24 v51, v52, s84, v49
  v_bfe_u32 v52, v49, 2, 2
  v_mad_u32_u24 v51, v52, s85, v51
  v_bfe_u32 v52, v49, 1, 1
  v_mad_u32_u24 v51, v52, s86, v51
  v_subrev_u32 v50, 192, v50
  v_lshlrev_b32 v50, 4, v50
  v_mad_u32_u24 v51, v51, s87, v50
  v_cndmask_b32 v51, v51, v57, s[96:97]
  s_add_u32 m0, s49, 0
  v_accvgpr_write_b32 a195, v51
  buffer_load_dwordx4 v14, s[4:7], s48 offen lds
  v_add_u32 v48, 512, v0
  v_mul_u32_u24 v49, 3641, v48
  v_lshrrev_b32 v49, 16, v49
  v_mad_i32_i24 v50, v49, s3, v48
  v_lshrrev_b32 v52, 4, v49
  v_mad_u32_u24 v51, v52, s84, v49
  v_bfe_u32 v52, v49, 2, 2
  v_mad_u32_u24 v51, v52, s85, v51
  v_bfe_u32 v52, v49, 1, 1
  v_mad_u32_u24 v51, v52, s86, v51
  v_lshlrev_b32 v50, 4, v50
  v_mad_u32_u24 v51, v51, s87, v50
  v_cndmask_b32 v51, v51, v57, s[96:97]
  s_add_u32 m0, s49, 896
  v_accvgpr_write_b32 a196, v51
  buffer_load_dwordx4 v14, s[4:7], s48 offen offset:128 lds
  v_xor_b32 v48, v44, v45
  v_lshlrev_b32 v48, 4, v48
  v_lshl_add_u32 v48, v45, 8, v48
  v_add_u32 v48, 148480, v48
  v_xor_b32 v25, 64, v48
  v_xor_b32 v26, 192, v48
  s_cmp_eq_u32 s64, 3
  s_cselect_b32 s84, 128, 0
  s_cselect_b64 s[96:97], -1, 0
  v_xor_b32 v24, s84, v48
  s_lshl_b32 s3, s64, 4
  s_add_u32 s99, s3, 156672
  s_add_u32 s3, s3, 158760
  s_add_u32 m0, s49, 1792
  v_mov_b32 v52, 158720
  buffer_load_dwordx4 v14, s[4:7], s48 offen offset:256 lds
  v_mul_u32_u24 v49, 24, v46
  v_add_u32 v49, 158840, v49
  v_add_u32 v50, 8, v49
  v_cmp_gt_u32 vcc, 32, v0
  s_nop 1
  v_cndmask_b32 v49, v49, v50, vcc
  v_lshl_add_u32 v48, v44, 3, v46
  v_mad_u32_u24 v48, v48, 40, s99
  s_mov_b32 s84, 0x11111111
  s_mov_b32 s85, 0x22222211
  s_mov_b32 s86, 0x44444444
  s_mov_b32 s87, 0x88888844
  s_cmp_eq_u32 s64, 3
  s_cmov_b32 s84, 0x44441111
  s_cmov_b32 s85, 0x44441111
  s_cmov_b64 s[86:87], 0
  s_add_u32 m0, s49, 2688
  s_nop 0
  buffer_load_dwordx4 v14, s[4:7], s48 offen offset:384 lds
  v_cndmask_b32 v50, v48, v49, s[96:97]
  v_cndmask_b32 v19, v52, v50, s[84:85]
  v_cndmask_b32 v21, v52, v48, s[86:87]
  v_add_u32 v48, 160, v48
  s_mov_b32 s84, 0x11111111
  s_mov_b32 s85, 0x22222222
  s_mov_b32 s86, 0x44444444
  s_mov_b32 s87, 0x88888888
  s_cmp_eq_u32 s64, 3
  s_cmov_b32 s84, 0x88882222
  s_cmov_b32 s85, 0x88882222
  s_cmov_b64 s[86:87], 0
  v_cndmask_b32 v50, v48, v49, s[96:97]
  s_add_u32 m0, s49, 3584
  v_cndmask_b32 v20, v52, v50, s[84:85]
  buffer_load_dwordx4 v14, s[4:7], s48 offen offset:512 lds
  v_cndmask_b32 v22, v52, v48, s[86:87]
  s_mov_b32 s84, 0x88882222
  s_mov_b32 s85, 0x0
  s_mov_b32 s86, 0x0
  s_mov_b32 s87, 0x220011
  s_andn2_b64 s[84:85], s[84:85], s[96:97]
  s_andn2_b64 s[86:87], s[86:87], s[96:97]
  v_mad_u32_u24 v48, v46, 40, s99
  v_add_u32 v48, 1280, v48
  v_mad_u32_u24 v49, v46, 40, s3
  v_cndmask_b32 v23, v52, v48, s[84:85]
  v_cndmask_b32 v23, v23, v49, s[86:87]
  s_mov_b32 s84, 0x80000
  s_mov_b32 s85, 0x2001
  buffer_load_dword a205, v7, s[8:11], 0 offen
  s_mov_b32 s86, 0x20000000
  s_mov_b32 s87, 0x80040
  v_cndmask_b32 v49, 0, v253, s[84:85]
  v_cndmask_b32 v49, v49, v252, s[86:87]
  v_lshlrev_b32 v50, 2, v0
  v_add_u32 v50, 158720, v50
  v_cmp_eq_u32 vcc, 0, v0
  s_nop 1
  v_cndmask_b32 v27, v57, 0, vcc
  ds_write_b32 v50, v49
  v_accvgpr_write_b32 a122, 0
  v_accvgpr_write_b32 a123, 0
  v_accvgpr_write_b32 a126, 0
  v_accvgpr_write_b32 a127, 0
  s_lshl2_add_u32 s84, s60, s64
  s_add_u32 s48, s48, s66
  s_lshl3_add_u32 s49, s66, s49
  s_add_u32 m0, s49, 0
  s_nop 0
  buffer_load_dwordx4 v14, s[4:7], s48 offen lds
  s_mul_i32 s85, s84, 57
  s_lshr_b32 s85, s85, 9
  s_mul_i32 s86, s85, 9
  s_sub_u32 s86, s84, s86
  s_xor_b32 s85, s85, s62
  s_and_b32 s87, s85, 1
  s_add_u32 s86, s86, s87
  s_cmp_eq_u32 s86, 9
  s_cmov_b32 s86, 0
  s_lshl2_add_u32 s85, s61, s85
  s_mul_i32 s85, s85, 9
  s_add_u32 s85, s85, s86
  s_mul_i32 s85, s85, 36864
  s_mul_i32 s86, s63, 331776
  s_add_u32 m0, s49, 896
  s_nop 0
  buffer_load_dwordx4 v14, s[4:7], s48 offen offset:128 lds
  s_add_u32 s87, s84, 224
  s_movk_i32 s99, 1024
  s_mul_i32 s96, s84, 9
  s_cmp_ge_u32 s84, 28
  s_cmov_b32 s96, s87
  s_cmovk_i32 s99, 8192
  s_cmp_ge_u32 s84, 36
  s_cmovk_i32 s99, 1024
  s_lshl_b32 s84, s96, 10
  s_add_u32 s86, s86, s84
  s_add_u32 s86, s86, 4194304
  s_mov_b32 s70, 1073741824
  s_mov_b32 s71, 1073741824
  s_cmp_le_u32 s60, 8
  s_cmov_b32 s70, s85
  s_cmov_b32 s71, s86
  s_add_u32 m0, s49, 1792
  s_nop 0
  buffer_load_dwordx4 v14, s[4:7], s48 offen offset:256 lds
  s_lshl2_add_u32 s87, s61, s64
  s_mul_i32 s85, s87, 41472
  s_mul_i32 s98, s62, 165888
  s_add_u32 s98, s98, 10485760
  s_mul_i32 s87, s87, 9216
  s_add_u32 s86, s98, s87
  s_cmp_eq_u32 s60, 9
  s_cmov_b32 s70, s85
  s_cmov_b32 s71, s86
  s_mul_i32 s85, s61, 331776
  s_add_u32 s85, s85, 18432
  s_mul_i32 s86, s61, 9216
  s_add_u32 s86, s86, s98
  s_add_u32 s86, s86, 147456
  s_add_u32 m0, s49, 2688
  s_nop 0
  buffer_load_dwordx4 v14, s[4:7], s48 offen offset:384 lds
  s_lshr_b32 s84, s61, 1
  s_or_b32 s84, s84, s64
  s_xor_b32 s87, s60, 10
  s_or_b32 s84, s84, s87
  s_cmp_eq_u32 s84, 0
  s_cmov_b32 s70, s85
  s_cmov_b32 s71, s86
  s_mul_i32 s84, s62, 288
  s_add_u32 s70, s70, s84
  s_add_u32 s84, s89, 221184
  s_cmp_ge_u32 s60, 14
  s_cmov_b32 s70, s84
  s_lshl_b32 s84, s60, 1
  s_cmp_eq_u32 s64, 2
  s_cmov_b32 s84, s60
  s_add_u32 s40, s40, 18432
  s_add_u32 s41, s41, 73728
  s_add_u32 m0, s41, 0
  s_nop 0
  buffer_load_dwordx4 v15, s[4:7], s40 offen lds
  s_mul_i32 s85, s64, 36
  s_min_u32 s85, s85, 90
  s_add_u32 s84, s84, s85
  s_lshl_b32 s84, s84, 10
  s_mul_i32 s85, s63, 132096
  s_add_u32 s85, s85, 1048576
  s_add_u32 s80, s84, s85
  s_add_u32 s69, s85, s65
  s_add_u32 s81, s80, 1024
  s_cmp_eq_u32 s64, 2
  s_cmov_b32 s81, 1073741824
  s_lshl2_add_u32 s84, s60, s64
  s_lshl2_add_u32 s84, s84, s61
  s_lshl_b32 s84, s84, 2
  s_add_u32 m0, s41, 896
  s_nop 0
  buffer_load_dwordx4 v15, s[4:7], s40 offen offset:128 lds
  s_xor_b32 s85, s62, 0
  s_add_u32 s85, s85, s84
  s_mul_i32 s85, s85, 18432
  s_add_u32 s82, s85, 12582912
  s_xor_b32 s85, s62, 1
  s_add_u32 s85, s85, s84
  s_mul_i32 s85, s85, 18432
  s_add_u32 s91, s85, 12582912
  s_xor_b32 s85, s62, 2
  s_add_u32 s85, s85, s84
  s_mul_i32 s85, s85, 18432
  s_add_u32 s92, s85, 12582912
  s_xor_b32 s85, s62, 3
  s_add_u32 s85, s85, s84
  s_add_u32 m0, s41, 1792
  s_nop 0
  buffer_load_dwordx4 v15, s[4:7], s40 offen offset:256 lds
  s_mul_i32 s85, s85, 18432
  s_add_u32 s93, s85, 12582912
  s_waitcnt lgkmcnt(0)
  s_or_b32 s84, s2, s64
  s_cmp_lg_u32 s84, 0
  s_cbranch_scc1 L_noepoch
  s_mul_i32 s67, s67, 0x41c64e6d
  s_add_u32 s67, s67, 0x3039
  s_cmp_eq_u32 s67, 0
  s_cmov_b32 s67, 0x3039
  v_mov_b32 v31, s67
  buffer_store_dword v31, v27, s[36:39], 0 offen sc1
  buffer_store_dword v31, v27, s[32:35], 0 offen sc1
L_noepoch:
  s_waitcnt vmcnt(13)
  ds_read_b128 v[104:107], v29
  ds_read_b128 v[108:111], v30
  ds_read_b128 v[112:115], v29 offset:1024
  ds_read_b128 v[116:119], v30 offset:1024
  ds_read_b128 v[120:123], v29 offset:2048
  ds_read_b128 v[124:127], v30 offset:2048
  ds_read_b128 v[128:131], v29 offset:3072
  ds_read_b128 v[132:135], v30 offset:3072
  ds_read_b128 v[136:139], v29 offset:4096
  ds_read_b128 v[140:143], v30 offset:4096
  ds_read_b128 v[144:147], v29 offset:5120
  s_add_u32 m0, s41, 2688
  ds_read_b128 v[148:151], v30 offset:5120
  buffer_load_dwordx4 v15, s[4:7], s40 offen offset:384 lds
  ds_read_b128 v[152:155], v29 offset:6144
  ds_read_b128 v[156:159], v30 offset:6144
  ds_read_b128 v[160:163], v29 offset:7168
  ds_read_b128 v[164:167], v30 offset:7168
  ds_read_b128 v[168:171], v29 offset:8192
  ds_read_b128 v[172:175], v30 offset:8192
  s_waitcnt lgkmcnt(14)
  v_mfma_f32_16x16x32_bf16 v[32:35], v[248:251], v[104:107], 0
  v_mfma_f32_16x16x32_bf16 v[32:35], v[248:251], v[108:111], v[32:35]
  s_add_u32 m0, s41, 3584
  v_mfma_f32_16x16x32_bf16 v[32:35], v[248:251], v[112:115], v[32:35]
  buffer_load_dwordx4 v15, s[4:7], s40 offen offset:512 lds
  v_mfma_f32_16x16x32_bf16 v[32:35], v[248:251], v[116:119], v[32:35]
  s_waitcnt lgkmcnt(13)
  v_mfma_f32_16x16x32_bf16 v[32:35], v[248:251], v[120:123], v[32:35]
  s_waitcnt lgkmcnt(12)
  v_mfma_f32_16x16x32_bf16 v[32:35], v[248:251], v[124:127], v[32:35]
  s_waitcnt lgkmcnt(11)
  v_mfma_f32_16x16x32_bf16 v[32:35], v[248:251], v[128:131], v[32:35]
  s_add_u32 m0, s41, 4480
  s_waitcnt lgkmcnt(10)
  v_mfma_f32_16x16x32_bf16 v[32:35], v[248:251], v[132:135], v[32:35]
  buffer_load_dwordx4 v15, s[4:7], s40 offen offset:640 lds
  s_waitcnt lgkmcnt(9)
  v_mfma_f32_16x16x32_bf16 v[32:35], v[248:251], v[136:139], v[32:35]
  s_waitcnt lgkmcnt(8)
  v_mfma_f32_16x16x32_bf16 v[32:35], v[248:251], v[140:143], v[32:35]
  s_waitcnt lgkmcnt(7)
  v_mfma_f32_16x16x32_bf16 v[32:35], v[248:251], v[144:147], v[32:35]
  s_waitcnt lgkmcnt(6)
  v_mfma_f32_16x16x32_bf16 v[32:35], v[248:251], v[148:151], v[32:35]
  s_add_u32 m0, s41, 5376
  s_waitcnt lgkmcnt(5)
  v_mfma_f32_16x16x32_bf16 v[32:35], v[248:251], v[152:155], v[32:35]
  buffer_load_dwordx4 v15, s[4:7], s40 offen offset:768 lds
  s_waitcnt lgkmcnt(4)
  v_mfma_f32_16x16x32_bf16 v[32:35], v[248:251], v[156:159], v[32:35]
  s_waitcnt lgkmcnt(3)
  v_mfma_f32_16x16x32_bf16 v[32:35], v[248:251], v[160:163], v[32:35]
  s_waitcnt lgkmcnt(2)
  v_mfma_f32_16x16x32_bf16 v[32:35], v[248:251], v[164:167], v[32:35]
  s_waitcnt lgkmcnt(1)
  v_mfma_f32_16x16x32_bf16 v[32:35], v[248:251], v[168:171], v[32:35]
  s_add_u32 m0, s41, 6272
  s_waitcnt lgkmcnt(0)
  v_mfma_f32_16x16x32_bf16 v[32:35], v[248:251], v[172:175], v[32:35]
  buffer_load_dwordx4 v15, s[4:7], s40 offen offset:896 lds
  s_nop 6
  v_mul_f32 v32, 0xbae38e39, v32
  v_mul_f32 v33, 0xbae38e39, v33
  v_mul_f32 v34, 0xbae38e39, v34
  v_mul_f32 v35, 0xbae38e39, v35
  s_nop 1
  v_mfma_f32_16x16x32_bf16 v[64:67], a[250:253], v[104:107], v[32:35]
  v_mfma_f32_16x16x32_bf16 v[68:71], a[248:251], v[104:107], v[32:35]
  v_mfma_f32_16x16x32_bf16 v[72:75], a[250:253], v[108:111], v[32:35]
  s_add_u32 m0, s41, 7168
  v_mfma_f32_16x16x32_bf16 v[76:79], a[248:251], v[108:111], v[32:35]
  buffer_load_dwordx4 v15, s[4:7], s40 offen offset:1024 lds
  v_mfma_f32_16x16x32_bf16 v[80:83], a[250:253], v[112:115], v[32:35]
  v_mfma_f32_16x16x32_bf16 v[84:87], a[248:251], v[112:115], v[32:35]
  s_nop 0
  v_cvt_pk_bf16_f32 v64, v64, v65
  v_cvt_pk_bf16_f32 v65, v66, v67
  v_cvt_pk_bf16_f32 v66, v68, v69
  v_cvt_pk_bf16_f32 v67, v70, v71
  v_accvgpr_write_b32 a0, v64
  v_accvgpr_write_b32 a1, v65
  v_accvgpr_write_b32 a2, v66
  s_add_u32 m0, s65, 0
  v_accvgpr_write_b32 a3, v67
  buffer_load_dwordx4 v12, s[20:23], s68 offen lds
  v_mfma_f32_16x16x32_bf16 v[64:67], a[250:253], v[116:119], v[32:35]
  v_mfma_f32_16x16x32_bf16 v[68:71], a[248:251], v[116:119], v[32:35]
  v_cvt_pk_bf16_f32 v72, v72, v73
  v_cvt_pk_bf16_f32 v73, v74, v75
  v_cvt_pk_bf16_f32 v74, v76, v77
  v_cvt_pk_bf16_f32 v75, v78, v79
  v_accvgpr_write_b32 a4, v72
  v_accvgpr_write_b32 a5, v73
  v_accvgpr_write_b32 a6, v74
  v_accvgpr_write_b32 a7, v75
  s_add_u32 s68, s68, 293888
  buffer_load_dwordx4 v12, s[20:23], s68 offen offset:1024 lds
  v_mfma_f32_16x16x32_bf16 v[72:75], a[250:253], v[120:123], v[32:35]
  v_mfma_f32_16x16x32_bf16 v[76:79], a[248:251], v[120:123], v[32:35]
  v_cvt_pk_bf16_f32 v80, v80, v81
  v_cvt_pk_bf16_f32 v81, v82, v83
  v_cvt_pk_bf16_f32 v82, v84, v85
  v_cvt_pk_bf16_f32 v83, v86, v87
  v_accvgpr_write_b32 a8, v80
  v_accvgpr_write_b32 a9, v81
  v_accvgpr_write_b32 a10, v82
  v_accvgpr_write_b32 a11, v83
  s_add_u32 s68, s68, 293888
  buffer_load_dwordx4 v12, s[20:23], s68 offen offset:2048 lds
  v_mfma_f32_16x16x32_bf16 v[80:83], a[250:253], v[124:127], v[32:35]
  v_mfma_f32_16x16x32_bf16 v[84:87], a[248:251], v[124:127], v[32:35]
  v_cvt_pk_bf16_f32 v64, v64, v65
  v_cvt_pk_bf16_f32 v65, v66, v67
  v_cvt_pk_bf16_f32 v66, v68, v69
  v_cvt_pk_bf16_f32 v67, v70, v71
  v_accvgpr_write_b32 a12, v64
  v_accvgpr_write_b32 a13, v65
  v_accvgpr_write_b32 a14, v66
  v_accvgpr_write_b32 a15, v67
  s_add_u32 s68, s68, 293888
  buffer_load_dwordx4 v12, s[20:23], s68 offen offset:3072 lds
  v_mfma_f32_16x16x32_bf16 v[64:67], a[250:253], v[128:131], v[32:35]
  v_mfma_f32_16x16x32_bf16 v[68:71], a[248:251], v[128:131], v[32:35]
  v_cvt_pk_bf16_f32 v72, v72, v73
  v_cvt_pk_bf16_f32 v73, v74, v75
  v_cvt_pk_bf16_f32 v74, v76, v77
  v_cvt_pk_bf16_f32 v75, v78, v79
  v_accvgpr_write_b32 a16, v72
  v_accvgpr_write_b32 a17, v73
  v_accvgpr_write_b32 a18, v74
  v_accvgpr_write_b32 a19, v75
  s_add_u32 s68, s68, 297984
  s_add_u32 m0, s65, 4096
  s_nop 0
  buffer_load_dwordx4 v12, s[20:23], s68 offen lds
  v_mfma_f32_16x16x32_bf16 v[72:75], a[250:253], v[132:135], v[32:35]
  v_mfma_f32_16x16x32_bf16 v[76:79], a[248:251], v[132:135], v[32:35]
  v_cvt_pk_bf16_f32 v80, v80, v81
  v_cvt_pk_bf16_f32 v81, v82, v83
  v_cvt_pk_bf16_f32 v82, v84, v85
  v_cvt_pk_bf16_f32 v83, v86, v87
  v_accvgpr_write_b32 a20, v80
  v_accvgpr_write_b32 a21, v81
  v_accvgpr_write_b32 a22, v82
  v_accvgpr_write_b32 a23, v83
  s_add_u32 s68, s68, 293888
  buffer_load_dwordx4 v12, s[20:23], s68 offen offset:1024 lds
  v_mfma_f32_16x16x32_bf16 v[80:83], a[250:253], v[136:139], v[32:35]
  v_mfma_f32_16x16x32_bf16 v[84:87], a[248:251], v[136:139], v[32:35]
  v_cvt_pk_bf16_f32 v64, v64, v65
  v_cvt_pk_bf16_f32 v65, v66, v67
  v_cvt_pk_bf16_f32 v66, v68, v69
  v_cvt_pk_bf16_f32 v67, v70, v71
  v_accvgpr_write_b32 a24, v64
  v_accvgpr_write_b32 a25, v65
  v_accvgpr_write_b32 a26, v66
  v_accvgpr_write_b32 a27, v67
  s_add_u32 s68, s68, 293888
  buffer_load_dwordx4 v12, s[20:23], s68 offen offset:2048 lds
  v_mfma_f32_16x16x32_bf16 v[64:67], a[250:253], v[140:143], v[32:35]
  v_mfma_f32_16x16x32_bf16 v[68:71], a[248:251], v[140:143], v[32:35]
  v_cvt_pk_bf16_f32 v72, v72, v73
  v_cvt_pk_bf16_f32 v73, v74, v75
  v_cvt_pk_bf16_f32 v74, v76, v77
  v_cvt_pk_bf16_f32 v75, v78, v79
  v_accvgpr_write_b32 a28, v72
  v_accvgpr_write_b32 a29, v73
  v_accvgpr_write_b32 a30, v74
  v_accvgpr_write_b32 a31, v75
  s_add_u32 s68, s68, 293888
  buffer_load_dwordx4 v12, s[20:23], s68 offen offset:3072 lds
  v_mfma_f32_16x16x32_bf16 v[72:75], a[250:253], v[144:147], v[32:35]
  v_mfma_f32_16x16x32_bf16 v[76:79], a[248:251], v[144:147], v[32:35]
  v_cvt_pk_bf16_f32 v80, v80, v81
  v_cvt_pk_bf16_f32 v81, v82, v83
  v_cvt_pk_bf16_f32 v82, v84, v85
  v_cvt_pk_bf16_f32 v83, v86, v87
  v_accvgpr_write_b32 a32, v80
  v_accvgpr_write_b32 a33, v81
  v_accvgpr_write_b32 a34, v82
  v_accvgpr_write_b32 a35, v83
  s_add_u32 s68, s68, 297984
  s_add_u32 m0, s65, 8192
  s_nop 0
  buffer_load_dwordx4 v12, s[20:23], s68 offen lds
  v_mfma_f32_16x16x32_bf16 v[80:83], a[250:253], v[148:151], v[32:35]
  v_mfma_f32_16x16x32_bf16 v[84:87], a[248:251], v[148:151], v[32:35]
  v_cvt_pk_bf16_f32 v64, v64, v65
  v_cvt_pk_bf16_f32 v65, v66, v67
  v_cvt_pk_bf16_f32 v66, v68, v69
  v_cvt_pk_bf16_f32 v67, v70, v71
  v_accvgpr_write_b32 a36, v64
  v_accvgpr_write_b32 a37, v65
  v_accvgpr_write_b32 a38, v66
  s_add_u32 m0, s90, 148480
  v_accvgpr_write_b32 a39, v67
  buffer_load_dwordx4 v55, s[8:11], s89 offen lds
  v_mfma_f32_16x16x32_bf16 v[64:67], a[250:253], v[152:155], v[32:35]
  v_mfma_f32_16x16x32_bf16 v[68:71], a[248:251], v[152:155], v[32:35]
  v_cvt_pk_bf16_f32 v72, v72, v73
  v_cvt_pk_bf16_f32 v73, v74, v75
  v_cvt_pk_bf16_f32 v74, v76, v77
  v_cvt_pk_bf16_f32 v75, v78, v79
  v_accvgpr_write_b32 a40, v72
  v_accvgpr_write_b32 a41, v73
  v_accvgpr_write_b32 a42, v74
  v_accvgpr_write_b32 a43, v75
  v_mfma_f32_16x16x32_bf16 v[72:75], a[250:253], v[156:159], v[32:35]
  v_mfma_f32_16x16x32_bf16 v[76:79], a[248:251], v[156:159], v[32:35]
  v_cvt_pk_bf16_f32 v80, v80, v81
  v_cvt_pk_bf16_f32 v81, v82, v83
  v_cvt_pk_bf16_f32 v82, v84, v85
  v_cvt_pk_bf16_f32 v83, v86, v87
  v_accvgpr_write_b32 a44, v80
  v_accvgpr_write_b32 a45, v81
  v_accvgpr_write_b32 a46, v82
  v_accvgpr_write_b32 a47, v83
  v_mfma_f32_16x16x32_bf16 v[80:83], a[250:253], v[160:163], v[32:35]
  buffer_load_dwordx4 v56, s[8:11], s89 offen offset:1024 lds
  v_mfma_f32_16x16x32_bf16 v[84:87], a[248:251], v[160:163], v[32:35]
  v_cvt_pk_bf16_f32 v64, v64, v65
  v_cvt_pk_bf16_f32 v65, v66, v67
  v_cvt_pk_bf16_f32 v66, v68, v69
  v_cvt_pk_bf16_f32 v67, v70, v71
  v_accvgpr_write_b32 a48, v64
  v_accvgpr_write_b32 a49, v65
  v_accvgpr_write_b32 a50, v66
  v_accvgpr_write_b32 a51, v67
  v_mfma_f32_16x16x32_bf16 v[64:67], a[250:253], v[164:167], v[32:35]
  v_mfma_f32_16x16x32_bf16 v[68:71], a[248:251], v[164:167], v[32:35]
  v_cvt_pk_bf16_f32 v72, v72, v73
  v_cvt_pk_bf16_f32 v73, v74, v75
  v_cvt_pk_bf16_f32 v74, v76, v77
  v_cvt_pk_bf16_f32 v75, v78, v79
  v_accvgpr_write_b32 a52, v72
  v_accvgpr_write_b32 a53, v73
  v_accvgpr_write_b32 a54, v74
  v_accvgpr_write_b32 a55, v75
  v_mfma_f32_16x16x32_bf16 v[72:75], a[250:253], v[168:171], v[32:35]
  s_add_u32 m0, s94, 156672
  v_mfma_f32_16x16x32_bf16 v[76:79], a[248:251], v[168:171], v[32:35]
  buffer_load_dword v53, s[12:15], s95 offen lds
  v_cvt_pk_bf16_f32 v80, v80, v81
  v_cvt_pk_bf16_f32 v81, v82, v83
  v_cvt_pk_bf16_f32 v82, v84, v85
  v_cvt_pk_bf16_f32 v83, v86, v87
  v_accvgpr_write_b32 a56, v80
  s_add_u32 m0, s94, 156928
  v_accvgpr_write_b32 a57, v81
  buffer_load_dword v54, s[12:15], s95 offen lds
  v_accvgpr_write_b32 a58, v82
  v_accvgpr_write_b32 a59, v83
  v_mfma_f32_16x16x32_bf16 v[80:83], a[250:253], v[172:175], v[32:35]
  v_mfma_f32_16x16x32_bf16 v[84:87], a[248:251], v[172:175], v[32:35]
  buffer_load_dword a201, v5, s[20:23], 0 offen offset:128
  v_cvt_pk_bf16_f32 v64, v64, v65
  v_cvt_pk_bf16_f32 v65, v66, v67
  v_cvt_pk_bf16_f32 v66, v68, v69
  v_cvt_pk_bf16_f32 v67, v70, v71
  v_accvgpr_write_b32 a60, v64
  v_accvgpr_write_b32 a61, v65
  v_accvgpr_write_b32 a62, v66
  v_accvgpr_write_b32 a63, v67
  v_cvt_pk_bf16_f32 v72, v72, v73
  v_cvt_pk_bf16_f32 v73, v74, v75
  v_cvt_pk_bf16_f32 v74, v76, v77
  v_cvt_pk_bf16_f32 v75, v78, v79
  v_accvgpr_write_b32 a64, v72
  v_accvgpr_write_b32 a65, v73
  buffer_load_dword a202, v5, s[20:23], 0 offen offset:256
  v_accvgpr_write_b32 a66, v74
  v_accvgpr_write_b32 a67, v75
  v_cvt_pk_bf16_f32 v80, v80, v81
  v_cvt_pk_bf16_f32 v81, v82, v83
  v_cvt_pk_bf16_f32 v82, v84, v85
  v_cvt_pk_bf16_f32 v83, v86, v87
  v_accvgpr_write_b32 a68, v80
  v_accvgpr_write_b32 a69, v81
  v_accvgpr_write_b32 a70, v82
  v_accvgpr_write_b32 a71, v83
  s_mov_b64 exec, 0
  s_cmp_eq_u32 s64, 0
  s_cbranch_scc1 L_pg0
  s_cmp_eq_u32 s64, 1
  s_cbranch_scc1 L_pg1
  s_cmp_eq_u32 s64, 2
  s_cbranch_scc1 L_pg2
  s_branch L_pg3
L_pgret:
  s_mov_b64 exec, -1
  s_waitcnt vmcnt(15)
  v_add_u32 v29, 73728, v29
  v_add_u32 v30, 73728, v30
  ds_read_b128 v[176:179], v29
  ds_read_b128 v[180:183], v30
  s_add_u32 s68, s68, 294912
  s_add_u32 m0, s65, 36864
  s_nop 0
  buffer_load_dwordx4 v12, s[20:23], s68 offen lds
  ds_read_b128 v[184:187], v29 offset:1024
  ds_read_b128 v[188:191], v30 offset:1024
  ds_read_b128 v[192:195], v29 offset:2048
  ds_read_b128 v[196:199], v30 offset:2048
  ds_read_b128 v[200:203], v29 offset:3072
  ds_read_b128 v[204:207], v30 offset:3072
  ds_read_b128 v[208:211], v29 offset:4096
  ds_read_b128 v[212:215], v30 offset:4096
  ds_read_b128 v[216:219], v29 offset:5120
  ds_read_b128 v[220:223], v30 offset:5120
  ds_read_b128 v[224:227], v29 offset:6144
  ds_read_b128 v[228:231], v30 offset:6144
  ds_read_b128 v[232:235], v29 offset:7168
  ds_read_b128 v[236:239], v30 offset:7168
  s_add_u32 s68, s68, 293888
  buffer_load_dwordx4 v12, s[20:23], s68 offen offset:1024 lds
  ds_read_b128 v[240:243], v29 offset:8192
  ds_read_b128 v[244:247], v30 offset:8192
  s_waitcnt lgkmcnt(14)
  v_mfma_f32_16x16x32_bf16 v[96:99], v[248:251], v[176:179], 0
  v_mfma_f32_16x16x32_bf16 v[96:99], v[248:251], v[180:183], v[96:99]
  v_mfma_f32_16x16x32_bf16 v[96:99], v[248:251], v[184:187], v[96:99]
  v_mfma_f32_16x16x32_bf16 v[96:99], v[248:251], v[188:191], v[96:99]
  s_add_u32 s68, s68, 293888
  buffer_load_dwordx4 v12, s[20:23], s68 offen offset:2048 lds
  s_waitcnt lgkmcnt(13)
  v_mfma_f32_16x16x32_bf16 v[96:99], v[248:251], v[192:195], v[96:99]
  s_waitcnt lgkmcnt(12)
  v_mfma_f32_16x16x32_bf16 v[96:99], v[248:251], v[196:199], v[96:99]
  s_waitcnt lgkmcnt(11)
  v_mfma_f32_16x16x32_bf16 v[96:99], v[248:251], v[200:203], v[96:99]
  s_waitcnt lgkmcnt(10)
  v_mfma_f32_16x16x32_bf16 v[96:99], v[248:251], v[204:207], v[96:99]
  s_waitcnt lgkmcnt(9)
  v_mfma_f32_16x16x32_bf16 v[96:99], v[248:251], v[208:211], v[96:99]
  s_add_u32 s68, s68, 293888
  buffer_load_dwordx4 v12, s[20:23], s68 offen offset:3072 lds
  s_waitcnt lgkmcnt(8)
  v_mfma_f32_16x16x32_bf16 v[96:99], v[248:251], v[212:215], v[96:99]
  s_waitcnt lgkmcnt(7)
  v_mfma_f32_16x16x32_bf16 v[96:99], v[248:251], v[216:219], v[96:99]
  s_waitcnt lgkmcnt(6)
  v_mfma_f32_16x16x32_bf16 v[96:99], v[248:251], v[220:223], v[96:99]
  s_waitcnt lgkmcnt(5)
  v_mfma_f32_16x16x32_bf16 v[96:99], v[248:251], v[224:227], v[96:99]
  s_waitcnt lgkmcnt(4)
  v_mfma_f32_16x16x32_bf16 v[96:99], v[248:251], v[228:231], v[96:99]
  s_add_u32 s68, s68, 297984
  s_add_u32 m0, s65, 40960
  s_nop 0
  buffer_load_dwordx4 v12, s[20:23], s68 offen lds
  s_waitcnt lgkmcnt(3)
  v_mfma_f32_16x16x32_bf16 v[96:99], v[248:251], v[232:235], v[96:99]
  s_waitcnt lgkmcnt(2)
  v_mfma_f32_16x16x32_bf16 v[96:99], v[248:251], v[236:239], v[96:99]
  s_waitcnt lgkmcnt(1)
  v_mfma_f32_16x16x32_bf16 v[96:99], v[248:251], v[240:243], v[96:99]
  s_waitcnt lgkmcnt(0)
  v_mfma_f32_16x16x32_bf16 v[96:99], v[248:251], v[244:247], v[96:99]
  s_nop 7
  v_mul_f32 v104, 0xbae38e39, v96
  v_mul_f32 v105, 0xbae38e39, v97
  s_add_u32 s68, s68, 293888
  buffer_load_dwordx4 v12, s[20:23], s68 offen offset:1024 lds
  s_nop 3
  v_mul_f32 v106, 0xbae38e39, v98
  v_mul_f32 v107, 0xbae38e39, v99
  s_nop 1
  v_mfma_f32_16x16x32_bf16 v[112:115], a[250:253], v[176:179], v[104:107]
  v_mfma_f32_16x16x32_bf16 v[116:119], a[248:251], v[176:179], v[104:107]
  v_mfma_f32_16x16x32_bf16 v[120:123], a[250:253], v[180:183], v[104:107]
  v_mfma_f32_16x16x32_bf16 v[124:127], a[248:251], v[180:183], v[104:107]
  s_add_u32 s68, s68, 293888
  buffer_load_dwordx4 v12, s[20:23], s68 offen offset:2048 lds
  v_mfma_f32_16x16x32_bf16 v[128:131], a[250:253], v[184:187], v[104:107]
  v_mfma_f32_16x16x32_bf16 v[132:135], a[248:251], v[184:187], v[104:107]
  s_nop 0
  v_cvt_pk_bf16_f32 v32, v112, v113
  v_cvt_pk_bf16_f32 v33, v114, v115
  v_cvt_pk_bf16_f32 v34, v116, v117
  v_cvt_pk_bf16_f32 v35, v118, v119
  v_mfma_f32_16x16x32_bf16 v[112:115], a[250:253], v[188:191], v[104:107]
  v_mfma_f32_16x16x32_bf16 v[116:119], a[248:251], v[188:191], v[104:107]
  s_add_u32 s68, s68, 293888
  buffer_load_dwordx4 v12, s[20:23], s68 offen offset:3072 lds
  v_cvt_pk_bf16_f32 v36, v120, v121
  v_cvt_pk_bf16_f32 v37, v122, v123
  v_cvt_pk_bf16_f32 v38, v124, v125
  v_cvt_pk_bf16_f32 v39, v126, v127
  v_mfma_f32_16x16x32_bf16 v[120:123], a[250:253], v[192:195], v[104:107]
  v_mfma_f32_16x16x32_bf16 v[124:127], a[248:251], v[192:195], v[104:107]
  v_cvt_pk_bf16_f32 v40, v128, v129
  v_cvt_pk_bf16_f32 v41, v130, v131
  v_cvt_pk_bf16_f32 v42, v132, v133
  v_cvt_pk_bf16_f32 v43, v134, v135
  s_add_u32 s68, s68, 297984
  s_add_u32 m0, s65, 45056
  s_nop 0
  buffer_load_dwordx4 v12, s[20:23], s68 offen lds
  v_mfma_f32_16x16x32_bf16 v[128:131], a[250:253], v[196:199], v[104:107]
  v_mfma_f32_16x16x32_bf16 v[132:135], a[248:251], v[196:199], v[104:107]
  v_cvt_pk_bf16_f32 v44, v112, v113
  v_cvt_pk_bf16_f32 v45, v114, v115
  v_cvt_pk_bf16_f32 v46, v116, v117
  v_cvt_pk_bf16_f32 v47, v118, v119
  v_mfma_f32_16x16x32_bf16 v[112:115], a[250:253], v[200:203], v[104:107]
  v_mfma_f32_16x16x32_bf16 v[116:119], a[248:251], v[200:203], v[104:107]
  s_sub_u32 s68, s68, 5013376
  s_add_u32 m0, s65, 73728
  s_nop 0
  buffer_load_dwordx4 v12, s[20:23], s68 offen lds
  v_cvt_pk_bf16_f32 v48, v120, v121
  v_cvt_pk_bf16_f32 v49, v122, v123
  v_cvt_pk_bf16_f32 v50, v124, v125
  v_cvt_pk_bf16_f32 v51, v126, v127
  v_mfma_f32_16x16x32_bf16 v[120:123], a[250:253], v[204:207], v[104:107]
  v_mfma_f32_16x16x32_bf16 v[124:127], a[248:251], v[204:207], v[104:107]
  v_cvt_pk_bf16_f32 v52, v128, v129
  v_cvt_pk_bf16_f32 v53, v130, v131
  v_cvt_pk_bf16_f32 v54, v132, v133
  v_cvt_pk_bf16_f32 v55, v134, v135
  s_add_u32 s68, s68, 293888
  buffer_load_dwordx4 v12, s[20:23], s68 offen offset:1024 lds
  v_mfma_f32_16x16x32_bf16 v[128:131], a[250:253], v[208:211], v[104:107]
  v_mfma_f32_16x16x32_bf16 v[132:135], a[248:251], v[208:211], v[104:107]
  v_cvt_pk_bf16_f32 v56, v112, v113
  v_cvt_pk_bf16_f32 v57, v114, v115
  v_cvt_pk_bf16_f32 v58, v116, v117
  v_cvt_pk_bf16_f32 v59, v118, v119
  v_mfma_f32_16x16x32_bf16 v[112:115], a[250:253], v[212:215], v[104:107]
  v_mfma_f32_16x16x32_bf16 v[116:119], a[248:251], v[212:215], v[104:107]
  s_add_u32 s68, s68, 293888
  buffer_load_dwordx4 v12, s[20:23], s68 offen offset:2048 lds
  v_cvt_pk_bf16_f32 v60, v120, v121
L_pg0:
  s_cbranch_execz L_pg4
  v_cvt_pk_bf16_f32 v61, v122, v123
  v_cvt_pk_bf16_f32 v62, v124, v125
  v_cvt_pk_bf16_f32 v63, v126, v127
  v_mfma_f32_16x16x32_bf16 v[120:123], a[250:253], v[216:219], v[104:107]
  v_mfma_f32_16x16x32_bf16 v[124:127], a[248:251], v[216:219], v[104:107]
  v_cvt_pk_bf16_f32 v64, v128, v129
  v_cvt_pk_bf16_f32 v65, v130, v131
  v_cvt_pk_bf16_f32 v66, v132, v133
  v_cvt_pk_bf16_f32 v67, v134, v135
  s_add_u32 s68, s68, 293888
  buffer_load_dwordx4 v12, s[20:23], s68 offen offset:3072 lds
  v_mfma_f32_16x16x32_bf16 v[128:131], a[250:253], v[220:223], v[104:107]
  v_mfma_f32_16x16x32_bf16 v[132:135], a[248:251], v[220:223], v[104:107]
  v_cvt_pk_bf16_f32 v68, v112, v113
  v_cvt_pk_bf16_f32 v69, v114, v115
  v_cvt_pk_bf16_f32 v70, v116, v117
  v_cvt_pk_bf16_f32 v71, v118, v119
  v_mfma_f32_16x16x32_bf16 v[112:115], a[250:253], v[224:227], v[104:107]
  v_mfma_f32_16x16x32_bf16 v[116:119], a[248:251], v[224:227], v[104:107]
  s_add_u32 s68, s68, 297984
  s_add_u32 m0, s65, 77824
  s_nop 0
  buffer_load_dwordx4 v12, s[20:23], s68 offen lds
  v_cvt_pk_bf16_f32 v72, v120, v121
  v_cvt_pk_bf16_f32 v73, v122, v123
  v_cvt_pk_bf16_f32 v74, v124, v125
  v_cvt_pk_bf16_f32 v75, v126, v127
  v_mfma_f32_16x16x32_bf16 v[120:123], a[250:253], v[228:231], v[104:107]
  v_mfma_f32_16x16x32_bf16 v[124:127], a[248:251], v[228:231], v[104:107]
  v_cvt_pk_bf16_f32 v76, v128, v129
  v_cvt_pk_bf16_f32 v77, v130, v131
  v_cvt_pk_bf16_f32 v78, v132, v133
  v_cvt_pk_bf16_f32 v79, v134, v135
  s_add_u32 s68, s68, 293888
  buffer_load_dwordx4 v12, s[20:23], s68 offen offset:1024 lds
  v_mfma_f32_16x16x32_bf16 v[128:131], a[250:253], v[232:235], v[104:107]
  v_mfma_f32_16x16x32_bf16 v[132:135], a[248:251], v[232:235], v[104:107]
  v_cvt_pk_bf16_f32 v80, v112, v113
  v_cvt_pk_bf16_f32 v81, v114, v115
  v_cvt_pk_bf16_f32 v82, v116, v117
  v_cvt_pk_bf16_f32 v83, v118, v119
  v_mfma_f32_16x16x32_bf16 v[112:115], a[250:253], v[236:239], v[104:107]
  v_mfma_f32_16x16x32_bf16 v[116:119], a[248:251], v[236:239], v[104:107]
  s_add_u32 s68, s68, 293888
  buffer_load_dwordx4 v12, s[20:23], s68 offen offset:2048 lds
  v_cvt_pk_bf16_f32 v84, v120, v121
  v_cvt_pk_bf16_f32 v85, v122, v123
  v_cvt_pk_bf16_f32 v86, v124, v125
  v_cvt_pk_bf16_f32 v87, v126, v127
  v_mfma_f32_16x16x32_bf16 v[120:123], a[250:253], v[240:243], v[104:107]
  v_mfma_f32_16x16x32_bf16 v[124:127], a[248:251], v[240:243], v[104:107]
  v_cvt_pk_bf16_f32 v88, v128, v129
  v_cvt_pk_bf16_f32 v89, v130, v131
  v_cvt_pk_bf16_f32 v90, v132, v133
  v_cvt_pk_bf16_f32 v91, v134, v135
  s_add_u32 s68, s68, 293888
  buffer_load_dwordx4 v12, s[20:23], s68 offen offset:3072 lds
  v_mfma_f32_16x16x32_bf16 v[128:131], a[250:253], v[244:247], v[104:107]
  v_mfma_f32_16x16x32_bf16 v[132:135], a[248:251], v[244:247], v[104:107]
  v_cvt_pk_bf16_f32 v92, v112, v113
  v_cvt_pk_bf16_f32 v93, v114, v115
  v_cvt_pk_bf16_f32 v94, v116, v117
  v_cvt_pk_bf16_f32 v95, v118, v119
  v_cvt_pk_bf16_f32 v96, v120, v121
  v_cvt_pk_bf16_f32 v97, v122, v123
  v_cvt_pk_bf16_f32 v98, v124, v125
  v_cvt_pk_bf16_f32 v99, v126, v127
  s_add_u32 s68, s68, 297984
  s_add_u32 m0, s65, 81920
  s_nop 0
  buffer_load_dwordx4 v12, s[20:23], s68 offen lds
  v_cvt_pk_bf16_f32 v100, v128, v129
  v_cvt_pk_bf16_f32 v101, v130, v131
  v_cvt_pk_bf16_f32 v102, v132, v133
  v_cvt_pk_bf16_f32 v103, v134, v135
  s_waitcnt vmcnt(20)
  s_barrier
  ds_read_b64_tr_b16 a[72:73], v2
  ds_read_b64_tr_b16 a[74:75], v2 offset:18432
  ds_read_b64_tr_b16 a[76:77], v3
  ds_read_b64_tr_b16 a[78:79], v3 offset:18432
  ds_read_b64_tr_b16 a[80:81], v8
  ds_read_b64_tr_b16 a[82:83], v8 offset:18432
  ds_read_b64_tr_b16 a[84:85], v9
  ds_read_b64_tr_b16 a[86:87], v9 offset:18432
  ds_read_b64_tr_b16 a[88:89], v2 offset:1024
  ds_read_b64_tr_b16 a[90:91], v2 offset:19456
  ds_read_b64_tr_b16 a[92:93], v3 offset:1024
  ds_read_b64_tr_b16 a[94:95], v3 offset:19456
  s_waitcnt lgkmcnt(8)
  v_mfma_f32_16x16x32_bf16 v[176:179], a[72:75], a[0:3], 0
  ds_read_b64_tr_b16 a[96:97], v8 offset:1024
  ds_read_b64_tr_b16 a[104:105], v19
  v_accvgpr_read_b32 v14, a188
  v_mfma_f32_16x16x32_bf16 v[180:183], a[72:75], v[32:35], 0
  ds_read_b64_tr_b16 a[98:99], v8 offset:19456
  ds_read_b64_tr_b16 a[106:107], v20
  s_add_u32 m0, s65, 110592
  v_mfma_f32_16x16x32_bf16 v[184:187], a[76:79], a[0:3], 0
  ds_read_b64_tr_b16 a[100:101], v9 offset:1024
  ds_read_b64_tr_b16 a[108:109], v19 offset:8
  buffer_load_dwordx4 v14, s[16:19], s70 offen nt lds
  v_mfma_f32_16x16x32_bf16 v[188:191], a[76:79], v[32:35], 0
  ds_read_b64_tr_b16 a[102:103], v9 offset:19456
  ds_read_b64_tr_b16 a[110:111], v20 offset:8
  s_waitcnt lgkmcnt(12)
  v_mfma_f32_16x16x32_bf16 v[192:195], a[80:83], a[0:3], 0
  ds_read_b64_tr_b16 a[72:73], v2 offset:2048
  v_mfma_f32_16x16x32_bf16 v[196:199], a[80:83], v[32:35], 0
  ds_read_b64_tr_b16 a[74:75], v2 offset:20480
  ds_read_b64_tr_b16 a[112:113], v21
  v_mfma_f32_16x16x32_bf16 v[200:203], a[84:87], a[0:3], 0
  ds_read_b64_tr_b16 a[76:77], v3 offset:2048
  ds_read_b64_tr_b16 a[114:115], v22
  v_mfma_f32_16x16x32_bf16 v[204:207], a[84:87], v[32:35], 0
  ds_read_b64_tr_b16 a[78:79], v3 offset:20480
  ds_read_b64_tr_b16 a[116:117], v21 offset:8
  s_waitcnt lgkmcnt(14)
  v_mfma_f32_16x16x32_bf16 v[176:179], a[88:91], a[4:7], v[176:179]
  ds_read_b64_tr_b16 a[80:81], v8 offset:2048
  ds_read_b64_tr_b16 a[118:119], v22 offset:8
  v_mfma_f32_16x16x32_bf16 v[180:183], a[88:91], v[36:39], v[180:183]
  ds_read_b64_tr_b16 a[82:83], v8 offset:20480
  v_accvgpr_read_b32 v15, a189
  v_mfma_f32_16x16x32_bf16 v[184:187], a[92:95], a[4:7], v[184:187]
  ds_read_b64_tr_b16 a[84:85], v9 offset:2048
  ds_read_b64_tr_b16 a[120:121], v23
  buffer_load_dwordx4 v15, s[16:19], s70 offen offset:1024 nt lds
  v_mfma_f32_16x16x32_bf16 v[188:191], a[92:95], v[36:39], v[188:191]
  ds_read_b64_tr_b16 a[86:87], v9 offset:20480
  ds_read_b64_tr_b16 a[124:125], v23 offset:8
  s_waitcnt lgkmcnt(14)
  v_mfma_f32_16x16x32_bf16 v[192:195], a[96:99], a[4:7], v[192:195]
  ds_read_b64_tr_b16 a[88:89], v2 offset:3072
  ds_read_b128 a[128:131], v24
  v_mfma_f32_16x16x32_bf16 v[196:199], a[96:99], v[36:39], v[196:199]
  ds_read_b64_tr_b16 a[90:91], v2 offset:21504
  ds_read_b128 a[132:135], v24 offset:4096
  v_mfma_f32_16x16x32_bf16 v[200:203], a[100:103], a[4:7], v[200:203]
  ds_read_b64_tr_b16 a[92:93], v3 offset:3072
  v_mfma_f32_16x16x32_bf16 v[204:207], a[100:103], v[36:39], v[204:207]
  ds_read_b64_tr_b16 a[94:95], v3 offset:21504
  ds_read_b128 a[136:139], v25
  s_waitcnt lgkmcnt(14)
  v_mfma_f32_16x16x32_bf16 v[176:179], a[72:75], a[8:11], v[176:179]
  ds_read_b64_tr_b16 a[96:97], v8 offset:3072
  ds_read_b128 a[140:143], v25 offset:4096
  v_mfma_f32_16x16x32_bf16 v[180:183], a[72:75], v[40:43], v[180:183]
  ds_read_b64_tr_b16 a[98:99], v8 offset:21504
  ds_read_b128 a[144:147], v26
  v_mfma_f32_16x16x32_bf16 v[184:187], a[76:79], a[8:11], v[184:187]
  ds_read_b64_tr_b16 a[100:101], v9 offset:3072
  ds_read_b128 a[148:151], v26 offset:4096
  buffer_load_dword a203, v5, s[20:23], 0 offen offset:384
  v_mfma_f32_16x16x32_bf16 v[188:191], a[76:79], v[40:43], v[188:191]
  ds_read_b64_tr_b16 a[102:103], v9 offset:21504
  s_waitcnt lgkmcnt(14)
  v_mfma_f32_16x16x32_bf16 v[192:195], a[80:83], a[8:11], v[192:195]
  ds_read_b64_tr_b16 a[72:73], v2 offset:4096
  v_mfma_f32_16x16x32_bf16 v[196:199], a[80:83], v[40:43], v[196:199]
  ds_read_b64_tr_b16 a[74:75], v2 offset:22528
  v_mfma_f32_16x16x32_bf16 v[200:203], a[84:87], a[8:11], v[200:203]
  ds_read_b64_tr_b16 a[76:77], v3 offset:4096
  s_waitcnt lgkmcnt(14)
  v_mfma_f32_16x16x32_bf16 v[248:251], a[128:131], a[108:111], 0
  buffer_load_dword a204, v5, s[20:23], 0 offen offset:512
  v_mfma_f32_16x16x32_bf16 v[204:207], a[84:87], v[40:43], v[204:207]
  ds_read_b64_tr_b16 a[78:79], v3 offset:22528
  s_waitcnt lgkmcnt(14)
  v_mfma_f32_16x16x32_bf16 v[252:255], a[132:135], a[108:111], 0
  s_waitcnt lgkmcnt(12)
  v_mfma_f32_16x16x32_bf16 v[176:179], a[88:91], a[12:15], v[176:179]
  ds_read_b64_tr_b16 a[80:81], v8 offset:4096
  s_waitcnt lgkmcnt(12)
  v_mfma_f32_16x16x32_bf16 v[248:251], a[136:139], a[116:119], v[248:251]
  v_mfma_f32_16x16x32_bf16 v[180:183], a[88:91], v[44:47], v[180:183]
  ds_read_b64_tr_b16 a[82:83], v8 offset:22528
  s_waitcnt lgkmcnt(11)
  v_mfma_f32_16x16x32_bf16 v[252:255], a[140:143], a[116:119], v[252:255]
  v_mfma_f32_16x16x32_bf16 v[184:187], a[92:95], a[12:15], v[184:187]
  ds_read_b64_tr_b16 a[84:85], v9 offset:4096
  s_waitcnt lgkmcnt(10)
  v_mfma_f32_16x16x32_bf16 v[248:251], a[144:147], a[124:127], v[248:251]
  v_mfma_f32_16x16x32_bf16 v[188:191], a[92:95], v[44:47], v[188:191]
  ds_read_b64_tr_b16 a[86:87], v9 offset:22528
  s_waitcnt lgkmcnt(9)
  v_mfma_f32_16x16x32_bf16 v[252:255], a[148:151], a[124:127], v[252:255]
  s_waitcnt lgkmcnt(8)
  v_mfma_f32_16x16x32_bf16 v[192:195], a[96:99], a[12:15], v[192:195]
  ds_read_b64_tr_b16 a[88:89], v2 offset:5120
  v_bfe_u32 v16, v0, 3, 1
  v_mfma_f32_16x16x32_bf16 v[196:199], a[96:99], v[44:47], v[196:199]
  ds_read_b64_tr_b16 a[90:91], v2 offset:23552
  v_mul_u32_u24 v16, 7168, v16
  v_mfma_f32_16x16x32_bf16 v[200:203], a[100:103], a[12:15], v[200:203]
  ds_read_b64_tr_b16 a[92:93], v3 offset:5120
  v_mfma_f32_16x16x32_bf16 v[204:207], a[100:103], v[44:47], v[204:207]
  ds_read_b64_tr_b16 a[94:95], v3 offset:23552
  v_subrev_u32 v16, 37888, v16
  s_waitcnt lgkmcnt(8)
  v_mfma_f32_16x16x32_bf16 v[176:179], a[72:75], a[16:19], v[176:179]
  ds_read_b64_tr_b16 a[96:97], v8 offset:5120
  v_cvt_pk_bf16_f32 v28, v248, v249
  v_add_u32 v24, v16, v24
  v_mfma_f32_16x16x32_bf16 v[180:183], a[72:75], v[48:51], v[180:183]
  ds_read_b64_tr_b16 a[98:99], v8 offset:23552
  v_cvt_pk_bf16_f32 v29, v250, v251
  v_mfma_f32_16x16x32_bf16 v[184:187], a[76:79], a[16:19], v[184:187]
  ds_read_b64_tr_b16 a[100:101], v9 offset:5120
  v_cvt_pk_bf16_f32 v30, v252, v253
  v_add_u32 v25, v16, v25
  v_mfma_f32_16x16x32_bf16 v[188:191], a[76:79], v[48:51], v[188:191]
  ds_read_b64_tr_b16 a[102:103], v9 offset:23552
  v_add_u32 v26, v16, v26
  s_waitcnt lgkmcnt(8)
  v_mfma_f32_16x16x32_bf16 v[192:195], a[80:83], a[16:19], v[192:195]
  ds_read_b64_tr_b16 a[72:73], v2 offset:6144
  v_cvt_pk_bf16_f32 v31, v254, v255
  v_mfma_f32_16x16x32_bf16 v[196:199], a[80:83], v[48:51], v[196:199]
  ds_read_b64_tr_b16 a[74:75], v2 offset:24576
  v_mfma_f32_16x16x32_bf16 v[248:251], a[128:131], a[104:107], 0
  v_mfma_f32_16x16x32_bf16 v[200:203], a[84:87], a[16:19], v[200:203]
  ds_read_b64_tr_b16 a[76:77], v3 offset:6144
  v_mfma_f32_16x16x32_bf16 v[252:255], a[132:135], a[104:107], 0
  buffer_store_dwordx4 v[28:31], v1, s[36:39], s81 offen sc1
  v_mfma_f32_16x16x32_bf16 v[204:207], a[84:87], v[48:51], v[204:207]
  ds_read_b64_tr_b16 a[78:79], v3 offset:24576
  v_mfma_f32_16x16x32_bf16 v[248:251], a[136:139], a[112:115], v[248:251]
  s_waitcnt lgkmcnt(8)
  v_mfma_f32_16x16x32_bf16 v[176:179], a[88:91], a[20:23], v[176:179]
  ds_read_b64_tr_b16 a[80:81], v8 offset:6144
  v_mfma_f32_16x16x32_bf16 v[252:255], a[140:143], a[112:115], v[252:255]
  v_mfma_f32_16x16x32_bf16 v[180:183], a[88:91], v[52:55], v[180:183]
  ds_read_b64_tr_b16 a[82:83], v8 offset:24576
  v_mfma_f32_16x16x32_bf16 v[248:251], a[144:147], a[120:123], v[248:251]
  v_mfma_f32_16x16x32_bf16 v[184:187], a[92:95], a[20:23], v[184:187]
  ds_read_b64_tr_b16 a[84:85], v9 offset:6144
  v_mfma_f32_16x16x32_bf16 v[252:255], a[148:151], a[120:123], v[252:255]
  v_mfma_f32_16x16x32_bf16 v[188:191], a[92:95], v[52:55], v[188:191]
  ds_read_b64_tr_b16 a[86:87], v9 offset:24576
  s_waitcnt lgkmcnt(8)
  v_mfma_f32_16x16x32_bf16 v[192:195], a[96:99], a[20:23], v[192:195]
  ds_read_b64_tr_b16 a[88:89], v2 offset:7168
  v_mfma_f32_16x16x32_bf16 v[196:199], a[96:99], v[52:55], v[196:199]
  ds_read_b64_tr_b16 a[90:91], v2 offset:25600
  v_accvgpr_read_b32 v14, a190
  v_mfma_f32_16x16x32_bf16 v[200:203], a[100:103], a[20:23], v[200:203]
  ds_read_b64_tr_b16 a[92:93], v3 offset:7168
  v_cvt_pk_bf16_f32 v248, v248, v249
  buffer_load_dwordx4 v14, s[16:19], s70 offen offset:2048 nt lds
  v_mfma_f32_16x16x32_bf16 v[204:207], a[100:103], v[52:55], v[204:207]
  ds_read_b64_tr_b16 a[94:95], v3 offset:25600
  s_waitcnt lgkmcnt(8)
  v_mfma_f32_16x16x32_bf16 v[176:179], a[72:75], a[24:27], v[176:179]
  ds_read_b64_tr_b16 a[96:97], v8 offset:7168
  v_cvt_pk_bf16_f32 v249, v250, v251
  v_mfma_f32_16x16x32_bf16 v[180:183], a[72:75], v[56:59], v[180:183]
  ds_read_b64_tr_b16 a[98:99], v8 offset:25600
  v_cvt_pk_bf16_f32 v250, v252, v253
  v_mfma_f32_16x16x32_bf16 v[184:187], a[76:79], a[24:27], v[184:187]
  ds_read_b64_tr_b16 a[100:101], v9 offset:7168
  v_cvt_pk_bf16_f32 v251, v254, v255
  v_mfma_f32_16x16x32_bf16 v[188:191], a[76:79], v[56:59], v[188:191]
  ds_read_b64_tr_b16 a[102:103], v9 offset:25600
  s_waitcnt lgkmcnt(8)
  v_mfma_f32_16x16x32_bf16 v[192:195], a[80:83], a[24:27], v[192:195]
  ds_read_b64_tr_b16 a[72:73], v2 offset:8192
  buffer_store_dwordx4 v[248:251], v1, s[36:39], s80 offen sc1
  v_mfma_f32_16x16x32_bf16 v[196:199], a[80:83], v[56:59], v[196:199]
  ds_read_b64_tr_b16 a[74:75], v2 offset:26624
  s_cmp_eq_u32 s64, 2
  s_movk_i32 s40, 4096
  s_cmovk_i32 s40, 2048
  v_mfma_f32_16x16x32_bf16 v[200:203], a[84:87], a[24:27], v[200:203]
  ds_read_b64_tr_b16 a[76:77], v3 offset:8192
  s_add_u32 s80, s80, s40
  v_accvgpr_read_b32 v15, a191
  buffer_load_dwordx4 v15, s[16:19], s70 offen offset:3072 nt lds
  v_mfma_f32_16x16x32_bf16 v[204:207], a[84:87], v[56:59], v[204:207]
  ds_read_b64_tr_b16 a[78:79], v3 offset:26624
  s_waitcnt lgkmcnt(8)
  v_mfma_f32_16x16x32_bf16 v[176:179], a[88:91], a[28:31], v[176:179]
  ds_read_b64_tr_b16 a[80:81], v8 offset:8192
  v_mfma_f32_16x16x32_bf16 v[180:183], a[88:91], v[60:63], v[180:183]
  ds_read_b64_tr_b16 a[82:83], v8 offset:26624
  s_add_u32 s81, s81, 4096
  v_mfma_f32_16x16x32_bf16 v[184:187], a[92:95], a[28:31], v[184:187]
  ds_read_b64_tr_b16 a[84:85], v9 offset:8192
  s_cmp_lt_u32 s60, 14
  s_cmov_b32 s80, 1073741824
  s_cmov_b32 s81, 1073741824
  v_mfma_f32_16x16x32_bf16 v[188:191], a[92:95], v[60:63], v[188:191]
  ds_read_b64_tr_b16 a[86:87], v9 offset:26624
  s_waitcnt lgkmcnt(8)
  v_mfma_f32_16x16x32_bf16 v[192:195], a[96:99], a[28:31], v[192:195]
  s_waitcnt vmcnt(6)
  s_barrier
  ds_read_b64_tr_b16 a[88:89], v2 offset:36864
  v_accvgpr_read_b32 v14, a192
  v_mfma_f32_16x16x32_bf16 v[196:199], a[96:99], v[60:63], v[196:199]
  ds_read_b64_tr_b16 a[90:91], v2 offset:55296
  ds_read_b128 a[128:131], v24
  s_add_u32 m0, s65, 114688
  v_mfma_f32_16x16x32_bf16 v[200:203], a[100:103], a[28:31], v[200:203]
  ds_read_b64_tr_b16 a[92:93], v3 offset:36864
  ds_read_b128 a[132:135], v24 offset:18432
  buffer_load_dwordx4 v14, s[16:19], s70 offen nt lds
  v_mfma_f32_16x16x32_bf16 v[204:207], a[100:103], v[60:63], v[204:207]
  ds_read_b64_tr_b16 a[94:95], v3 offset:55296
  s_waitcnt lgkmcnt(10)
  v_mfma_f32_16x16x32_bf16 v[176:179], a[72:75], a[32:35], v[176:179]
  ds_read_b64_tr_b16 a[96:97], v8 offset:36864
  ds_read_b128 a[136:139], v25
  v_mfma_f32_16x16x32_bf16 v[180:183], a[72:75], v[64:67], v[180:183]
  ds_read_b64_tr_b16 a[98:99], v8 offset:55296
  ds_read_b128 a[140:143], v25 offset:18432
  v_mfma_f32_16x16x32_bf16 v[184:187], a[76:79], a[32:35], v[184:187]
  ds_read_b64_tr_b16 a[100:101], v9 offset:36864
  ds_read_b128 a[144:147], v26
  v_mfma_f32_16x16x32_bf16 v[188:191], a[76:79], v[64:67], v[188:191]
  ds_read_b64_tr_b16 a[102:103], v9 offset:55296
  s_waitcnt lgkmcnt(13)
  v_mfma_f32_16x16x32_bf16 v[192:195], a[80:83], a[32:35], v[192:195]
  ds_read_b64_tr_b16 a[72:73], v2 offset:37888
  ds_read_b128 a[148:151], v26 offset:18432
  v_mfma_f32_16x16x32_bf16 v[196:199], a[80:83], v[64:67], v[196:199]
  ds_read_b64_tr_b16 a[74:75], v2 offset:56320
  v_accvgpr_read_b32 v15, a193
  v_mfma_f32_16x16x32_bf16 v[200:203], a[84:87], a[32:35], v[200:203]
  ds_read_b64_tr_b16 a[76:77], v3 offset:37888
  buffer_load_dwordx4 v15, s[16:19], s70 offen offset:1024 nt lds
  v_mfma_f32_16x16x32_bf16 v[204:207], a[84:87], v[64:67], v[204:207]
  ds_read_b64_tr_b16 a[78:79], v3 offset:56320
  s_waitcnt lgkmcnt(12)
  v_mfma_f32_16x16x32_bf16 v[176:179], a[88:91], a[36:39], v[176:179]
  ds_read_b64_tr_b16 a[80:81], v8 offset:37888
  v_mfma_f32_16x16x32_bf16 v[180:183], a[88:91], v[68:71], v[180:183]
  ds_read_b64_tr_b16 a[82:83], v8 offset:56320
  v_mfma_f32_16x16x32_bf16 v[248:251], a[128:131], a[108:111], 0
  v_mfma_f32_16x16x32_bf16 v[184:187], a[92:95], a[36:39], v[184:187]
  ds_read_b64_tr_b16 a[84:85], v9 offset:37888
  v_mfma_f32_16x16x32_bf16 v[252:255], a[132:135], a[108:111], 0
  v_mfma_f32_16x16x32_bf16 v[188:191], a[92:95], v[68:71], v[188:191]
  ds_read_b64_tr_b16 a[86:87], v9 offset:56320
  s_waitcnt lgkmcnt(14)
  v_mfma_f32_16x16x32_bf16 v[248:251], a[136:139], a[116:119], v[248:251]
  s_waitcnt lgkmcnt(9)
  v_mfma_f32_16x16x32_bf16 v[192:195], a[96:99], a[36:39], v[192:195]
  ds_read_b64_tr_b16 a[88:89], v2 offset:38912
  v_mfma_f32_16x16x32_bf16 v[252:255], a[140:143], a[116:119], v[252:255]
  v_mfma_f32_16x16x32_bf16 v[196:199], a[96:99], v[68:71], v[196:199]
  ds_read_b64_tr_b16 a[90:91], v2 offset:57344
  v_mfma_f32_16x16x32_bf16 v[248:251], a[144:147], a[124:127], v[248:251]
  v_accvgpr_read_b32 v14, a194
  v_mfma_f32_16x16x32_bf16 v[200:203], a[100:103], a[36:39], v[200:203]
  ds_read_b64_tr_b16 a[92:93], v3 offset:38912
  s_waitcnt lgkmcnt(10)
  v_mfma_f32_16x16x32_bf16 v[252:255], a[148:151], a[124:127], v[252:255]
  buffer_load_dwordx4 v14, s[16:19], s70 offen offset:2048 nt lds
  v_mfma_f32_16x16x32_bf16 v[204:207], a[100:103], v[68:71], v[204:207]
  ds_read_b64_tr_b16 a[94:95], v3 offset:57344
  s_waitcnt lgkmcnt(8)
  v_mfma_f32_16x16x32_bf16 v[176:179], a[72:75], a[40:43], v[176:179]
  ds_read_b64_tr_b16 a[96:97], v8 offset:38912
  v_mfma_f32_16x16x32_bf16 v[180:183], a[72:75], v[72:75], v[180:183]
  ds_read_b64_tr_b16 a[98:99], v8 offset:57344
  v_mfma_f32_16x16x32_bf16 v[184:187], a[76:79], a[40:43], v[184:187]
  ds_read_b64_tr_b16 a[100:101], v9 offset:38912
  v_cvt_pk_bf16_f32 v28, v248, v249
  v_mfma_f32_16x16x32_bf16 v[188:191], a[76:79], v[72:75], v[188:191]
  ds_read_b64_tr_b16 a[102:103], v9 offset:57344
  s_waitcnt lgkmcnt(8)
  v_mfma_f32_16x16x32_bf16 v[192:195], a[80:83], a[40:43], v[192:195]
  ds_read_b64_tr_b16 a[72:73], v2 offset:39936
  v_cvt_pk_bf16_f32 v29, v250, v251
  v_mfma_f32_16x16x32_bf16 v[196:199], a[80:83], v[72:75], v[196:199]
  ds_read_b64_tr_b16 a[74:75], v2 offset:58368
  v_cvt_pk_bf16_f32 v30, v252, v253
  v_accvgpr_read_b32 v15, a195
  v_mfma_f32_16x16x32_bf16 v[200:203], a[84:87], a[40:43], v[200:203]
  ds_read_b64_tr_b16 a[76:77], v3 offset:39936
  v_cvt_pk_bf16_f32 v31, v254, v255
  buffer_load_dwordx4 v15, s[16:19], s70 offen offset:3072 nt lds
  v_mfma_f32_16x16x32_bf16 v[204:207], a[84:87], v[72:75], v[204:207]
  ds_read_b64_tr_b16 a[78:79], v3 offset:58368
  s_waitcnt lgkmcnt(8)
  v_mfma_f32_16x16x32_bf16 v[176:179], a[88:91], a[44:47], v[176:179]
  ds_read_b64_tr_b16 a[80:81], v8 offset:39936
  v_mfma_f32_16x16x32_bf16 v[248:251], a[128:131], a[104:107], 0
  v_mfma_f32_16x16x32_bf16 v[180:183], a[88:91], v[76:79], v[180:183]
  ds_read_b64_tr_b16 a[82:83], v8 offset:58368
  v_mfma_f32_16x16x32_bf16 v[252:255], a[132:135], a[104:107], 0
  buffer_store_dwordx4 v[28:31], v1, s[36:39], s81 offen sc1
  v_mfma_f32_16x16x32_bf16 v[184:187], a[92:95], a[44:47], v[184:187]
  ds_read_b64_tr_b16 a[84:85], v9 offset:39936
  v_mfma_f32_16x16x32_bf16 v[248:251], a[136:139], a[112:115], v[248:251]
  v_mfma_f32_16x16x32_bf16 v[188:191], a[92:95], v[76:79], v[188:191]
  ds_read_b64_tr_b16 a[86:87], v9 offset:58368
  v_mfma_f32_16x16x32_bf16 v[252:255], a[140:143], a[112:115], v[252:255]
  s_waitcnt lgkmcnt(8)
  v_mfma_f32_16x16x32_bf16 v[192:195], a[96:99], a[44:47], v[192:195]
  ds_read_b64_tr_b16 a[88:89], v2 offset:40960
  v_mfma_f32_16x16x32_bf16 v[248:251], a[144:147], a[120:123], v[248:251]
  v_accvgpr_read_b32 v14, a196
  v_mfma_f32_16x16x32_bf16 v[196:199], a[96:99], v[76:79], v[196:199]
  ds_read_b64_tr_b16 a[90:91], v2 offset:59392
  v_mfma_f32_16x16x32_bf16 v[252:255], a[148:151], a[120:123], v[252:255]
  v_mfma_f32_16x16x32_bf16 v[200:203], a[100:103], a[44:47], v[200:203]
  ds_read_b64_tr_b16 a[92:93], v3 offset:40960
  s_add_u32 m0, s65, 118784
  s_nop 0
  buffer_load_dwordx4 v14, s[16:19], s70 offen nt lds
  v_mfma_f32_16x16x32_bf16 v[204:207], a[100:103], v[76:79], v[204:207]
  ds_read_b64_tr_b16 a[94:95], v3 offset:59392
  s_waitcnt lgkmcnt(8)
  v_mfma_f32_16x16x32_bf16 v[176:179], a[72:75], a[48:51], v[176:179]
  ds_read_b64_tr_b16 a[96:97], v8 offset:40960
  v_mfma_f32_16x16x32_bf16 v[180:183], a[72:75], v[80:83], v[180:183]
  ds_read_b64_tr_b16 a[98:99], v8 offset:59392
  v_cvt_pk_bf16_f32 v248, v248, v249
  v_mfma_f32_16x16x32_bf16 v[184:187], a[76:79], a[48:51], v[184:187]
  ds_read_b64_tr_b16 a[100:101], v9 offset:40960
  v_cvt_pk_bf16_f32 v249, v250, v251
  v_mfma_f32_16x16x32_bf16 v[188:191], a[76:79], v[80:83], v[188:191]
  ds_read_b64_tr_b16 a[102:103], v9 offset:59392
  s_waitcnt lgkmcnt(8)
  v_mfma_f32_16x16x32_bf16 v[192:195], a[80:83], a[48:51], v[192:195]
  ds_read_b64_tr_b16 a[72:73], v2 offset:41984
  v_cvt_pk_bf16_f32 v250, v252, v253
  s_add_u32 s68, s68, 294912
  v_mfma_f32_16x16x32_bf16 v[196:199], a[80:83], v[80:83], v[196:199]
  ds_read_b64_tr_b16 a[74:75], v2 offset:60416
  v_cvt_pk_bf16_f32 v251, v254, v255
  s_add_u32 m0, s65, 0
  v_mfma_f32_16x16x32_bf16 v[200:203], a[84:87], a[48:51], v[200:203]
  ds_read_b64_tr_b16 a[76:77], v3 offset:41984
  buffer_load_dwordx4 v12, s[20:23], s68 offen lds
  v_mfma_f32_16x16x32_bf16 v[204:207], a[84:87], v[80:83], v[204:207]
  ds_read_b64_tr_b16 a[78:79], v3 offset:60416
  buffer_store_dwordx4 v[248:251], v1, s[36:39], s80 offen sc1
  s_waitcnt lgkmcnt(8)
  v_mfma_f32_16x16x32_bf16 v[176:179], a[88:91], a[52:55], v[176:179]
  ds_read_b64_tr_b16 a[80:81], v8 offset:41984
  v_mfma_f32_16x16x32_bf16 v[180:183], a[88:91], v[84:87], v[180:183]
  ds_read_b64_tr_b16 a[82:83], v8 offset:60416
  v_mfma_f32_16x16x32_bf16 v[248:251], a[0:3], a[0:3], 0
  v_mfma_f32_16x16x32_bf16 v[184:187], a[92:95], a[52:55], v[184:187]
  ds_read_b64_tr_b16 a[84:85], v9 offset:41984
  v_mfma_f32_16x16x32_bf16 v[252:255], v[32:35], v[32:35], 0
  buffer_load_dword v7, off, s[32:35], 0 sc1
  v_mfma_f32_16x16x32_bf16 v[188:191], a[92:95], v[84:87], v[188:191]
  ds_read_b64_tr_b16 a[86:87], v9 offset:60416
  v_mfma_f32_16x16x32_bf16 v[248:251], a[4:7], a[4:7], v[248:251]
  s_add_u32 s68, s68, 293888
  s_waitcnt lgkmcnt(8)
  v_mfma_f32_16x16x32_bf16 v[192:195], a[96:99], a[52:55], v[192:195]
  ds_read_b64_tr_b16 a[88:89], v2 offset:43008
  v_mfma_f32_16x16x32_bf16 v[252:255], v[36:39], v[36:39], v[252:255]
  buffer_load_dwordx4 v12, s[20:23], s68 offen offset:1024 lds
  v_mfma_f32_16x16x32_bf16 v[196:199], a[96:99], v[84:87], v[196:199]
  ds_read_b64_tr_b16 a[90:91], v2 offset:61440
  v_mfma_f32_16x16x32_bf16 v[248:251], a[8:11], a[8:11], v[248:251]
  v_mfma_f32_16x16x32_bf16 v[200:203], a[100:103], a[52:55], v[200:203]
  ds_read_b64_tr_b16 a[92:93], v3 offset:43008
  v_mfma_f32_16x16x32_bf16 v[252:255], v[40:43], v[40:43], v[252:255]
  v_mfma_f32_16x16x32_bf16 v[204:207], a[100:103], v[84:87], v[204:207]
  ds_read_b64_tr_b16 a[94:95], v3 offset:61440
  v_mfma_f32_16x16x32_bf16 v[248:251], a[12:15], a[12:15], v[248:251]
  s_add_u32 s68, s68, 293888
  s_waitcnt lgkmcnt(8)
  v_mfma_f32_16x16x32_bf16 v[176:179], a[72:75], a[56:59], v[176:179]
  ds_read_b64_tr_b16 a[96:97], v8 offset:43008
  v_mfma_f32_16x16x32_bf16 v[252:255], v[44:47], v[44:47], v[252:255]
  buffer_load_dwordx4 v12, s[20:23], s68 offen offset:2048 lds
  v_mfma_f32_16x16x32_bf16 v[180:183], a[72:75], v[88:91], v[180:183]
  ds_read_b64_tr_b16 a[98:99], v8 offset:61440
  v_mfma_f32_16x16x32_bf16 v[248:251], a[16:19], a[16:19], v[248:251]
  v_mfma_f32_16x16x32_bf16 v[184:187], a[76:79], a[56:59], v[184:187]
  ds_read_b64_tr_b16 a[100:101], v9 offset:43008
  v_mfma_f32_16x16x32_bf16 v[252:255], v[48:51], v[48:51], v[252:255]
  v_mfma_f32_16x16x32_bf16 v[188:191], a[76:79], v[88:91], v[188:191]
  ds_read_b64_tr_b16 a[102:103], v9 offset:61440
  v_mfma_f32_16x16x32_bf16 v[248:251], a[20:23], a[20:23], v[248:251]
  s_add_u32 s68, s68, 293888
  s_waitcnt lgkmcnt(8)
  v_mfma_f32_16x16x32_bf16 v[192:195], a[80:83], a[56:59], v[192:195]
  ds_read_b64_tr_b16 a[72:73], v2 offset:44032
  v_mfma_f32_16x16x32_bf16 v[252:255], v[52:55], v[52:55], v[252:255]
  buffer_load_dwordx4 v12, s[20:23], s68 offen offset:3072 lds
  v_mfma_f32_16x16x32_bf16 v[196:199], a[80:83], v[88:91], v[196:199]
  ds_read_b64_tr_b16 a[74:75], v2 offset:62464
  v_mfma_f32_16x16x32_bf16 v[248:251], a[24:27], a[24:27], v[248:251]
  v_mfma_f32_16x16x32_bf16 v[200:203], a[84:87], a[56:59], v[200:203]
  ds_read_b64_tr_b16 a[76:77], v3 offset:44032
  v_mfma_f32_16x16x32_bf16 v[252:255], v[56:59], v[56:59], v[252:255]
  s_add_u32 s68, s68, 297984
  v_mfma_f32_16x16x32_bf16 v[204:207], a[84:87], v[88:91], v[204:207]
  ds_read_b64_tr_b16 a[78:79], v3 offset:62464
  v_mfma_f32_16x16x32_bf16 v[248:251], a[28:31], a[28:31], v[248:251]
  s_add_u32 m0, s65, 4096
  s_waitcnt lgkmcnt(8)
  v_mfma_f32_16x16x32_bf16 v[176:179], a[88:91], a[60:63], v[176:179]
  ds_read_b64_tr_b16 a[80:81], v8 offset:44032
  v_mfma_f32_16x16x32_bf16 v[252:255], v[60:63], v[60:63], v[252:255]
  buffer_load_dwordx4 v12, s[20:23], s68 offen lds
  v_mfma_f32_16x16x32_bf16 v[180:183], a[88:91], v[92:95], v[180:183]
  ds_read_b64_tr_b16 a[82:83], v8 offset:62464
  v_mfma_f32_16x16x32_bf16 v[248:251], a[32:35], a[32:35], v[248:251]
  v_mfma_f32_16x16x32_bf16 v[184:187], a[92:95], a[60:63], v[184:187]
  ds_read_b64_tr_b16 a[84:85], v9 offset:44032
  v_mfma_f32_16x16x32_bf16 v[252:255], v[64:67], v[64:67], v[252:255]
  v_mfma_f32_16x16x32_bf16 v[188:191], a[92:95], v[92:95], v[188:191]
  ds_read_b64_tr_b16 a[86:87], v9 offset:62464
  v_mfma_f32_16x16x32_bf16 v[248:251], a[36:39], a[36:39], v[248:251]
  s_add_u32 s68, s68, 293888
  s_waitcnt lgkmcnt(8)
  v_mfma_f32_16x16x32_bf16 v[192:195], a[96:99], a[60:63], v[192:195]
  ds_read_b64_tr_b16 a[88:89], v2 offset:45056
  v_mfma_f32_16x16x32_bf16 v[252:255], v[68:71], v[68:71], v[252:255]
  buffer_load_dwordx4 v12, s[20:23], s68 offen offset:1024 lds
  v_mfma_f32_16x16x32_bf16 v[196:199], a[96:99], v[92:95], v[196:199]
  ds_read_b64_tr_b16 a[90:91], v2 offset:63488
  v_mfma_f32_16x16x32_bf16 v[248:251], a[40:43], a[40:43], v[248:251]
  v_mfma_f32_16x16x32_bf16 v[200:203], a[100:103], a[60:63], v[200:203]
  ds_read_b64_tr_b16 a[92:93], v3 offset:45056
  v_mfma_f32_16x16x32_bf16 v[252:255], v[72:75], v[72:75], v[252:255]
  v_mfma_f32_16x16x32_bf16 v[204:207], a[100:103], v[92:95], v[204:207]
  ds_read_b64_tr_b16 a[94:95], v3 offset:63488
  v_mfma_f32_16x16x32_bf16 v[248:251], a[44:47], a[44:47], v[248:251]
  s_add_u32 s68, s68, 293888
  s_waitcnt lgkmcnt(8)
  v_mfma_f32_16x16x32_bf16 v[176:179], a[72:75], a[64:67], v[176:179]
  ds_read_b64_tr_b16 a[96:97], v8 offset:45056
  v_mfma_f32_16x16x32_bf16 v[252:255], v[76:79], v[76:79], v[252:255]
  buffer_load_dwordx4 v12, s[20:23], s68 offen offset:2048 lds
  v_mfma_f32_16x16x32_bf16 v[180:183], a[72:75], v[96:99], v[180:183]
  ds_read_b64_tr_b16 a[98:99], v8 offset:63488
  v_mfma_f32_16x16x32_bf16 v[248:251], a[48:51], a[48:51], v[248:251]
  v_mfma_f32_16x16x32_bf16 v[184:187], a[76:79], a[64:67], v[184:187]
  ds_read_b64_tr_b16 a[100:101], v9 offset:45056
  v_mfma_f32_16x16x32_bf16 v[252:255], v[80:83], v[80:83], v[252:255]
L_pg1:
  s_cbranch_execz L_pg5
  v_mfma_f32_16x16x32_bf16 v[188:191], a[76:79], v[96:99], v[188:191]
  ds_read_b64_tr_b16 a[102:103], v9 offset:63488
  v_add_u32 v2, 73728, v2
  v_mfma_f32_16x16x32_bf16 v[248:251], a[52:55], a[52:55], v[248:251]
  s_add_u32 s68, s68, 293888
  s_waitcnt lgkmcnt(8)
  v_mfma_f32_16x16x32_bf16 v[192:195], a[80:83], a[64:67], v[192:195]
  s_barrier
  ds_read_b64_tr_b16 a[72:73], v2
  v_mfma_f32_16x16x32_bf16 v[252:255], v[84:87], v[84:87], v[252:255]
  buffer_load_dwordx4 v12, s[20:23], s68 offen offset:3072 lds
  v_mfma_f32_16x16x32_bf16 v[196:199], a[80:83], v[96:99], v[196:199]
  ds_read_b64_tr_b16 a[74:75], v2 offset:18432
  v_add_u32 v3, 73728, v3
  v_mfma_f32_16x16x32_bf16 v[248:251], a[56:59], a[56:59], v[248:251]
  v_mfma_f32_16x16x32_bf16 v[200:203], a[84:87], a[64:67], v[200:203]
  ds_read_b64_tr_b16 a[76:77], v3
  v_mfma_f32_16x16x32_bf16 v[252:255], v[88:91], v[88:91], v[252:255]
  s_add_u32 s68, s68, 297984
  v_mfma_f32_16x16x32_bf16 v[204:207], a[84:87], v[96:99], v[204:207]
  ds_read_b64_tr_b16 a[78:79], v3 offset:18432
  v_add_u32 v8, 73728, v8
  v_mfma_f32_16x16x32_bf16 v[248:251], a[60:63], a[60:63], v[248:251]
  s_waitcnt lgkmcnt(8)
  v_mfma_f32_16x16x32_bf16 v[176:179], a[88:91], a[68:71], v[176:179]
  ds_read_b64_tr_b16 a[80:81], v8
  v_mfma_f32_16x16x32_bf16 v[252:255], v[92:95], v[92:95], v[252:255]
  s_add_u32 m0, s65, 8192
  s_nop 0
  buffer_load_dwordx4 v12, s[20:23], s68 offen lds
  v_mfma_f32_16x16x32_bf16 v[180:183], a[88:91], v[100:103], v[180:183]
  ds_read_b64_tr_b16 a[82:83], v8 offset:18432
  v_add_u32 v9, 73728, v9
  v_mfma_f32_16x16x32_bf16 v[248:251], a[64:67], a[64:67], v[248:251]
  v_mfma_f32_16x16x32_bf16 v[184:187], a[92:95], a[68:71], v[184:187]
  ds_read_b64_tr_b16 a[84:85], v9
  v_mfma_f32_16x16x32_bf16 v[252:255], v[96:99], v[96:99], v[252:255]
  v_mfma_f32_16x16x32_bf16 v[188:191], a[92:95], v[100:103], v[188:191]
  ds_read_b64_tr_b16 a[86:87], v9 offset:18432
  v_mfma_f32_16x16x32_bf16 v[248:251], a[68:71], a[68:71], v[248:251]
  s_waitcnt lgkmcnt(8)
  v_mfma_f32_16x16x32_bf16 v[192:195], a[96:99], a[68:71], v[192:195]
  ds_read_b64_tr_b16 a[88:89], v2 offset:1024
  v_mfma_f32_16x16x32_bf16 v[252:255], v[100:103], v[100:103], v[252:255]
  v_mfma_f32_16x16x32_bf16 v[196:199], a[96:99], v[100:103], v[196:199]
  ds_read_b64_tr_b16 a[90:91], v2 offset:19456
  s_sub_u32 s68, s68, 5013376
  s_add_u32 m0, s65, 36864
  s_nop 0
  buffer_load_dwordx4 v12, s[20:23], s68 offen lds
  v_mfma_f32_16x16x32_bf16 v[200:203], a[100:103], a[68:71], v[200:203]
  ds_read_b64_tr_b16 a[92:93], v3 offset:1024
  v_mfma_f32_16x16x32_bf16 v[204:207], a[100:103], v[100:103], v[204:207]
  ds_read_b64_tr_b16 a[94:95], v3 offset:19456
  s_waitcnt lgkmcnt(8)
  v_mfma_f32_16x16x32_bf16 v[208:211], a[72:75], a[0:3], 0
  ds_read_b64_tr_b16 a[96:97], v8 offset:1024
  v_mov_b32 v16, 1.0
  s_add_u32 s68, s68, 293888
  v_mfma_f32_16x16x32_bf16 v[212:215], a[72:75], v[32:35], 0
  ds_read_b64_tr_b16 a[98:99], v8 offset:19456
  v_cndmask_b32 v28, 0, v248, s[72:73]
  buffer_load_dwordx4 v12, s[20:23], s68 offen offset:1024 lds
  v_mfma_f32_16x16x32_bf16 v[216:219], a[76:79], a[0:3], 0
  ds_read_b64_tr_b16 a[100:101], v9 offset:1024
  v_cndmask_b32 v28, v28, v249, s[74:75]
  v_mfma_f32_16x16x32_bf16 v[220:223], a[76:79], v[32:35], 0
  ds_read_b64_tr_b16 a[102:103], v9 offset:19456
  s_waitcnt lgkmcnt(8)
  v_mfma_f32_16x16x32_bf16 v[224:227], a[80:83], a[0:3], 0
  ds_read_b64_tr_b16 a[72:73], v2 offset:2048
  v_cndmask_b32 v28, v28, v250, s[76:77]
  s_add_u32 s68, s68, 293888
  v_mfma_f32_16x16x32_bf16 v[228:231], a[80:83], v[32:35], 0
  ds_read_b64_tr_b16 a[74:75], v2 offset:20480
  v_cndmask_b32 v28, v28, v251, s[78:79]
  buffer_load_dwordx4 v12, s[20:23], s68 offen offset:2048 lds
  v_mfma_f32_16x16x32_bf16 v[232:235], a[84:87], a[0:3], 0
  ds_read_b64_tr_b16 a[76:77], v3 offset:2048
  v_cndmask_b32 v29, 0, v252, s[72:73]
  v_mfma_f32_16x16x32_bf16 v[236:239], a[84:87], v[32:35], 0
  ds_read_b64_tr_b16 a[78:79], v3 offset:20480
  s_waitcnt lgkmcnt(8)
  v_mfma_f32_16x16x32_bf16 v[208:211], a[88:91], a[4:7], v[208:211]
  ds_read_b64_tr_b16 a[80:81], v8 offset:2048
  v_cndmask_b32 v29, v29, v253, s[74:75]
  s_add_u32 s68, s68, 293888
  v_mfma_f32_16x16x32_bf16 v[212:215], a[88:91], v[36:39], v[212:215]
  ds_read_b64_tr_b16 a[82:83], v8 offset:20480
  v_cndmask_b32 v29, v29, v254, s[76:77]
  buffer_load_dwordx4 v12, s[20:23], s68 offen offset:3072 lds
  v_mfma_f32_16x16x32_bf16 v[216:219], a[92:95], a[4:7], v[216:219]
  ds_read_b64_tr_b16 a[84:85], v9 offset:2048
  v_cndmask_b32 v29, v29, v255, s[78:79]
  v_mfma_f32_16x16x32_bf16 v[220:223], a[92:95], v[36:39], v[220:223]
  ds_read_b64_tr_b16 a[86:87], v9 offset:20480
  v_mfma_f32_16x16x4_f32 v[248:251], v16, v28, 0
  s_waitcnt lgkmcnt(8)
  v_mfma_f32_16x16x32_bf16 v[224:227], a[96:99], a[4:7], v[224:227]
  ds_read_b64_tr_b16 a[88:89], v2 offset:3072
  v_mfma_f32_16x16x4_f32 v[252:255], v16, v29, 0
  s_add_u32 s68, s68, 297984
  s_add_u32 m0, s65, 40960
  v_mfma_f32_16x16x32_bf16 v[228:231], a[96:99], v[36:39], v[228:231]
  ds_read_b64_tr_b16 a[90:91], v2 offset:21504
  s_waitcnt vmcnt(12)
  v_cmp_eq_u32 vcc, 0, v7
  s_cbranch_vccz L_ok1
  s_mov_b32 s83, 0x8000
L_spin1:
  buffer_load_dword v7, off, s[32:35], 0 sc1
  s_waitcnt vmcnt(0)
  v_cmp_eq_u32 vcc, 0, v7
  s_cbranch_vccz L_ok1
  s_sub_u32 s83, s83, 1
  s_cbranch_scc0 L_spin1
  buffer_store_dword v1, off, s[32:35], 0 offset:16 sc1
  s_waitcnt vmcnt(0)
L_ok1:
  s_add_u32 m0, s65, 40960
  s_nop 0
  buffer_load_dwordx4 v12, s[20:23], s68 offen lds
  v_mfma_f32_16x16x32_bf16 v[232:235], a[100:103], a[4:7], v[232:235]
  ds_read_b64_tr_b16 a[92:93], v3 offset:3072
  v_cvt_pk_bf16_f32 v104, v176, v177
  v_mfma_f32_16x16x32_bf16 v[236:239], a[100:103], v[36:39], v[236:239]
  ds_read_b64_tr_b16 a[94:95], v3 offset:21504
  s_waitcnt lgkmcnt(8)
  v_mfma_f32_16x16x32_bf16 v[208:211], a[72:75], a[8:11], v[208:211]
  ds_read_b64_tr_b16 a[96:97], v8 offset:3072
  v_mov_b32 v16, 0x3727c5ac
  s_add_u32 s68, s68, 293888
  v_mfma_f32_16x16x32_bf16 v[212:215], a[72:75], v[40:43], v[212:215]
  ds_read_b64_tr_b16 a[98:99], v8 offset:21504
  v_and_b32 v30, 15, v0
  buffer_load_dwordx4 v12, s[20:23], s68 offen offset:1024 lds
  v_mfma_f32_16x16x32_bf16 v[216:219], a[76:79], a[8:11], v[216:219]
  ds_read_b64_tr_b16 a[100:101], v9 offset:3072
  s_lshl_b32 s40, s64, 7
  v_mfma_f32_16x16x32_bf16 v[220:223], a[76:79], v[40:43], v[220:223]
  ds_read_b64_tr_b16 a[102:103], v9 offset:21504
  s_lshl2_add_u32 s94, s60, s64
  s_lshl_b32 s94, s94, 2
  s_lshl_b32 s95, s63, 8
  s_waitcnt lgkmcnt(8)
  v_mfma_f32_16x16x32_bf16 v[224:227], a[80:83], a[8:11], v[224:227]
  ds_read_b64_tr_b16 a[72:73], v2 offset:4096
  s_add_u32 s40, s40, 163328
  s_add_u32 s95, s95, 4096
  s_add_u32 s94, s94, s95
  v_mfma_f32_16x16x32_bf16 v[228:231], a[80:83], v[40:43], v[228:231]
  ds_read_b64_tr_b16 a[74:75], v2 offset:22528
  v_lshl_add_u32 v30, v30, 2, s40
  buffer_store_dword v7, v27, s[36:39], s94 offen sc1
  v_mfma_f32_16x16x32_bf16 v[232:235], a[84:87], a[8:11], v[232:235]
  ds_read_b64_tr_b16 a[76:77], v3 offset:4096
  v_fmamk_f32 v5, v248, 0x3ae38e39, v16
  s_add_u32 s68, s68, 293888
  v_mfma_f32_16x16x32_bf16 v[236:239], a[84:87], v[40:43], v[236:239]
  ds_read_b64_tr_b16 a[78:79], v3 offset:22528
  buffer_load_dwordx4 v12, s[20:23], s68 offen offset:2048 lds
  s_waitcnt lgkmcnt(8)
  v_mfma_f32_16x16x32_bf16 v[208:211], a[88:91], a[12:15], v[208:211]
  ds_read_b64_tr_b16 a[80:81], v8 offset:4096
  v_rsq_f32 v5, v5
  v_mfma_f32_16x16x32_bf16 v[212:215], a[88:91], v[44:47], v[212:215]
  ds_read_b64_tr_b16 a[82:83], v8 offset:22528
  v_fmamk_f32 v6, v252, 0x3ae38e39, v16
  v_mfma_f32_16x16x32_bf16 v[216:219], a[92:95], a[12:15], v[216:219]
  ds_read_b64_tr_b16 a[84:85], v9 offset:4096
  v_rsq_f32 v6, v6
  s_add_u32 s68, s68, 293888
  v_mfma_f32_16x16x32_bf16 v[220:223], a[92:95], v[44:47], v[220:223]
  ds_read_b64_tr_b16 a[86:87], v9 offset:22528
  buffer_load_dwordx4 v12, s[20:23], s68 offen offset:3072 lds
  s_waitcnt lgkmcnt(8)
  v_mfma_f32_16x16x32_bf16 v[224:227], a[96:99], a[12:15], v[224:227]
  ds_read_b64_tr_b16 a[88:89], v2 offset:5120
  ds_write_b32 v30, v5
  v_mfma_f32_16x16x32_bf16 v[228:231], a[96:99], v[44:47], v[228:231]
  ds_read_b64_tr_b16 a[90:91], v2 offset:23552
  ds_write_b32 v30, v6 offset:64
  s_add_u32 s68, s68, 297984
  v_mfma_f32_16x16x32_bf16 v[232:235], a[100:103], a[12:15], v[232:235]
  ds_read_b64_tr_b16 a[92:93], v3 offset:5120
  v_lshlrev_b32 v16, 2, v0
  s_add_u32 m0, s65, 45056
  v_mfma_f32_16x16x32_bf16 v[236:239], a[100:103], v[44:47], v[236:239]
  ds_read_b64_tr_b16 a[94:95], v3 offset:23552
  buffer_load_dwordx4 v12, s[20:23], s68 offen lds
  s_waitcnt lgkmcnt(10)
  v_mfma_f32_16x16x32_bf16 v[208:211], a[72:75], a[16:19], v[208:211]
  ds_read_b64_tr_b16 a[96:97], v8 offset:5120
  ds_read_b64_tr_b16 a[152:153], v17
  v_mfma_f32_16x16x32_bf16 v[212:215], a[72:75], v[48:51], v[212:215]
  ds_read_b64_tr_b16 a[98:99], v8 offset:23552
  ds_read_b64_tr_b16 a[154:155], v17 offset:4608
  v_mfma_f32_16x16x32_bf16 v[216:219], a[76:79], a[16:19], v[216:219]
  ds_read_b64_tr_b16 a[100:101], v9 offset:5120
  ds_read_b64_tr_b16 a[156:157], v17 offset:64
  v_mfma_f32_16x16x32_bf16 v[220:223], a[76:79], v[48:51], v[220:223]
  ds_read_b64_tr_b16 a[102:103], v9 offset:23552
  s_waitcnt lgkmcnt(13)
  v_mfma_f32_16x16x32_bf16 v[224:227], a[80:83], a[16:19], v[224:227]
  ds_read_b64_tr_b16 a[72:73], v2 offset:6144
  ds_read_b64_tr_b16 a[158:159], v17 offset:4672
  v_mfma_f32_16x16x32_bf16 v[228:231], a[80:83], v[48:51], v[228:231]
  ds_read_b64_tr_b16 a[74:75], v2 offset:24576
  ds_read_b64_tr_b16 a[160:161], v17 offset:128
  s_waitcnt lgkmcnt(7)
  buffer_store_dwordx4 a[152:155], v1, s[36:39], s71 offen sc1
  v_mfma_f32_16x16x32_bf16 v[232:235], a[84:87], a[16:19], v[232:235]
  ds_read_b64_tr_b16 a[76:77], v3 offset:6144
  ds_read_b64_tr_b16 a[162:163], v17 offset:4736
  v_mfma_f32_16x16x32_bf16 v[236:239], a[84:87], v[48:51], v[236:239]
  ds_read_b64_tr_b16 a[78:79], v3 offset:24576
  v_mfma_f32_16x16x32_bf16 v[208:211], a[88:91], a[20:23], v[208:211]
  ds_read_b64_tr_b16 a[80:81], v8 offset:6144
  ds_read_b64_tr_b16 a[164:165], v17 offset:192
  v_mfma_f32_16x16x32_bf16 v[212:215], a[88:91], v[52:55], v[212:215]
  ds_read_b64_tr_b16 a[82:83], v8 offset:24576
  ds_read_b64_tr_b16 a[166:167], v17 offset:4800
  v_mfma_f32_16x16x32_bf16 v[216:219], a[92:95], a[20:23], v[216:219]
  ds_read_b64_tr_b16 a[84:85], v9 offset:6144
  ds_read_b64_tr_b16 a[168:169], v17 offset:8
  v_mfma_f32_16x16x32_bf16 v[220:223], a[92:95], v[52:55], v[220:223]
  ds_read_b64_tr_b16 a[86:87], v9 offset:24576
  s_waitcnt lgkmcnt(14)
  v_mfma_f32_16x16x32_bf16 v[224:227], a[96:99], a[20:23], v[224:227]
  ds_read_b64_tr_b16 a[88:89], v2 offset:7168
  ds_read_b64_tr_b16 a[170:171], v17 offset:4616
  v_mfma_f32_16x16x32_bf16 v[228:231], a[96:99], v[52:55], v[228:231]
  ds_read_b64_tr_b16 a[90:91], v2 offset:25600
  ds_read_b64_tr_b16 a[172:173], v17 offset:72
  s_add_u32 s71, s71, s99
  v_mfma_f32_16x16x32_bf16 v[232:235], a[100:103], a[20:23], v[232:235]
  ds_read_b64_tr_b16 a[92:93], v3 offset:7168
  ds_read_b64_tr_b16 a[174:175], v17 offset:4680
  s_waitcnt lgkmcnt(14)
  buffer_store_dwordx4 a[156:159], v1, s[36:39], s71 offen sc1
  v_mfma_f32_16x16x32_bf16 v[236:239], a[100:103], v[52:55], v[236:239]
  ds_read_b64_tr_b16 a[94:95], v3 offset:25600
  s_waitcnt lgkmcnt(14)
  v_mfma_f32_16x16x32_bf16 v[208:211], a[72:75], a[24:27], v[208:211]
  ds_read_b64_tr_b16 a[96:97], v8 offset:7168
  ds_read_b64_tr_b16 a[176:177], v17 offset:136
  v_mfma_f32_16x16x32_bf16 v[212:215], a[72:75], v[56:59], v[212:215]
  ds_read_b64_tr_b16 a[98:99], v8 offset:25600
  ds_read_b64_tr_b16 a[178:179], v17 offset:4744
  v_mfma_f32_16x16x32_bf16 v[216:219], a[76:79], a[24:27], v[216:219]
  ds_read_b64_tr_b16 a[100:101], v9 offset:7168
  ds_read_b64_tr_b16 a[180:181], v17 offset:200
  v_mfma_f32_16x16x32_bf16 v[220:223], a[76:79], v[56:59], v[220:223]
  ds_read_b64_tr_b16 a[102:103], v9 offset:25600
  s_waitcnt lgkmcnt(14)
  v_mfma_f32_16x16x32_bf16 v[224:227], a[80:83], a[24:27], v[224:227]
  ds_read_b64_tr_b16 a[72:73], v2 offset:8192
  ds_read_b64_tr_b16 a[182:183], v17 offset:4808
  v_mfma_f32_16x16x32_bf16 v[228:231], a[80:83], v[56:59], v[228:231]
  ds_read_b64_tr_b16 a[74:75], v2 offset:26624
  ds_read_b64_tr_b16 a[184:185], v18
  v_mfma_f32_16x16x32_bf16 v[232:235], a[84:87], a[24:27], v[232:235]
  ds_read_b64_tr_b16 a[76:77], v3 offset:8192
  ds_read_b64_tr_b16 a[186:187], v18 offset:4608
  v_mfma_f32_16x16x32_bf16 v[236:239], a[84:87], v[56:59], v[236:239]
  ds_read_b64_tr_b16 a[78:79], v3 offset:26624
  s_waitcnt lgkmcnt(14)
  v_mfma_f32_16x16x32_bf16 v[208:211], a[88:91], a[28:31], v[208:211]
  ds_read_b64_tr_b16 a[80:81], v8 offset:8192
  v_cvt_pk_bf16_f32 v105, v178, v179
  v_mfma_f32_16x16x32_bf16 v[212:215], a[88:91], v[60:63], v[212:215]
  ds_read_b64_tr_b16 a[82:83], v8 offset:26624
  v_cvt_pk_bf16_f32 v106, v184, v185
  v_mfma_f32_16x16x32_bf16 v[216:219], a[92:95], a[28:31], v[216:219]
  ds_read_b64_tr_b16 a[84:85], v9 offset:8192
  v_cvt_pk_bf16_f32 v107, v186, v187
  v_mfma_f32_16x16x32_bf16 v[220:223], a[92:95], v[60:63], v[220:223]
  ds_read_b64_tr_b16 a[86:87], v9 offset:26624
  v_subrev_u32 v2, 73728, v2
  s_waitcnt lgkmcnt(11)
  v_mfma_f32_16x16x32_bf16 v[224:227], a[96:99], a[28:31], v[224:227]
  s_waitcnt vmcnt(12)
  s_barrier
  ds_read_b64_tr_b16 a[88:89], v2
  s_add_u32 s68, s68, 294912
  v_mfma_f32_16x16x32_bf16 v[228:231], a[96:99], v[60:63], v[228:231]
  ds_read_b64_tr_b16 a[90:91], v2 offset:18432
  v_subrev_u32 v3, 73728, v3
  s_add_u32 m0, s65, 73728
  v_mfma_f32_16x16x32_bf16 v[232:235], a[100:103], a[28:31], v[232:235]
  ds_read_b64_tr_b16 a[92:93], v3
  v_pk_max_i16 v104, v104, 0
  buffer_load_dwordx4 v12, s[20:23], s68 offen lds
  v_mfma_f32_16x16x32_bf16 v[236:239], a[100:103], v[60:63], v[236:239]
  ds_read_b64_tr_b16 a[94:95], v3 offset:18432
  v_subrev_u32 v8, 73728, v8
  s_waitcnt lgkmcnt(8)
  v_mfma_f32_16x16x32_bf16 v[208:211], a[72:75], a[32:35], v[208:211]
  ds_read_b64_tr_b16 a[96:97], v8
  v_pk_max_i16 v105, v105, 0
  v_mfma_f32_16x16x32_bf16 v[212:215], a[72:75], v[64:67], v[212:215]
  ds_read_b64_tr_b16 a[98:99], v8 offset:18432
  v_subrev_u32 v9, 73728, v9
  s_add_u32 s71, s71, s99
  v_mfma_f32_16x16x32_bf16 v[216:219], a[76:79], a[32:35], v[216:219]
  ds_read_b64_tr_b16 a[100:101], v9
  v_pk_max_i16 v106, v106, 0
  buffer_store_dwordx4 a[160:163], v1, s[36:39], s71 offen sc1
  v_mfma_f32_16x16x32_bf16 v[220:223], a[76:79], v[64:67], v[220:223]
  ds_read_b64_tr_b16 a[102:103], v9 offset:18432
  s_waitcnt lgkmcnt(8)
  v_mfma_f32_16x16x32_bf16 v[224:227], a[80:83], a[32:35], v[224:227]
  ds_read_b64_tr_b16 a[72:73], v2 offset:1024
  v_pk_max_i16 v107, v107, 0
  v_mfma_f32_16x16x32_bf16 v[228:231], a[80:83], v[64:67], v[228:231]
  ds_read_b64_tr_b16 a[74:75], v2 offset:19456
  v_cvt_pk_bf16_f32 v108, v180, v181
  v_mfma_f32_16x16x32_bf16 v[232:235], a[84:87], a[32:35], v[232:235]
  ds_read_b64_tr_b16 a[76:77], v3 offset:1024
  v_cvt_pk_bf16_f32 v109, v182, v183
  buffer_store_dwordx4 v[104:107], v1, s[36:39], s82 offen sc1
  v_mfma_f32_16x16x32_bf16 v[236:239], a[84:87], v[64:67], v[236:239]
  ds_read_b64_tr_b16 a[78:79], v3 offset:19456
  s_waitcnt lgkmcnt(8)
  v_mfma_f32_16x16x32_bf16 v[208:211], a[88:91], a[36:39], v[208:211]
  ds_read_b64_tr_b16 a[80:81], v8 offset:1024
  v_cvt_pk_bf16_f32 v110, v188, v189
  v_mfma_f32_16x16x32_bf16 v[212:215], a[88:91], v[68:71], v[212:215]
  ds_read_b64_tr_b16 a[82:83], v8 offset:19456
  v_cvt_pk_bf16_f32 v111, v190, v191
  s_add_u32 s68, s68, 293888
  v_mfma_f32_16x16x32_bf16 v[216:219], a[92:95], a[36:39], v[216:219]
  ds_read_b64_tr_b16 a[84:85], v9 offset:1024
  v_pk_max_i16 v108, v108, 0
  buffer_load_dwordx4 v12, s[20:23], s68 offen offset:1024 lds
  v_mfma_f32_16x16x32_bf16 v[220:223], a[92:95], v[68:71], v[220:223]
  ds_read_b64_tr_b16 a[86:87], v9 offset:19456
  s_waitcnt lgkmcnt(8)
  v_mfma_f32_16x16x32_bf16 v[224:227], a[96:99], a[36:39], v[224:227]
  ds_read_b64_tr_b16 a[88:89], v2 offset:2048
  v_pk_max_i16 v109, v109, 0
  v_mfma_f32_16x16x32_bf16 v[228:231], a[96:99], v[68:71], v[228:231]
  ds_read_b64_tr_b16 a[90:91], v2 offset:20480
  v_pk_max_i16 v110, v110, 0
  s_add_u32 s68, s68, 293888
  v_mfma_f32_16x16x32_bf16 v[232:235], a[100:103], a[36:39], v[232:235]
  ds_read_b64_tr_b16 a[92:93], v3 offset:2048
  v_pk_max_i16 v111, v111, 0
  buffer_load_dwordx4 v12, s[20:23], s68 offen offset:2048 lds
  v_mfma_f32_16x16x32_bf16 v[236:239], a[100:103], v[68:71], v[236:239]
  ds_read_b64_tr_b16 a[94:95], v3 offset:20480
  s_waitcnt lgkmcnt(8)
  v_mfma_f32_16x16x32_bf16 v[208:211], a[72:75], a[40:43], v[208:211]
  ds_read_b64_tr_b16 a[96:97], v8 offset:2048
  v_cvt_pk_bf16_f32 v112, v192, v193
  v_mfma_f32_16x16x32_bf16 v[212:215], a[72:75], v[72:75], v[212:215]
  ds_read_b64_tr_b16 a[98:99], v8 offset:20480
  v_cvt_pk_bf16_f32 v113, v194, v195
  v_mfma_f32_16x16x32_bf16 v[216:219], a[76:79], a[40:43], v[216:219]
  ds_read_b64_tr_b16 a[100:101], v9 offset:2048
  v_cvt_pk_bf16_f32 v114, v200, v201
  buffer_store_dwordx4 v[108:111], v1, s[36:39], s82 offen offset:1024 sc1
  v_mfma_f32_16x16x32_bf16 v[220:223], a[76:79], v[72:75], v[220:223]
  ds_read_b64_tr_b16 a[102:103], v9 offset:20480
  s_waitcnt lgkmcnt(8)
  v_mfma_f32_16x16x32_bf16 v[224:227], a[80:83], a[40:43], v[224:227]
  ds_read_b64_tr_b16 a[72:73], v2 offset:3072
  v_cvt_pk_bf16_f32 v115, v202, v203
  v_mfma_f32_16x16x32_bf16 v[228:231], a[80:83], v[72:75], v[228:231]
  ds_read_b64_tr_b16 a[74:75], v2 offset:21504
  v_pk_max_i16 v112, v112, 0
  s_add_u32 s71, s71, s99
  v_mfma_f32_16x16x32_bf16 v[232:235], a[84:87], a[40:43], v[232:235]
  ds_read_b64_tr_b16 a[76:77], v3 offset:3072
  v_pk_max_i16 v113, v113, 0
  buffer_store_dwordx4 a[164:167], v1, s[36:39], s71 offen sc1
  v_mfma_f32_16x16x32_bf16 v[236:239], a[84:87], v[72:75], v[236:239]
  ds_read_b64_tr_b16 a[78:79], v3 offset:21504
  s_waitcnt lgkmcnt(8)
  v_mfma_f32_16x16x32_bf16 v[208:211], a[88:91], a[44:47], v[208:211]
  ds_read_b64_tr_b16 a[80:81], v8 offset:3072
  v_pk_max_i16 v114, v114, 0
  v_mfma_f32_16x16x32_bf16 v[212:215], a[88:91], v[76:79], v[212:215]
  ds_read_b64_tr_b16 a[82:83], v8 offset:21504
  v_pk_max_i16 v115, v115, 0
  s_add_u32 s82, s82, 2048
  v_mfma_f32_16x16x32_bf16 v[216:219], a[92:95], a[44:47], v[216:219]
  ds_read_b64_tr_b16 a[84:85], v9 offset:3072
  v_cvt_pk_bf16_f32 v116, v196, v197
  buffer_store_dwordx4 v[112:115], v1, s[36:39], s82 offen sc1
  v_mfma_f32_16x16x32_bf16 v[220:223], a[92:95], v[76:79], v[220:223]
  ds_read_b64_tr_b16 a[86:87], v9 offset:21504
  s_waitcnt lgkmcnt(8)
  v_mfma_f32_16x16x32_bf16 v[224:227], a[96:99], a[44:47], v[224:227]
  ds_read_b64_tr_b16 a[88:89], v2 offset:4096
  v_cvt_pk_bf16_f32 v117, v198, v199
  v_mfma_f32_16x16x32_bf16 v[228:231], a[96:99], v[76:79], v[228:231]
  ds_read_b64_tr_b16 a[90:91], v2 offset:22528
  v_cvt_pk_bf16_f32 v118, v204, v205
  s_add_u32 s68, s68, 293888
  v_mfma_f32_16x16x32_bf16 v[232:235], a[100:103], a[44:47], v[232:235]
  ds_read_b64_tr_b16 a[92:93], v3 offset:4096
  v_cvt_pk_bf16_f32 v119, v206, v207
  buffer_load_dwordx4 v12, s[20:23], s68 offen offset:3072 lds
  v_mfma_f32_16x16x32_bf16 v[236:239], a[100:103], v[76:79], v[236:239]
  ds_read_b64_tr_b16 a[94:95], v3 offset:22528
  s_waitcnt lgkmcnt(8)
  v_mfma_f32_16x16x32_bf16 v[208:211], a[72:75], a[48:51], v[208:211]
  ds_read_b64_tr_b16 a[96:97], v8 offset:4096
  v_pk_max_i16 v116, v116, 0
  s_add_u32 s68, s68, 297984
  v_mfma_f32_16x16x32_bf16 v[212:215], a[72:75], v[80:83], v[212:215]
  ds_read_b64_tr_b16 a[98:99], v8 offset:22528
  v_pk_max_i16 v117, v117, 0
  s_add_u32 m0, s65, 77824
  v_mfma_f32_16x16x32_bf16 v[216:219], a[76:79], a[48:51], v[216:219]
  ds_read_b64_tr_b16 a[100:101], v9 offset:4096
  v_pk_max_i16 v118, v118, 0
  buffer_load_dwordx4 v12, s[20:23], s68 offen lds
  v_mfma_f32_16x16x32_bf16 v[220:223], a[76:79], v[80:83], v[220:223]
  ds_read_b64_tr_b16 a[102:103], v9 offset:22528
  s_waitcnt lgkmcnt(8)
  v_mfma_f32_16x16x32_bf16 v[224:227], a[80:83], a[48:51], v[224:227]
  ds_read_b64_tr_b16 a[72:73], v2 offset:5120
  v_pk_max_i16 v119, v119, 0
  v_mfma_f32_16x16x32_bf16 v[228:231], a[80:83], v[80:83], v[228:231]
  ds_read_b64_tr_b16 a[74:75], v2 offset:23552
  v_mfma_f32_16x16x32_bf16 v[232:235], a[84:87], a[48:51], v[232:235]
  ds_read_b64_tr_b16 a[76:77], v3 offset:5120
  buffer_store_dwordx4 v[116:119], v1, s[36:39], s82 offen offset:1024 sc1
  v_mfma_f32_16x16x32_bf16 v[236:239], a[84:87], v[80:83], v[236:239]
  ds_read_b64_tr_b16 a[78:79], v3 offset:23552
  s_waitcnt lgkmcnt(8)
  v_mfma_f32_16x16x32_bf16 v[208:211], a[88:91], a[52:55], v[208:211]
  ds_read_b64_tr_b16 a[80:81], v8 offset:5120
  v_mfma_f32_16x16x32_bf16 v[212:215], a[88:91], v[84:87], v[212:215]
  ds_read_b64_tr_b16 a[82:83], v8 offset:23552
  s_add_u32 s71, s71, s99
  v_mfma_f32_16x16x32_bf16 v[216:219], a[92:95], a[52:55], v[216:219]
  ds_read_b64_tr_b16 a[84:85], v9 offset:5120
  buffer_store_dwordx4 a[168:171], v1, s[36:39], s71 offen sc1
  v_mfma_f32_16x16x32_bf16 v[220:223], a[92:95], v[84:87], v[220:223]
  ds_read_b64_tr_b16 a[86:87], v9 offset:23552
  s_waitcnt lgkmcnt(8)
  v_mfma_f32_16x16x32_bf16 v[224:227], a[96:99], a[52:55], v[224:227]
  ds_read_b64_tr_b16 a[88:89], v2 offset:6144
  v_mfma_f32_16x16x32_bf16 v[228:231], a[96:99], v[84:87], v[228:231]
  ds_read_b64_tr_b16 a[90:91], v2 offset:24576
  s_add_u32 s68, s68, 293888
  v_mfma_f32_16x16x32_bf16 v[232:235], a[100:103], a[52:55], v[232:235]
  ds_read_b64_tr_b16 a[92:93], v3 offset:6144
  buffer_load_dwordx4 v12, s[20:23], s68 offen offset:1024 lds
  v_mfma_f32_16x16x32_bf16 v[236:239], a[100:103], v[84:87], v[236:239]
  ds_read_b64_tr_b16 a[94:95], v3 offset:24576
  s_waitcnt lgkmcnt(8)
  v_mfma_f32_16x16x32_bf16 v[208:211], a[72:75], a[56:59], v[208:211]
  ds_read_b64_tr_b16 a[96:97], v8 offset:6144
  v_mfma_f32_16x16x32_bf16 v[212:215], a[72:75], v[88:91], v[212:215]
  ds_read_b64_tr_b16 a[98:99], v8 offset:24576
  s_add_u32 s68, s68, 293888
  v_mfma_f32_16x16x32_bf16 v[216:219], a[76:79], a[56:59], v[216:219]
  ds_read_b64_tr_b16 a[100:101], v9 offset:6144
  buffer_load_dwordx4 v12, s[20:23], s68 offen offset:2048 lds
  v_mfma_f32_16x16x32_bf16 v[220:223], a[76:79], v[88:91], v[220:223]
  ds_read_b64_tr_b16 a[102:103], v9 offset:24576
  s_waitcnt lgkmcnt(8)
  v_mfma_f32_16x16x32_bf16 v[224:227], a[80:83], a[56:59], v[224:227]
  ds_read_b64_tr_b16 a[72:73], v2 offset:7168
  v_mfma_f32_16x16x32_bf16 v[228:231], a[80:83], v[88:91], v[228:231]
  ds_read_b64_tr_b16 a[74:75], v2 offset:25600
  s_add_u32 s68, s68, 293888
  v_mfma_f32_16x16x32_bf16 v[232:235], a[84:87], a[56:59], v[232:235]
  ds_read_b64_tr_b16 a[76:77], v3 offset:7168
  buffer_load_dwordx4 v12, s[20:23], s68 offen offset:3072 lds
  v_mfma_f32_16x16x32_bf16 v[236:239], a[84:87], v[88:91], v[236:239]
  ds_read_b64_tr_b16 a[78:79], v3 offset:25600
  s_waitcnt lgkmcnt(8)
  v_mfma_f32_16x16x32_bf16 v[208:211], a[88:91], a[60:63], v[208:211]
  ds_read_b64_tr_b16 a[80:81], v8 offset:7168
  s_add_u32 s68, s68, 297984
  v_mfma_f32_16x16x32_bf16 v[212:215], a[88:91], v[92:95], v[212:215]
  ds_read_b64_tr_b16 a[82:83], v8 offset:25600
  s_add_u32 m0, s65, 81920
  v_mfma_f32_16x16x32_bf16 v[216:219], a[92:95], a[60:63], v[216:219]
  ds_read_b64_tr_b16 a[84:85], v9 offset:7168
  buffer_load_dwordx4 v12, s[20:23], s68 offen lds
  v_mfma_f32_16x16x32_bf16 v[220:223], a[92:95], v[92:95], v[220:223]
  ds_read_b64_tr_b16 a[86:87], v9 offset:25600
  s_waitcnt lgkmcnt(8)
  v_mfma_f32_16x16x32_bf16 v[224:227], a[96:99], a[60:63], v[224:227]
  ds_read_b64_tr_b16 a[88:89], v2 offset:8192
  v_mfma_f32_16x16x32_bf16 v[228:231], a[96:99], v[92:95], v[228:231]
  ds_read_b64_tr_b16 a[90:91], v2 offset:26624
  s_add_u32 s71, s71, s99
  v_mfma_f32_16x16x32_bf16 v[232:235], a[100:103], a[60:63], v[232:235]
  ds_read_b64_tr_b16 a[92:93], v3 offset:8192
  buffer_store_dwordx4 a[172:175], v1, s[36:39], s71 offen sc1
  v_mfma_f32_16x16x32_bf16 v[236:239], a[100:103], v[92:95], v[236:239]
  ds_read_b64_tr_b16 a[94:95], v3 offset:26624
  s_waitcnt lgkmcnt(8)
  v_mfma_f32_16x16x32_bf16 v[208:211], a[72:75], a[64:67], v[208:211]
  ds_read_b64_tr_b16 a[96:97], v8 offset:8192
  v_mfma_f32_16x16x32_bf16 v[212:215], a[72:75], v[96:99], v[212:215]
  ds_read_b64_tr_b16 a[98:99], v8 offset:26624
  v_mfma_f32_16x16x32_bf16 v[216:219], a[76:79], a[64:67], v[216:219]
  ds_read_b64_tr_b16 a[100:101], v9 offset:8192
  v_mfma_f32_16x16x32_bf16 v[220:223], a[76:79], v[96:99], v[220:223]
  ds_read_b64_tr_b16 a[102:103], v9 offset:26624
  s_waitcnt lgkmcnt(8)
  v_mfma_f32_16x16x32_bf16 v[224:227], a[80:83], a[64:67], v[224:227]
  s_waitcnt vmcnt(19)
  s_barrier
  ds_read_b64_tr_b16 a[72:73], v2 offset:36864
  v_mfma_f32_16x16x32_bf16 v[228:231], a[80:83], v[96:99], v[228:231]
  ds_read_b64_tr_b16 a[74:75], v2 offset:55296
  v_mfma_f32_16x16x32_bf16 v[232:235], a[84:87], a[64:67], v[232:235]
  ds_read_b64_tr_b16 a[76:77], v3 offset:36864
  v_mfma_f32_16x16x32_bf16 v[236:239], a[84:87], v[96:99], v[236:239]
  ds_read_b64_tr_b16 a[78:79], v3 offset:55296
  s_waitcnt lgkmcnt(8)
  v_mfma_f32_16x16x32_bf16 v[208:211], a[88:91], a[68:71], v[208:211]
  ds_read_b64_tr_b16 a[80:81], v8 offset:36864
  v_mfma_f32_16x16x32_bf16 v[212:215], a[88:91], v[100:103], v[212:215]
  ds_read_b64_tr_b16 a[82:83], v8 offset:55296
  v_mfma_f32_16x16x32_bf16 v[216:219], a[92:95], a[68:71], v[216:219]
  ds_read_b64_tr_b16 a[84:85], v9 offset:36864
  v_mfma_f32_16x16x32_bf16 v[220:223], a[92:95], v[100:103], v[220:223]
  ds_read_b64_tr_b16 a[86:87], v9 offset:55296
  s_waitcnt lgkmcnt(8)
  v_mfma_f32_16x16x32_bf16 v[224:227], a[96:99], a[68:71], v[224:227]
  ds_read_b64_tr_b16 a[88:89], v2 offset:37888
  v_mfma_f32_16x16x32_bf16 v[228:231], a[96:99], v[100:103], v[228:231]
  ds_read_b64_tr_b16 a[90:91], v2 offset:56320
  v_mfma_f32_16x16x32_bf16 v[232:235], a[100:103], a[68:71], v[232:235]
  ds_read_b64_tr_b16 a[92:93], v3 offset:37888
  buffer_load_dword v31, v16, s[36:39], s95 offen sc1
  v_mfma_f32_16x16x32_bf16 v[236:239], a[100:103], v[100:103], v[236:239]
  ds_read_b64_tr_b16 a[94:95], v3 offset:56320
  s_waitcnt lgkmcnt(8)
  v_mfma_f32_16x16x32_bf16 v[176:179], a[72:75], a[0:3], 0
  ds_read_b64_tr_b16 a[96:97], v8 offset:37888
  v_mfma_f32_16x16x32_bf16 v[180:183], a[72:75], v[32:35], 0
  ds_read_b64_tr_b16 a[98:99], v8 offset:56320
  s_add_u32 s71, s71, s99
  v_mfma_f32_16x16x32_bf16 v[184:187], a[76:79], a[0:3], 0
  ds_read_b64_tr_b16 a[100:101], v9 offset:37888
  buffer_store_dwordx4 a[176:179], v1, s[36:39], s71 offen sc1
  v_mfma_f32_16x16x32_bf16 v[188:191], a[76:79], v[32:35], 0
  ds_read_b64_tr_b16 a[102:103], v9 offset:56320
  s_waitcnt lgkmcnt(8)
  v_mfma_f32_16x16x32_bf16 v[192:195], a[80:83], a[0:3], 0
L_pg2:
  s_cbranch_execz L_pg6
  ds_read_b64_tr_b16 a[72:73], v2 offset:38912
  v_cvt_pk_bf16_f32 v120, v208, v209
  v_mfma_f32_16x16x32_bf16 v[196:199], a[80:83], v[32:35], 0
  ds_read_b64_tr_b16 a[74:75], v2 offset:57344
  v_mfma_f32_16x16x32_bf16 v[200:203], a[84:87], a[0:3], 0
  ds_read_b64_tr_b16 a[76:77], v3 offset:38912
  v_cvt_pk_bf16_f32 v121, v210, v211
  v_mfma_f32_16x16x32_bf16 v[204:207], a[84:87], v[32:35], 0
  ds_read_b64_tr_b16 a[78:79], v3 offset:57344
  s_waitcnt lgkmcnt(8)
  v_mfma_f32_16x16x32_bf16 v[176:179], a[88:91], a[4:7], v[176:179]
  ds_read_b64_tr_b16 a[80:81], v8 offset:38912
  v_mfma_f32_16x16x32_bf16 v[180:183], a[88:91], v[36:39], v[180:183]
  ds_read_b64_tr_b16 a[82:83], v8 offset:57344
  v_mfma_f32_16x16x32_bf16 v[184:187], a[92:95], a[4:7], v[184:187]
  ds_read_b64_tr_b16 a[84:85], v9 offset:38912
  v_cvt_pk_bf16_f32 v122, v216, v217
  v_mfma_f32_16x16x32_bf16 v[188:191], a[92:95], v[36:39], v[188:191]
  ds_read_b64_tr_b16 a[86:87], v9 offset:57344
  s_waitcnt lgkmcnt(8)
  v_mfma_f32_16x16x32_bf16 v[192:195], a[96:99], a[4:7], v[192:195]
  ds_read_b64_tr_b16 a[88:89], v2 offset:39936
  v_mfma_f32_16x16x32_bf16 v[196:199], a[96:99], v[36:39], v[196:199]
  ds_read_b64_tr_b16 a[90:91], v2 offset:58368
  v_mfma_f32_16x16x32_bf16 v[200:203], a[100:103], a[4:7], v[200:203]
  ds_read_b64_tr_b16 a[92:93], v3 offset:39936
  v_cvt_pk_bf16_f32 v123, v218, v219
  v_mfma_f32_16x16x32_bf16 v[204:207], a[100:103], v[36:39], v[204:207]
  ds_read_b64_tr_b16 a[94:95], v3 offset:58368
  s_waitcnt lgkmcnt(8)
  v_mfma_f32_16x16x32_bf16 v[176:179], a[72:75], a[8:11], v[176:179]
  ds_read_b64_tr_b16 a[96:97], v8 offset:39936
  v_mfma_f32_16x16x32_bf16 v[180:183], a[72:75], v[40:43], v[180:183]
  ds_read_b64_tr_b16 a[98:99], v8 offset:58368
  v_mfma_f32_16x16x32_bf16 v[184:187], a[76:79], a[8:11], v[184:187]
  ds_read_b64_tr_b16 a[100:101], v9 offset:39936
  v_pk_max_i16 v120, v120, 0
  v_mfma_f32_16x16x32_bf16 v[188:191], a[76:79], v[40:43], v[188:191]
  ds_read_b64_tr_b16 a[102:103], v9 offset:58368
  s_waitcnt lgkmcnt(8)
  v_mfma_f32_16x16x32_bf16 v[192:195], a[80:83], a[8:11], v[192:195]
  ds_read_b64_tr_b16 a[72:73], v2 offset:40960
  v_mfma_f32_16x16x32_bf16 v[196:199], a[80:83], v[40:43], v[196:199]
  ds_read_b64_tr_b16 a[74:75], v2 offset:59392
  s_add_u32 s71, s71, s99
  v_mfma_f32_16x16x32_bf16 v[200:203], a[84:87], a[8:11], v[200:203]
  ds_read_b64_tr_b16 a[76:77], v3 offset:40960
  v_pk_max_i16 v121, v121, 0
  buffer_store_dwordx4 a[180:183], v1, s[36:39], s71 offen sc1
  v_mfma_f32_16x16x32_bf16 v[204:207], a[84:87], v[40:43], v[204:207]
  ds_read_b64_tr_b16 a[78:79], v3 offset:59392
  s_waitcnt lgkmcnt(8)
  v_mfma_f32_16x16x32_bf16 v[176:179], a[88:91], a[12:15], v[176:179]
  ds_read_b64_tr_b16 a[80:81], v8 offset:40960
  v_mfma_f32_16x16x32_bf16 v[180:183], a[88:91], v[44:47], v[180:183]
  ds_read_b64_tr_b16 a[82:83], v8 offset:59392
  v_mfma_f32_16x16x32_bf16 v[184:187], a[92:95], a[12:15], v[184:187]
  ds_read_b64_tr_b16 a[84:85], v9 offset:40960
  v_pk_max_i16 v122, v122, 0
  v_mfma_f32_16x16x32_bf16 v[188:191], a[92:95], v[44:47], v[188:191]
  ds_read_b64_tr_b16 a[86:87], v9 offset:59392
  s_waitcnt lgkmcnt(8)
  v_mfma_f32_16x16x32_bf16 v[192:195], a[96:99], a[12:15], v[192:195]
  ds_read_b64_tr_b16 a[88:89], v2 offset:41984
  s_waitcnt vmcnt(2)
  v_cmp_ne_u32 vcc, v7, v31
  s_cbranch_vccz L_ok2
  s_mov_b32 s83, 0x8000
L_spin2:
  buffer_load_dword v31, v16, s[36:39], s95 offen sc1
  s_waitcnt vmcnt(0)
  v_cmp_ne_u32 vcc, v7, v31
  s_cbranch_vccz L_ok2
  s_sub_u32 s83, s83, 1
  s_cbranch_scc0 L_spin2
  buffer_store_dword v1, off, s[32:35], 0 offset:20 sc1
  s_waitcnt vmcnt(0)
L_ok2:
  v_mfma_f32_16x16x32_bf16 v[196:199], a[96:99], v[44:47], v[196:199]
  ds_read_b64_tr_b16 a[90:91], v2 offset:60416
  s_lshl2_add_u32 s11, s60, s61
  s_add_u32 m0, s65, 0
  v_mfma_f32_16x16x32_bf16 v[200:203], a[100:103], a[12:15], v[200:203]
  ds_read_b64_tr_b16 a[92:93], v3 offset:41984
  buffer_load_dwordx4 v1, s[36:39], s69 offen sc1 lds
  v_mfma_f32_16x16x32_bf16 v[204:207], a[100:103], v[44:47], v[204:207]
  ds_read_b64_tr_b16 a[94:95], v3 offset:60416
  s_waitcnt lgkmcnt(8)
  v_mfma_f32_16x16x32_bf16 v[176:179], a[72:75], a[16:19], v[176:179]
  ds_read_b64_tr_b16 a[96:97], v8 offset:41984
  v_pk_max_i16 v123, v123, 0
  v_mfma_f32_16x16x32_bf16 v[180:183], a[72:75], v[48:51], v[180:183]
  ds_read_b64_tr_b16 a[98:99], v8 offset:60416
  s_lshl_b32 s11, s11, 3
  v_mfma_f32_16x16x32_bf16 v[184:187], a[76:79], a[16:19], v[184:187]
  ds_read_b64_tr_b16 a[100:101], v9 offset:41984
  buffer_load_dwordx4 v1, s[36:39], s69 offen offset:1024 sc1 lds
  v_mfma_f32_16x16x32_bf16 v[188:191], a[76:79], v[48:51], v[188:191]
  ds_read_b64_tr_b16 a[102:103], v9 offset:60416
  s_waitcnt lgkmcnt(8)
  v_mfma_f32_16x16x32_bf16 v[192:195], a[80:83], a[16:19], v[192:195]
  ds_read_b64_tr_b16 a[72:73], v2 offset:43008
  v_cvt_pk_bf16_f32 v124, v212, v213
  v_mfma_f32_16x16x32_bf16 v[196:199], a[80:83], v[48:51], v[196:199]
  ds_read_b64_tr_b16 a[74:75], v2 offset:61440
  s_add_u32 s11, s11, s64
  s_add_u32 s82, s82, 2048
  v_mfma_f32_16x16x32_bf16 v[200:203], a[84:87], a[16:19], v[200:203]
  ds_read_b64_tr_b16 a[76:77], v3 offset:43008
  v_cvt_pk_bf16_f32 v125, v214, v215
  buffer_store_dwordx4 v[120:123], v1, s[36:39], s82 offen sc1
  v_mfma_f32_16x16x32_bf16 v[204:207], a[84:87], v[48:51], v[204:207]
  ds_read_b64_tr_b16 a[78:79], v3 offset:61440
  s_waitcnt lgkmcnt(8)
  v_mfma_f32_16x16x32_bf16 v[176:179], a[88:91], a[20:23], v[176:179]
  ds_read_b64_tr_b16 a[80:81], v8 offset:43008
  v_mfma_f32_16x16x32_bf16 v[180:183], a[88:91], v[52:55], v[180:183]
  ds_read_b64_tr_b16 a[82:83], v8 offset:61440
  s_lshl_b32 s11, s11, 4
  v_mfma_f32_16x16x32_bf16 v[184:187], a[92:95], a[20:23], v[184:187]
  ds_read_b64_tr_b16 a[84:85], v9 offset:43008
  v_cvt_pk_bf16_f32 v126, v220, v221
  buffer_load_dwordx4 v1, s[36:39], s69 offen offset:2048 sc1 lds
  v_mfma_f32_16x16x32_bf16 v[188:191], a[92:95], v[52:55], v[188:191]
  ds_read_b64_tr_b16 a[86:87], v9 offset:61440
  s_waitcnt lgkmcnt(8)
  v_mfma_f32_16x16x32_bf16 v[192:195], a[96:99], a[20:23], v[192:195]
  ds_read_b64_tr_b16 a[88:89], v2 offset:44032
  v_mfma_f32_16x16x32_bf16 v[196:199], a[96:99], v[52:55], v[196:199]
  ds_read_b64_tr_b16 a[90:91], v2 offset:62464
  s_add_u32 s11, s11, 8192
  v_mfma_f32_16x16x32_bf16 v[200:203], a[100:103], a[20:23], v[200:203]
  ds_read_b64_tr_b16 a[92:93], v3 offset:44032
  v_cvt_pk_bf16_f32 v127, v222, v223
  buffer_load_dwordx4 v1, s[36:39], s69 offen offset:3072 sc1 lds
  v_mfma_f32_16x16x32_bf16 v[204:207], a[100:103], v[52:55], v[204:207]
  ds_read_b64_tr_b16 a[94:95], v3 offset:62464
  s_waitcnt lgkmcnt(8)
  v_mfma_f32_16x16x32_bf16 v[176:179], a[72:75], a[24:27], v[176:179]
  ds_read_b64_tr_b16 a[96:97], v8 offset:44032
  s_add_u32 s84, s69, 4096
  v_mfma_f32_16x16x32_bf16 v[180:183], a[72:75], v[56:59], v[180:183]
  ds_read_b64_tr_b16 a[98:99], v8 offset:62464
  s_lshl2_add_u32 s12, s62, s11
  s_add_u32 m0, s65, 4096
  v_mfma_f32_16x16x32_bf16 v[184:187], a[76:79], a[24:27], v[184:187]
  ds_read_b64_tr_b16 a[100:101], v9 offset:44032
  v_pk_max_i16 v124, v124, 0
  buffer_load_dwordx4 v1, s[36:39], s84 offen sc1 lds
  v_mfma_f32_16x16x32_bf16 v[188:191], a[76:79], v[56:59], v[188:191]
  ds_read_b64_tr_b16 a[102:103], v9 offset:62464
  s_waitcnt lgkmcnt(8)
  v_mfma_f32_16x16x32_bf16 v[192:195], a[80:83], a[24:27], v[192:195]
  ds_read_b64_tr_b16 a[72:73], v2 offset:45056
  v_mfma_f32_16x16x32_bf16 v[196:199], a[80:83], v[56:59], v[196:199]
  ds_read_b64_tr_b16 a[74:75], v2 offset:63488
  s_lshl2_add_u32 s14, s63, s64
  s_add_u32 s71, s71, s99
  v_mfma_f32_16x16x32_bf16 v[200:203], a[84:87], a[24:27], v[200:203]
  ds_read_b64_tr_b16 a[76:77], v3 offset:45056
  v_pk_max_i16 v125, v125, 0
  buffer_store_dwordx4 a[184:187], v1, s[36:39], s71 offen sc1
  v_mfma_f32_16x16x32_bf16 v[204:207], a[84:87], v[56:59], v[204:207]
  ds_read_b64_tr_b16 a[78:79], v3 offset:63488
  s_waitcnt lgkmcnt(8)
  v_mfma_f32_16x16x32_bf16 v[176:179], a[88:91], a[28:31], v[176:179]
  ds_read_b64_tr_b16 a[80:81], v8 offset:45056
  v_mfma_f32_16x16x32_bf16 v[180:183], a[88:91], v[60:63], v[180:183]
  ds_read_b64_tr_b16 a[82:83], v8 offset:63488
  s_lshl_b32 s14, s14, 6
  v_mfma_f32_16x16x32_bf16 v[184:187], a[92:95], a[28:31], v[184:187]
  ds_read_b64_tr_b16 a[84:85], v9 offset:45056
  v_pk_max_i16 v126, v126, 0
  buffer_load_dwordx4 v1, s[36:39], s84 offen offset:1024 sc1 lds
  v_mfma_f32_16x16x32_bf16 v[188:191], a[92:95], v[60:63], v[188:191]
  ds_read_b64_tr_b16 a[86:87], v9 offset:63488
  v_add_u32 v2, 73728, v2
  s_waitcnt lgkmcnt(8)
  v_mfma_f32_16x16x32_bf16 v[192:195], a[96:99], a[28:31], v[192:195]
  s_barrier
  ds_read_b64_tr_b16 a[88:89], v2
  v_mfma_f32_16x16x32_bf16 v[196:199], a[96:99], v[60:63], v[196:199]
  ds_read_b64_tr_b16 a[90:91], v2 offset:18432
  v_add_u32 v3, 73728, v3
  v_mfma_f32_16x16x32_bf16 v[200:203], a[100:103], a[28:31], v[200:203]
  ds_read_b64_tr_b16 a[92:93], v3
  buffer_load_dwordx4 v1, s[36:39], s84 offen offset:2048 sc1 lds
  v_mfma_f32_16x16x32_bf16 v[204:207], a[100:103], v[60:63], v[204:207]
  ds_read_b64_tr_b16 a[94:95], v3 offset:18432
  v_add_u32 v8, 73728, v8
  s_waitcnt lgkmcnt(8)
  v_mfma_f32_16x16x32_bf16 v[176:179], a[72:75], a[32:35], v[176:179]
  ds_read_b64_tr_b16 a[96:97], v8
  s_add_u32 s14, s14, 16384
  v_mfma_f32_16x16x32_bf16 v[180:183], a[72:75], v[64:67], v[180:183]
  ds_read_b64_tr_b16 a[98:99], v8 offset:18432
  v_add_u32 v9, 73728, v9
  v_mfma_f32_16x16x32_bf16 v[184:187], a[76:79], a[32:35], v[184:187]
  ds_read_b64_tr_b16 a[100:101], v9
  v_pk_max_i16 v127, v127, 0
  buffer_load_dwordx4 v1, s[36:39], s84 offen offset:3072 sc1 lds
  v_mfma_f32_16x16x32_bf16 v[188:191], a[76:79], v[64:67], v[188:191]
  ds_read_b64_tr_b16 a[102:103], v9 offset:18432
  s_waitcnt lgkmcnt(8)
  v_mfma_f32_16x16x32_bf16 v[192:195], a[80:83], a[32:35], v[192:195]
  ds_read_b64_tr_b16 a[72:73], v2 offset:1024
  s_add_u32 s84, s69, 8192
  v_mfma_f32_16x16x32_bf16 v[196:199], a[80:83], v[64:67], v[196:199]
  ds_read_b64_tr_b16 a[74:75], v2 offset:19456
  s_lshl2_add_u32 s13, s60, s14
  s_add_u32 m0, s65, 8192
  v_mfma_f32_16x16x32_bf16 v[200:203], a[84:87], a[32:35], v[200:203]
  ds_read_b64_tr_b16 a[76:77], v3 offset:1024
  v_cvt_pk_bf16_f32 v128, v224, v225
  buffer_load_dwordx4 v1, s[36:39], s84 offen sc1 lds
  v_mfma_f32_16x16x32_bf16 v[204:207], a[84:87], v[64:67], v[204:207]
  ds_read_b64_tr_b16 a[78:79], v3 offset:19456
  s_waitcnt lgkmcnt(8)
  v_mfma_f32_16x16x32_bf16 v[176:179], a[88:91], a[36:39], v[176:179]
  ds_read_b64_tr_b16 a[80:81], v8 offset:1024
  v_mfma_f32_16x16x32_bf16 v[180:183], a[88:91], v[68:71], v[180:183]
  ds_read_b64_tr_b16 a[82:83], v8 offset:19456
  v_cvt_pk_bf16_f32 v129, v226, v227
  v_mfma_f32_16x16x32_bf16 v[184:187], a[92:95], a[36:39], v[184:187]
  ds_read_b64_tr_b16 a[84:85], v9 offset:1024
  s_lshl_b32 s9, s64, 10
  buffer_store_dwordx4 v[124:127], v1, s[36:39], s82 offen offset:1024 sc1
  v_mfma_f32_16x16x32_bf16 v[188:191], a[92:95], v[68:71], v[188:191]
  ds_read_b64_tr_b16 a[86:87], v9 offset:19456
  s_waitcnt lgkmcnt(8)
  v_mfma_f32_16x16x32_bf16 v[192:195], a[96:99], a[36:39], v[192:195]
  ds_read_b64_tr_b16 a[88:89], v2 offset:2048
  s_add_u32 s84, s69, 36864
  v_mfma_f32_16x16x32_bf16 v[196:199], a[96:99], v[68:71], v[196:199]
  ds_read_b64_tr_b16 a[90:91], v2 offset:20480
  v_cvt_pk_bf16_f32 v130, v232, v233
  s_add_u32 m0, s65, 36864
  v_mfma_f32_16x16x32_bf16 v[200:203], a[100:103], a[36:39], v[200:203]
  ds_read_b64_tr_b16 a[92:93], v3 offset:2048
  s_add_u32 s9, s9, s98
  buffer_load_dwordx4 v1, s[36:39], s84 offen sc1 lds
  v_mfma_f32_16x16x32_bf16 v[204:207], a[100:103], v[68:71], v[204:207]
  ds_read_b64_tr_b16 a[94:95], v3 offset:20480
  s_waitcnt lgkmcnt(8)
  v_mfma_f32_16x16x32_bf16 v[176:179], a[72:75], a[40:43], v[176:179]
  ds_read_b64_tr_b16 a[96:97], v8 offset:2048
  v_mfma_f32_16x16x32_bf16 v[180:183], a[72:75], v[72:75], v[180:183]
  ds_read_b64_tr_b16 a[98:99], v8 offset:20480
  v_cvt_pk_bf16_f32 v131, v234, v235
  v_mfma_f32_16x16x32_bf16 v[184:187], a[76:79], a[40:43], v[184:187]
  ds_read_b64_tr_b16 a[100:101], v9 offset:2048
  v_subrev_u32 v28, 36, v0
  buffer_load_dwordx4 v1, s[36:39], s84 offen offset:1024 sc1 lds
  v_mfma_f32_16x16x32_bf16 v[188:191], a[76:79], v[72:75], v[188:191]
  ds_read_b64_tr_b16 a[102:103], v9 offset:20480
  s_waitcnt lgkmcnt(8)
  v_mfma_f32_16x16x32_bf16 v[192:195], a[80:83], a[40:43], v[192:195]
  ds_read_b64_tr_b16 a[72:73], v2 offset:3072
  v_mfma_f32_16x16x32_bf16 v[196:199], a[80:83], v[72:75], v[196:199]
  ds_read_b64_tr_b16 a[74:75], v2 offset:21504
  v_pk_max_i16 v128, v128, 0
  v_mfma_f32_16x16x32_bf16 v[200:203], a[84:87], a[40:43], v[200:203]
  ds_read_b64_tr_b16 a[76:77], v3 offset:3072
  v_lshrrev_b32 v29, 2, v28
  buffer_load_dwordx4 v1, s[36:39], s84 offen offset:2048 sc1 lds
  v_mfma_f32_16x16x32_bf16 v[204:207], a[84:87], v[72:75], v[204:207]
  ds_read_b64_tr_b16 a[78:79], v3 offset:21504
  s_waitcnt lgkmcnt(8)
  v_mfma_f32_16x16x32_bf16 v[176:179], a[88:91], a[44:47], v[176:179]
  ds_read_b64_tr_b16 a[80:81], v8 offset:3072
  v_mfma_f32_16x16x32_bf16 v[180:183], a[88:91], v[76:79], v[180:183]
  ds_read_b64_tr_b16 a[82:83], v8 offset:21504
  v_pk_max_i16 v129, v129, 0
  v_mfma_f32_16x16x32_bf16 v[184:187], a[92:95], a[44:47], v[184:187]
  ds_read_b64_tr_b16 a[84:85], v9 offset:3072
  v_and_b32 v30, 3, v0
  buffer_load_dwordx4 v1, s[36:39], s84 offen offset:3072 sc1 lds
  v_mfma_f32_16x16x32_bf16 v[188:191], a[92:95], v[76:79], v[188:191]
  ds_read_b64_tr_b16 a[86:87], v9 offset:21504
  s_waitcnt lgkmcnt(8)
  v_mfma_f32_16x16x32_bf16 v[192:195], a[96:99], a[44:47], v[192:195]
  ds_read_b64_tr_b16 a[88:89], v2 offset:4096
  s_add_u32 s84, s69, 40960
  v_mfma_f32_16x16x32_bf16 v[196:199], a[96:99], v[76:79], v[196:199]
  ds_read_b64_tr_b16 a[90:91], v2 offset:22528
  v_pk_max_i16 v130, v130, 0
  s_add_u32 m0, s65, 40960
  v_mfma_f32_16x16x32_bf16 v[200:203], a[100:103], a[44:47], v[200:203]
  ds_read_b64_tr_b16 a[92:93], v3 offset:4096
  v_lshlrev_b32 v29, 10, v29
  buffer_load_dwordx4 v1, s[36:39], s84 offen sc1 lds
  v_mfma_f32_16x16x32_bf16 v[204:207], a[100:103], v[76:79], v[204:207]
  ds_read_b64_tr_b16 a[94:95], v3 offset:22528
  s_waitcnt lgkmcnt(8)
  v_mfma_f32_16x16x32_bf16 v[176:179], a[72:75], a[48:51], v[176:179]
  ds_read_b64_tr_b16 a[96:97], v8 offset:4096
  v_mfma_f32_16x16x32_bf16 v[180:183], a[72:75], v[80:83], v[180:183]
  ds_read_b64_tr_b16 a[98:99], v8 offset:22528
  v_pk_max_i16 v131, v131, 0
  s_add_u32 s82, s82, 2048
  v_mfma_f32_16x16x32_bf16 v[184:187], a[76:79], a[48:51], v[184:187]
  ds_read_b64_tr_b16 a[100:101], v9 offset:4096
  v_lshl_add_u32 v29, v30, 2, v29
  buffer_store_dwordx4 v[128:131], v1, s[36:39], s82 offen sc1
  v_mfma_f32_16x16x32_bf16 v[188:191], a[76:79], v[80:83], v[188:191]
  ds_read_b64_tr_b16 a[102:103], v9 offset:22528
  s_waitcnt lgkmcnt(8)
  v_mfma_f32_16x16x32_bf16 v[192:195], a[80:83], a[48:51], v[192:195]
  ds_read_b64_tr_b16 a[72:73], v2 offset:5120
  v_mfma_f32_16x16x32_bf16 v[196:199], a[80:83], v[80:83], v[196:199]
  ds_read_b64_tr_b16 a[74:75], v2 offset:23552
  v_cvt_pk_bf16_f32 v132, v228, v229
  v_mfma_f32_16x16x32_bf16 v[200:203], a[84:87], a[48:51], v[200:203]
  ds_read_b64_tr_b16 a[76:77], v3 offset:5120
  v_lshlrev_b32 v30, 10, v30
  buffer_load_dwordx4 v1, s[36:39], s84 offen offset:1024 sc1 lds
  v_mfma_f32_16x16x32_bf16 v[204:207], a[84:87], v[80:83], v[204:207]
  ds_read_b64_tr_b16 a[78:79], v3 offset:23552
  s_waitcnt lgkmcnt(8)
  v_mfma_f32_16x16x32_bf16 v[176:179], a[88:91], a[52:55], v[176:179]
  ds_read_b64_tr_b16 a[80:81], v8 offset:5120
  v_cvt_pk_bf16_f32 v133, v230, v231
  v_mfma_f32_16x16x32_bf16 v[180:183], a[88:91], v[84:87], v[180:183]
  ds_read_b64_tr_b16 a[82:83], v8 offset:23552
  s_add_u32 s94, s94, 57344
  s_waitcnt vmcnt(12)
  v_mfma_f32_16x16x32_bf16 v[184:187], a[92:95], a[52:55], v[184:187]
  ds_read_b64_tr_b16 a[84:85], v9 offset:5120
  v_add_u32 v30, 16, v30
  buffer_store_dword v7, v27, s[36:39], s94 offen sc1
  v_mfma_f32_16x16x32_bf16 v[188:191], a[92:95], v[84:87], v[188:191]
  ds_read_b64_tr_b16 a[86:87], v9 offset:23552
  s_waitcnt lgkmcnt(8)
  v_mfma_f32_16x16x32_bf16 v[192:195], a[96:99], a[52:55], v[192:195]
  ds_read_b64_tr_b16 a[88:89], v2 offset:6144
  v_cvt_pk_bf16_f32 v134, v236, v237
  v_mfma_f32_16x16x32_bf16 v[196:199], a[96:99], v[84:87], v[196:199]
  ds_read_b64_tr_b16 a[90:91], v2 offset:24576
  buffer_load_dwordx4 v1, s[36:39], s84 offen offset:2048 sc1 lds
  v_mfma_f32_16x16x32_bf16 v[200:203], a[100:103], a[52:55], v[200:203]
  ds_read_b64_tr_b16 a[92:93], v3 offset:6144
  v_cmp_gt_u32 vcc, 52, v0
  s_nop 1
  v_cndmask_b32 v29, v30, v29, vcc
  v_mfma_f32_16x16x32_bf16 v[204:207], a[100:103], v[84:87], v[204:207]
  ds_read_b64_tr_b16 a[94:95], v3 offset:24576
  s_waitcnt lgkmcnt(8)
  v_mfma_f32_16x16x32_bf16 v[176:179], a[72:75], a[56:59], v[176:179]
  ds_read_b64_tr_b16 a[96:97], v8 offset:6144
  v_cvt_pk_bf16_f32 v135, v238, v239
  v_mfma_f32_16x16x32_bf16 v[180:183], a[72:75], v[88:91], v[180:183]
  ds_read_b64_tr_b16 a[98:99], v8 offset:24576
  buffer_load_dwordx4 v1, s[36:39], s84 offen offset:3072 sc1 lds
  v_mfma_f32_16x16x32_bf16 v[184:187], a[76:79], a[56:59], v[184:187]
  ds_read_b64_tr_b16 a[100:101], v9 offset:6144
  s_lshl_b32 s40, s62, 8
  v_mfma_f32_16x16x32_bf16 v[188:191], a[76:79], v[88:91], v[188:191]
  ds_read_b64_tr_b16 a[102:103], v9 offset:24576
  s_add_u32 s84, s69, 45056
  s_waitcnt lgkmcnt(8)
  v_mfma_f32_16x16x32_bf16 v[192:195], a[80:83], a[56:59], v[192:195]
  ds_read_b64_tr_b16 a[72:73], v2 offset:7168
  v_pk_max_i16 v132, v132, 0
  s_add_u32 m0, s65, 45056
  v_mfma_f32_16x16x32_bf16 v[196:199], a[80:83], v[88:91], v[196:199]
  ds_read_b64_tr_b16 a[74:75], v2 offset:25600
  buffer_load_dwordx4 v1, s[36:39], s84 offen sc1 lds
  v_mfma_f32_16x16x32_bf16 v[200:203], a[84:87], a[56:59], v[200:203]
  ds_read_b64_tr_b16 a[76:77], v3 offset:7168
  s_add_u32 s40, s40, 61584
  v_mfma_f32_16x16x32_bf16 v[204:207], a[84:87], v[88:91], v[204:207]
  ds_read_b64_tr_b16 a[78:79], v3 offset:25600
  s_waitcnt lgkmcnt(8)
  v_mfma_f32_16x16x32_bf16 v[176:179], a[88:91], a[60:63], v[176:179]
  ds_read_b64_tr_b16 a[80:81], v8 offset:7168
  v_pk_max_i16 v133, v133, 0
  v_mfma_f32_16x16x32_bf16 v[180:183], a[88:91], v[92:95], v[180:183]
  ds_read_b64_tr_b16 a[82:83], v8 offset:25600
  v_mfma_f32_16x16x32_bf16 v[184:187], a[92:95], a[60:63], v[184:187]
  ds_read_b64_tr_b16 a[84:85], v9 offset:7168
  v_add_u32 v29, s40, v29
  v_mfma_f32_16x16x32_bf16 v[188:191], a[92:95], v[92:95], v[188:191]
  ds_read_b64_tr_b16 a[86:87], v9 offset:25600
  s_waitcnt lgkmcnt(8)
  v_mfma_f32_16x16x32_bf16 v[192:195], a[96:99], a[60:63], v[192:195]
  ds_read_b64_tr_b16 a[88:89], v2 offset:8192
  v_pk_max_i16 v134, v134, 0
  v_mfma_f32_16x16x32_bf16 v[196:199], a[96:99], v[92:95], v[196:199]
  ds_read_b64_tr_b16 a[90:91], v2 offset:26624
  v_mfma_f32_16x16x32_bf16 v[200:203], a[100:103], a[60:63], v[200:203]
  ds_read_b64_tr_b16 a[92:93], v3 offset:8192
  s_add_u32 s40, s95, 57344
  v_mfma_f32_16x16x32_bf16 v[204:207], a[100:103], v[92:95], v[204:207]
  ds_read_b64_tr_b16 a[94:95], v3 offset:26624
  s_waitcnt lgkmcnt(8)
  v_mfma_f32_16x16x32_bf16 v[176:179], a[72:75], a[64:67], v[176:179]
  ds_read_b64_tr_b16 a[96:97], v8 offset:8192
  v_pk_max_i16 v135, v135, 0
  v_mfma_f32_16x16x32_bf16 v[180:183], a[72:75], v[96:99], v[180:183]
  ds_read_b64_tr_b16 a[98:99], v8 offset:26624
  buffer_store_dwordx4 v[132:135], v1, s[36:39], s82 offen offset:1024 sc1
  v_mfma_f32_16x16x32_bf16 v[184:187], a[76:79], a[64:67], v[184:187]
  ds_read_b64_tr_b16 a[100:101], v9 offset:8192
  v_add_u32 v16, s40, v16
  v_mfma_f32_16x16x32_bf16 v[188:191], a[76:79], v[96:99], v[188:191]
  ds_read_b64_tr_b16 a[102:103], v9 offset:26624
  s_waitcnt lgkmcnt(8)
  v_mfma_f32_16x16x32_bf16 v[192:195], a[80:83], a[64:67], v[192:195]
  s_waitcnt vmcnt(13)
  s_barrier
  ds_read_b128 a[72:75], v1
  v_mfma_f32_16x16x32_bf16 v[196:199], a[80:83], v[96:99], v[196:199]
  s_add_u32 s84, s69, 73728
  v_mfma_f32_16x16x32_bf16 v[200:203], a[84:87], a[64:67], v[200:203]
  ds_read_b128 a[76:79], v1 offset:1024
  v_mov_b32 v30, s40
  s_add_u32 m0, s65, 73728
  v_mfma_f32_16x16x32_bf16 v[204:207], a[84:87], v[96:99], v[204:207]
  buffer_load_dwordx4 v1, s[36:39], s84 offen sc1 lds
  s_waitcnt lgkmcnt(6)
  v_mfma_f32_16x16x32_bf16 v[176:179], a[88:91], a[68:71], v[176:179]
  ds_read_b128 a[80:83], v1 offset:2048
  v_cmp_gt_u32 vcc, 18, v28
  s_nop 1
  v_cndmask_b32 v29, v30, v29, vcc
  v_mfma_f32_16x16x32_bf16 v[180:183], a[88:91], v[100:103], v[180:183]
  v_mfma_f32_16x16x32_bf16 v[184:187], a[92:95], a[68:71], v[184:187]
  ds_read_b128 a[84:87], v1 offset:3072
  v_cmp_gt_u32 vcc, 36, v0
  s_nop 1
  v_cndmask_b32 v16, v29, v16, vcc
  v_mfma_f32_16x16x32_bf16 v[188:191], a[92:95], v[100:103], v[188:191]
  buffer_load_dwordx4 v1, s[36:39], s84 offen offset:1024 sc1 lds
  s_waitcnt lgkmcnt(4)
  v_mfma_f32_16x16x32_bf16 v[192:195], a[96:99], a[68:71], v[192:195]
  ds_read_b128 a[88:91], v1 offset:4096
  s_mov_b32 s44, 110592
  v_mfma_f32_16x16x32_bf16 v[196:199], a[96:99], v[100:103], v[196:199]
  v_mfma_f32_16x16x32_bf16 v[200:203], a[100:103], a[68:71], v[200:203]
  ds_read_b128 a[92:95], v1 offset:5120
  v_and_b32 v28, 15, v0
  v_mfma_f32_16x16x32_bf16 v[204:207], a[100:103], v[100:103], v[204:207]
  buffer_load_dwordx4 v1, s[36:39], s84 offen offset:2048 sc1 lds
  s_waitcnt lgkmcnt(4)
  v_mfma_f32_16x16x32_bf16 v[248:251], a[72:75], a[0:3], 0
  ds_read_b128 a[96:99], v1 offset:6144
  v_lshrrev_b32 v29, 4, v0
  v_mfma_f32_16x16x32_bf16 v[252:255], a[72:75], v[32:35], 0
  v_mfma_f32_16x16x32_bf16 v[240:243], a[76:79], a[0:3], 0
  ds_read_b128 a[100:103], v1 offset:7168
  s_lshl_b32 s40, s64, 5
  v_mfma_f32_16x16x32_bf16 v[244:247], a[76:79], v[32:35], 0
  v_cvt_pk_bf16_f32 v136, v176, v177
  s_waitcnt lgkmcnt(4)
  v_mfma_f32_16x16x32_bf16 v[248:251], a[80:83], a[4:7], v[248:251]
  ds_read_b128 a[72:75], v1 offset:8192
  buffer_load_dwordx4 v1, s[36:39], s84 offen offset:3072 sc1 lds
  v_mfma_f32_16x16x32_bf16 v[252:255], a[80:83], v[36:39], v[252:255]
  v_cvt_pk_bf16_f32 v137, v178, v179
  v_add_u32 v28, s40, v28
  v_mfma_f32_16x16x32_bf16 v[240:243], a[84:87], a[4:7], v[240:243]
  ds_read_b128 a[76:79], v1 offset:9216
  v_mfma_f32_16x16x32_bf16 v[244:247], a[84:87], v[36:39], v[244:247]
  v_cvt_pk_bf16_f32 v138, v184, v185
  s_add_u32 s84, s69, 77824
  s_waitcnt lgkmcnt(4)
  v_mfma_f32_16x16x32_bf16 v[248:251], a[88:91], a[8:11], v[248:251]
  ds_read_b128 a[80:83], v1 offset:10240
  v_mul_u32_u24 v17, 296, v28
  s_add_u32 m0, s65, 77824
  v_mfma_f32_16x16x32_bf16 v[252:255], a[88:91], v[40:43], v[252:255]
  v_cvt_pk_bf16_f32 v139, v186, v187
  buffer_load_dwordx4 v1, s[36:39], s84 offen sc1 lds
  v_mfma_f32_16x16x32_bf16 v[240:243], a[92:95], a[8:11], v[240:243]
  ds_read_b128 a[84:87], v1 offset:11264
  v_mul_u32_u24 v30, 72, v29
  v_mfma_f32_16x16x32_bf16 v[244:247], a[92:95], v[40:43], v[244:247]
  v_pk_max_i16 v136, v136, 0
  s_waitcnt lgkmcnt(4)
  v_mfma_f32_16x16x32_bf16 v[248:251], a[96:99], a[12:15], v[248:251]
  ds_read_b128 a[88:91], v1 offset:12288
  v_mfma_f32_16x16x32_bf16 v[252:255], a[96:99], v[44:47], v[252:255]
  v_pk_max_i16 v137, v137, 0
  v_add3_u32 v17, v17, v30, s44
  v_mfma_f32_16x16x32_bf16 v[240:243], a[100:103], a[12:15], v[240:243]
  ds_read_b128 a[92:95], v1 offset:13312
  buffer_load_dwordx4 v1, s[36:39], s84 offen offset:1024 sc1 lds
  v_mfma_f32_16x16x32_bf16 v[244:247], a[100:103], v[44:47], v[244:247]
  v_pk_max_i16 v138, v138, 0
  s_waitcnt lgkmcnt(4)
  v_mfma_f32_16x16x32_bf16 v[248:251], a[72:75], a[16:19], v[248:251]
  ds_read_b128 a[96:99], v1 offset:14336
  v_mul_u32_u24 v18, 104, v28
  v_mfma_f32_16x16x32_bf16 v[252:255], a[72:75], v[48:51], v[252:255]
  v_pk_max_i16 v139, v139, 0
  s_add_u32 s82, s82, 2048
  v_mfma_f32_16x16x32_bf16 v[240:243], a[76:79], a[16:19], v[240:243]
  ds_read_b128 a[100:103], v1 offset:15360
  v_lshl_add_u32 v18, v29, 3, v18
  buffer_store_dwordx4 v[136:139], v1, s[36:39], s82 offen sc1
  v_mfma_f32_16x16x32_bf16 v[244:247], a[76:79], v[48:51], v[244:247]
  v_cvt_pk_bf16_f32 v140, v180, v181
  s_waitcnt lgkmcnt(4)
  v_mfma_f32_16x16x32_bf16 v[248:251], a[80:83], a[20:23], v[248:251]
  ds_read_b128 a[72:75], v1 offset:16384
  v_mfma_f32_16x16x32_bf16 v[252:255], a[80:83], v[52:55], v[252:255]
  v_cvt_pk_bf16_f32 v141, v182, v183
  v_add_u32 v18, 148480, v18
  v_mfma_f32_16x16x32_bf16 v[240:243], a[84:87], a[20:23], v[240:243]
  ds_read_b128 a[76:79], v1 offset:17408
  buffer_load_dwordx4 v1, s[36:39], s84 offen offset:2048 sc1 lds
  v_mfma_f32_16x16x32_bf16 v[244:247], a[84:87], v[52:55], v[244:247]
  v_cvt_pk_bf16_f32 v142, v188, v189
  s_waitcnt lgkmcnt(4)
  v_mfma_f32_16x16x32_bf16 v[248:251], a[88:91], a[24:27], v[248:251]
  ds_read_b128 a[80:83], v1 offset:18432
  v_lshrrev_b32 v28, 2, v0
  v_mfma_f32_16x16x32_bf16 v[252:255], a[88:91], v[56:59], v[252:255]
  v_cvt_pk_bf16_f32 v143, v190, v191
  v_mfma_f32_16x16x32_bf16 v[240:243], a[92:95], a[24:27], v[240:243]
  ds_read_b128 a[84:87], v1 offset:19456
  v_and_b32 v29, 3, v0
  buffer_load_dwordx4 v1, s[36:39], s84 offen offset:3072 sc1 lds
  v_mfma_f32_16x16x32_bf16 v[244:247], a[92:95], v[56:59], v[244:247]
  v_pk_max_i16 v140, v140, 0
  s_waitcnt lgkmcnt(4)
  v_mfma_f32_16x16x32_bf16 v[248:251], a[96:99], a[28:31], v[248:251]
  ds_read_b128 a[88:91], v1 offset:20480
  s_add_u32 s84, s69, 81920
  v_mfma_f32_16x16x32_bf16 v[252:255], a[96:99], v[60:63], v[252:255]
  v_pk_max_i16 v141, v141, 0
  s_lshr_b32 s44, s64, 1
  s_add_u32 m0, s65, 81920
  v_mfma_f32_16x16x32_bf16 v[240:243], a[100:103], a[28:31], v[240:243]
  ds_read_b128 a[92:95], v1 offset:21504
  buffer_load_dwordx4 v1, s[36:39], s84 offen sc1 lds
  v_mfma_f32_16x16x32_bf16 v[244:247], a[100:103], v[60:63], v[244:247]
  v_pk_max_i16 v142, v142, 0
  s_waitcnt lgkmcnt(4)
  v_mfma_f32_16x16x32_bf16 v[248:251], a[72:75], a[32:35], v[248:251]
  ds_read_b128 a[96:99], v1 offset:22528
  s_and_b32 s45, s64, 1
  v_mfma_f32_16x16x32_bf16 v[252:255], a[72:75], v[64:67], v[252:255]
  v_pk_max_i16 v143, v143, 0
  v_mfma_f32_16x16x32_bf16 v[240:243], a[76:79], a[32:35], v[240:243]
  ds_read_b128 a[100:103], v1 offset:23552
  v_mul_u32_u24 v20, 296, v28
  buffer_store_dwordx4 v[140:143], v1, s[36:39], s82 offen offset:1024 sc1
  v_mfma_f32_16x16x32_bf16 v[244:247], a[76:79], v[64:67], v[244:247]
  v_cvt_pk_bf16_f32 v144, v192, v193
  s_waitcnt lgkmcnt(4)
  v_mfma_f32_16x16x32_bf16 v[248:251], a[80:83], a[36:39], v[248:251]
  ds_read_b128 a[72:75], v1 offset:24576
  v_mfma_f32_16x16x32_bf16 v[252:255], a[80:83], v[68:71], v[252:255]
  v_cvt_pk_bf16_f32 v145, v194, v195
  s_mul_i32 s40, s44, 72
  v_mfma_f32_16x16x32_bf16 v[240:243], a[84:87], a[36:39], v[240:243]
  ds_read_b128 a[76:79], v1 offset:25600
  v_mfma_f32_16x16x32_bf16 v[244:247], a[84:87], v[68:71], v[244:247]
  v_cvt_pk_bf16_f32 v146, v200, v201
  s_waitcnt lgkmcnt(4)
  v_mfma_f32_16x16x32_bf16 v[248:251], a[88:91], a[40:43], v[248:251]
L_pg3:
  s_cbranch_execz L_pg7
  ds_read_b128 a[80:83], v1 offset:26624
  s_lshl_b32 s41, s45, 3
  v_mfma_f32_16x16x32_bf16 v[252:255], a[88:91], v[72:75], v[252:255]
  v_cvt_pk_bf16_f32 v147, v202, v203
  v_mfma_f32_16x16x32_bf16 v[240:243], a[92:95], a[40:43], v[240:243]
  ds_read_b128 a[84:87], v1 offset:27648
  s_add_u32 s40, s40, s41
  v_mfma_f32_16x16x32_bf16 v[244:247], a[92:95], v[72:75], v[244:247]
  v_pk_max_i16 v144, v144, 0
  s_waitcnt lgkmcnt(4)
  v_mfma_f32_16x16x32_bf16 v[248:251], a[96:99], a[44:47], v[248:251]
  ds_read_b128 a[88:91], v1 offset:28672
  v_mfma_f32_16x16x32_bf16 v[252:255], a[96:99], v[76:79], v[252:255]
  v_pk_max_i16 v145, v145, 0
  s_add_u32 s40, s40, 110736
  v_mfma_f32_16x16x32_bf16 v[240:243], a[100:103], a[44:47], v[240:243]
  ds_read_b128 a[92:95], v1 offset:29696
  v_mfma_f32_16x16x32_bf16 v[244:247], a[100:103], v[76:79], v[244:247]
  v_pk_max_i16 v146, v146, 0
  s_waitcnt lgkmcnt(4)
  v_mfma_f32_16x16x32_bf16 v[248:251], a[72:75], a[48:51], v[248:251]
  ds_read_b128 a[96:99], v1 offset:30720
  v_lshl_add_u32 v19, v29, 4, v20
  v_mfma_f32_16x16x32_bf16 v[252:255], a[72:75], v[80:83], v[252:255]
  v_pk_max_i16 v147, v147, 0
  s_add_u32 s82, s82, 2048
  v_mfma_f32_16x16x32_bf16 v[240:243], a[76:79], a[48:51], v[240:243]
  ds_read_b128 a[100:103], v1 offset:31744
  v_add_u32 v19, s40, v19
  buffer_store_dwordx4 v[144:147], v1, s[36:39], s82 offen sc1
  v_mfma_f32_16x16x32_bf16 v[244:247], a[76:79], v[80:83], v[244:247]
  v_cvt_pk_bf16_f32 v148, v196, v197
  s_waitcnt lgkmcnt(4)
  v_mfma_f32_16x16x32_bf16 v[248:251], a[80:83], a[52:55], v[248:251]
  ds_read_b128 a[72:75], v1 offset:32768
  v_mfma_f32_16x16x32_bf16 v[252:255], a[80:83], v[84:87], v[252:255]
  v_cvt_pk_bf16_f32 v149, v198, v199
  v_and_b32 v30, 1, v29
  v_mfma_f32_16x16x32_bf16 v[240:243], a[84:87], a[52:55], v[240:243]
  ds_read_b128 a[76:79], v1 offset:33792
  v_mfma_f32_16x16x32_bf16 v[244:247], a[84:87], v[84:87], v[244:247]
  v_cvt_pk_bf16_f32 v150, v204, v205
  s_waitcnt lgkmcnt(4)
  v_mfma_f32_16x16x32_bf16 v[248:251], a[88:91], a[56:59], v[248:251]
  ds_read_b128 a[80:83], v1 offset:34816
  v_mul_u32_u24 v30, 72, v30
  v_mfma_f32_16x16x32_bf16 v[252:255], a[88:91], v[88:91], v[252:255]
  v_cvt_pk_bf16_f32 v151, v206, v207
  v_mfma_f32_16x16x32_bf16 v[240:243], a[92:95], a[56:59], v[240:243]
  ds_read_b128 a[84:87], v1 offset:35840
  v_add_u32 v20, v20, v30
  v_mfma_f32_16x16x32_bf16 v[244:247], a[92:95], v[88:91], v[244:247]
  v_pk_max_i16 v148, v148, 0
  s_waitcnt lgkmcnt(4)
  v_mfma_f32_16x16x32_bf16 v[248:251], a[96:99], a[60:63], v[248:251]
  s_waitcnt vmcnt(13)
  s_barrier
  ds_read_b128 a[88:91], v1 offset:36864
  v_mfma_f32_16x16x32_bf16 v[252:255], a[96:99], v[92:95], v[252:255]
  s_lshl_b32 s8, s64, 12
  s_sub_u32 s69, s69, s8
  s_mul_i32 s8, s64, 5120
  s_add_u32 s84, s69, 110592
  s_add_u32 m0, s8, 0
  v_mfma_f32_16x16x32_bf16 v[240:243], a[100:103], a[60:63], v[240:243]
  ds_read_b128 a[92:95], v1 offset:37888
  v_pk_max_i16 v149, v149, 0
  buffer_load_dwordx4 v1, s[36:39], s84 offen sc1 lds
  v_mfma_f32_16x16x32_bf16 v[244:247], a[100:103], v[92:95], v[244:247]
  v_add_u32 v20, 110800, v20
  s_waitcnt lgkmcnt(4)
  v_mfma_f32_16x16x32_bf16 v[248:251], a[72:75], a[64:67], v[248:251]
  ds_read_b128 a[96:99], v1 offset:38912
  v_pk_max_i16 v150, v150, 0
  v_mfma_f32_16x16x32_bf16 v[252:255], a[72:75], v[96:99], v[252:255]
  v_mfma_f32_16x16x32_bf16 v[240:243], a[76:79], a[64:67], v[240:243]
  ds_read_b128 a[100:103], v1 offset:39936
  v_pk_max_i16 v151, v151, 0
  buffer_load_dwordx4 v1, s[36:39], s84 offen offset:1024 sc1 lds
  v_mfma_f32_16x16x32_bf16 v[244:247], a[76:79], v[96:99], v[244:247]
  v_mul_u32_u24 v21, 104, v28
  s_waitcnt lgkmcnt(4)
  v_mfma_f32_16x16x32_bf16 v[248:251], a[80:83], a[68:71], v[248:251]
  ds_read_b128 a[72:75], v1 offset:40960
  v_mfma_f32_16x16x32_bf16 v[252:255], a[80:83], v[100:103], v[252:255]
  v_lshl_add_u32 v21, v29, 3, v21
  v_mfma_f32_16x16x32_bf16 v[240:243], a[84:87], a[68:71], v[240:243]
  ds_read_b128 a[76:79], v1 offset:41984
  buffer_store_dwordx4 v[148:151], v1, s[36:39], s82 offen offset:1024 sc1
  v_mfma_f32_16x16x32_bf16 v[244:247], a[84:87], v[100:103], v[244:247]
  s_lshl_b32 s40, s44, 5
  s_waitcnt lgkmcnt(4)
  v_mfma_f32_16x16x32_bf16 v[208:211], a[88:91], a[0:3], 0
  ds_read_b128 a[80:83], v1 offset:43008
  v_mfma_f32_16x16x32_bf16 v[212:215], a[88:91], v[32:35], 0
  s_add_u32 s40, s40, 148480
  v_mfma_f32_16x16x32_bf16 v[216:219], a[92:95], a[0:3], 0
  ds_read_b128 a[84:87], v1 offset:44032
  buffer_load_dwordx4 v1, s[36:39], s84 offen offset:2048 sc1 lds
  v_mfma_f32_16x16x32_bf16 v[220:223], a[92:95], v[32:35], 0
  s_mov_b32 s41, 148544
  s_waitcnt lgkmcnt(4)
  v_mfma_f32_16x16x32_bf16 v[208:211], a[96:99], a[4:7], v[208:211]
  ds_read_b128 a[88:91], v1 offset:45056
  v_mfma_f32_16x16x32_bf16 v[212:215], a[96:99], v[36:39], v[212:215]
  s_cmp_eq_u32 s45, 0
  s_cselect_b32 s42, s40, s41
  s_cselect_b32 s43, s41, s40
  v_mfma_f32_16x16x32_bf16 v[216:219], a[100:103], a[4:7], v[216:219]
  ds_read_b128 a[92:95], v1 offset:46080
  buffer_load_dwordx4 v1, s[36:39], s84 offen offset:3072 sc1 lds
  v_mfma_f32_16x16x32_bf16 v[220:223], a[100:103], v[36:39], v[220:223]
  v_add_u32 v22, s43, v21
  s_waitcnt lgkmcnt(4)
  v_mfma_f32_16x16x32_bf16 v[208:211], a[72:75], a[8:11], v[208:211]
  ds_read_b128 a[96:99], v1 offset:47104
  s_add_u32 s84, s69, 114688
  v_mfma_f32_16x16x32_bf16 v[212:215], a[72:75], v[40:43], v[212:215]
  v_add_u32 v21, s42, v21
  s_add_u32 m0, s8, 4096
  v_mfma_f32_16x16x32_bf16 v[216:219], a[76:79], a[8:11], v[216:219]
  ds_read_b128 a[100:103], v1 offset:48128
  buffer_load_dwordx4 v1, s[36:39], s84 offen sc1 lds
  v_mfma_f32_16x16x32_bf16 v[220:223], a[76:79], v[40:43], v[220:223]
  s_lshl2_add_u32 s40, s63, s64
  s_waitcnt lgkmcnt(4)
  v_mfma_f32_16x16x32_bf16 v[208:211], a[80:83], a[12:15], v[208:211]
  ds_read_b128 a[72:75], v1 offset:49152
  v_mfma_f32_16x16x32_bf16 v[212:215], a[80:83], v[44:47], v[212:215]
  s_lshr_b32 s41, s60, 1
  v_mfma_f32_16x16x32_bf16 v[216:219], a[84:87], a[12:15], v[216:219]
  ds_read_b128 a[76:79], v1 offset:50176
  v_mfma_f32_16x16x32_bf16 v[220:223], a[84:87], v[44:47], v[220:223]
  s_lshl3_add_u32 s40, s40, s41
  s_waitcnt lgkmcnt(4)
  v_mfma_f32_16x16x32_bf16 v[208:211], a[88:91], a[16:19], v[208:211]
  ds_read_b128 a[80:83], v1 offset:51200
  v_mfma_f32_16x16x32_bf16 v[212:215], a[88:91], v[48:51], v[212:215]
  s_and_b32 s42, s60, 1
  v_mfma_f32_16x16x32_bf16 v[216:219], a[92:95], a[16:19], v[216:219]
  ds_read_b128 a[84:87], v1 offset:52224
  v_mfma_f32_16x16x32_bf16 v[220:223], a[92:95], v[48:51], v[220:223]
  s_lshl_b32 s42, s42, 3
  s_waitcnt lgkmcnt(4)
  v_mfma_f32_16x16x32_bf16 v[208:211], a[96:99], a[20:23], v[208:211]
  ds_read_b128 a[88:91], v1 offset:53248
  v_mfma_f32_16x16x32_bf16 v[212:215], a[96:99], v[52:55], v[212:215]
  s_lshl_b32 s41, s40, 9
  v_mfma_f32_16x16x32_bf16 v[216:219], a[100:103], a[20:23], v[216:219]
  ds_read_b128 a[92:95], v1 offset:54272
  v_mfma_f32_16x16x32_bf16 v[220:223], a[100:103], v[52:55], v[220:223]
  s_add_u32 s41, s41, 34603008
  s_waitcnt lgkmcnt(4)
  v_mfma_f32_16x16x32_bf16 v[208:211], a[72:75], a[24:27], v[208:211]
  ds_read_b128 a[96:99], v4
  v_mfma_f32_16x16x32_bf16 v[212:215], a[72:75], v[56:59], v[212:215]
  s_add_u32 s41, s41, s42
  v_mfma_f32_16x16x32_bf16 v[216:219], a[76:79], a[24:27], v[216:219]
  ds_read_b128 a[100:103], v4 offset:1024
  v_mfma_f32_16x16x32_bf16 v[220:223], a[76:79], v[56:59], v[220:223]
  s_lshl_b32 s40, s40, 10
  s_waitcnt lgkmcnt(4)
  v_mfma_f32_16x16x32_bf16 v[208:211], a[80:83], a[28:31], v[208:211]
  ds_read_b128 a[72:75], v4 offset:2048
  v_mfma_f32_16x16x32_bf16 v[212:215], a[80:83], v[60:63], v[212:215]
  s_add_u32 s40, s40, 33554432
  v_mfma_f32_16x16x32_bf16 v[216:219], a[84:87], a[28:31], v[216:219]
  ds_read_b128 a[76:79], v4 offset:3072
  v_mfma_f32_16x16x32_bf16 v[220:223], a[84:87], v[60:63], v[220:223]
  s_add_u32 s40, s40, s42
  s_waitcnt lgkmcnt(4)
  v_mfma_f32_16x16x32_bf16 v[208:211], a[88:91], a[32:35], v[208:211]
  ds_read_b128 a[80:83], v4 offset:4096
  v_mfma_f32_16x16x32_bf16 v[212:215], a[88:91], v[64:67], v[212:215]
  v_add_u32 v23, s40, v1
  v_mfma_f32_16x16x32_bf16 v[216:219], a[92:95], a[32:35], v[216:219]
  ds_read_b128 a[84:87], v4 offset:5120
  v_mfma_f32_16x16x32_bf16 v[220:223], a[92:95], v[64:67], v[220:223]
  v_and_b32 v28, 3, v0
  s_waitcnt lgkmcnt(4)
  v_mfma_f32_16x16x32_bf16 v[208:211], a[96:99], a[36:39], v[208:211]
  ds_read_b128 a[88:91], v4 offset:6144
  v_mfma_f32_16x16x32_bf16 v[212:215], a[96:99], v[68:71], v[212:215]
  v_subrev_u32 v28, 1, v28
  v_mfma_f32_16x16x32_bf16 v[216:219], a[100:103], a[36:39], v[216:219]
  ds_read_b128 a[92:95], v4 offset:7168
  v_mfma_f32_16x16x32_bf16 v[220:223], a[100:103], v[68:71], v[220:223]
  v_max_i32 v28, 0, v28
  s_waitcnt lgkmcnt(4)
  v_mfma_f32_16x16x32_bf16 v[208:211], a[72:75], a[40:43], v[208:211]
  ds_read_b128 a[96:99], v4 offset:8192
  v_mfma_f32_16x16x32_bf16 v[212:215], a[72:75], v[72:75], v[212:215]
  v_lshrrev_b32 v29, 4, v0
  v_mfma_f32_16x16x32_bf16 v[216:219], a[76:79], a[40:43], v[216:219]
  ds_read_b128 a[100:103], v4 offset:9216
  v_mfma_f32_16x16x32_bf16 v[220:223], a[76:79], v[72:75], v[220:223]
  v_mad_u32_u24 v28, v29, 3, v28
  s_waitcnt lgkmcnt(4)
  v_mfma_f32_16x16x32_bf16 v[208:211], a[80:83], a[44:47], v[208:211]
  ds_read_b128 a[72:75], v4 offset:10240
  v_mfma_f32_16x16x32_bf16 v[212:215], a[80:83], v[76:79], v[212:215]
  v_lshl_add_u32 v28, v28, 4, s41
  v_mfma_f32_16x16x32_bf16 v[216:219], a[84:87], a[44:47], v[216:219]
  ds_read_b128 a[76:79], v4 offset:11264
  v_mfma_f32_16x16x32_bf16 v[220:223], a[84:87], v[76:79], v[220:223]
  v_mov_b32 v30, 1073741824
  s_waitcnt vmcnt(3)
  s_waitcnt lgkmcnt(4)
  v_mfma_f32_16x16x32_bf16 v[208:211], a[88:91], a[48:51], v[208:211]
  ds_read_b128 a[80:83], v4 offset:12288
  buffer_store_dword v7, v27, s[36:39], s12 offen sc1
  v_mfma_f32_16x16x32_bf16 v[212:215], a[88:91], v[80:83], v[212:215]
  s_cmp_lt_u32 s64, 2
  s_mov_b32 s42, 0xc200c2
  s_mov_b32 s43, 0xc200c2
  s_cmov_b32 s42, 0xd000d
  s_cmov_b32 s43, 0xd000d
  v_mfma_f32_16x16x32_bf16 v[216:219], a[92:95], a[48:51], v[216:219]
  ds_read_b128 a[84:87], v4 offset:13312
  v_mfma_f32_16x16x32_bf16 v[220:223], a[92:95], v[80:83], v[220:223]
  v_cndmask_b32 v24, v30, v28, s[42:43]
  s_waitcnt lgkmcnt(4)
  v_mfma_f32_16x16x32_bf16 v[208:211], a[96:99], a[52:55], v[208:211]
  ds_read_b128 a[88:91], v4 offset:14336
  v_mfma_f32_16x16x32_bf16 v[212:215], a[96:99], v[84:87], v[212:215]
  v_add_u32 v28, 192, v28
  v_mfma_f32_16x16x32_bf16 v[216:219], a[100:103], a[52:55], v[216:219]
  ds_read_b128 a[92:95], v4 offset:15360
  v_mfma_f32_16x16x32_bf16 v[220:223], a[100:103], v[84:87], v[220:223]
  v_and_b32 v29, 15, v0
  s_waitcnt lgkmcnt(4)
  v_mfma_f32_16x16x32_bf16 v[208:211], a[72:75], a[56:59], v[208:211]
  ds_read_b128 a[96:99], v4 offset:16384
  v_mfma_f32_16x16x32_bf16 v[212:215], a[72:75], v[88:91], v[212:215]
  v_lshl_add_u32 v29, v29, 4, s41
  v_mfma_f32_16x16x32_bf16 v[216:219], a[76:79], a[56:59], v[216:219]
  ds_read_b128 a[100:103], v4 offset:17408
  v_mfma_f32_16x16x32_bf16 v[220:223], a[76:79], v[88:91], v[220:223]
  v_add_u32 v29, 192, v29
  s_waitcnt lgkmcnt(4)
  v_mfma_f32_16x16x32_bf16 v[208:211], a[80:83], a[60:63], v[208:211]
  s_barrier
  ds_read_b128 a[72:75], v4 offset:18432
  v_mfma_f32_16x16x32_bf16 v[212:215], a[80:83], v[92:95], v[212:215]
  s_sub_u32 s68, s68, 5013376
  v_mfma_f32_16x16x32_bf16 v[216:219], a[84:87], a[60:63], v[216:219]
  ds_read_b128 a[76:79], v4 offset:19456
  s_mov_b64 s[42:43], 0
  s_add_u32 m0, s65, 36864
  v_mfma_f32_16x16x32_bf16 v[220:223], a[84:87], v[92:95], v[220:223]
  buffer_load_dwordx4 v12, s[20:23], s68 offen lds
  s_waitcnt lgkmcnt(4)
  v_mfma_f32_16x16x32_bf16 v[208:211], a[88:91], a[64:67], v[208:211]
  ds_read_b128 a[80:83], v4 offset:20480
  s_cmp_eq_u32 s64, 1
  s_cmov_b32 s42, 0xc2000d
  s_cmov_b32 s43, 0x0
  v_mfma_f32_16x16x32_bf16 v[212:215], a[88:91], v[96:99], v[212:215]
  v_mfma_f32_16x16x32_bf16 v[216:219], a[92:95], a[64:67], v[216:219]
  ds_read_b128 a[84:87], v4 offset:21504
  v_cndmask_b32 v25, v30, v28, s[42:43]
  s_add_u32 s68, s68, 293888
  v_mfma_f32_16x16x32_bf16 v[220:223], a[92:95], v[96:99], v[220:223]
  buffer_load_dwordx4 v12, s[20:23], s68 offen offset:1024 lds
  s_waitcnt lgkmcnt(4)
  v_mfma_f32_16x16x32_bf16 v[208:211], a[96:99], a[68:71], v[208:211]
  ds_read_b128 a[88:91], v4 offset:22528
  s_mov_b64 s[42:43], 0
  v_mfma_f32_16x16x32_bf16 v[212:215], a[96:99], v[100:103], v[212:215]
  v_mfma_f32_16x16x32_bf16 v[216:219], a[100:103], a[68:71], v[216:219]
  ds_read_b128 a[92:95], v4 offset:23552
  s_cmp_eq_u32 s64, 0
  s_cmov_b32 s42, 0xffff
  v_mfma_f32_16x16x32_bf16 v[220:223], a[100:103], v[100:103], v[220:223]
  s_add_u32 s68, s68, 293888
  buffer_load_dwordx4 v12, s[20:23], s68 offen offset:2048 lds
  s_waitcnt lgkmcnt(4)
  v_mfma_f32_16x16x32_bf16 v[224:227], a[72:75], a[0:3], 0
  ds_read_b128 a[96:99], v4 offset:24576
  s_cmp_eq_u32 s64, 2
  s_cmov_b32 s42, 0xffff0000
  v_mfma_f32_16x16x32_bf16 v[228:231], a[72:75], v[32:35], 0
  v_mfma_f32_16x16x32_bf16 v[224:227], a[76:79], a[4:7], v[224:227]
  ds_read_b128 a[100:103], v4 offset:25600
  v_cndmask_b32 v25, v25, v29, s[42:43]
  s_add_u32 s68, s68, 293888
  v_mfma_f32_16x16x32_bf16 v[228:231], a[76:79], v[36:39], v[228:231]
  buffer_load_dwordx4 v12, s[20:23], s68 offen offset:3072 lds
  s_waitcnt lgkmcnt(4)
  v_mfma_f32_16x16x32_bf16 v[224:227], a[80:83], a[8:11], v[224:227]
  ds_read_b128 a[72:75], v4 offset:26624
  s_bitcmp1_b32 s64, 0
  s_cselect_b64 s[42:43], -1, 0
  v_mfma_f32_16x16x32_bf16 v[228:231], a[80:83], v[40:43], v[228:231]
  s_add_u32 s68, s68, 297984
  v_mfma_f32_16x16x32_bf16 v[224:227], a[84:87], a[12:15], v[224:227]
  ds_read_b128 a[76:79], v4 offset:27648
  v_cndmask_b32 v28, v23, v24, s[42:43]
  s_add_u32 m0, s65, 40960
  v_mfma_f32_16x16x32_bf16 v[228:231], a[84:87], v[44:47], v[228:231]
  buffer_load_dwordx4 v12, s[20:23], s68 offen lds
  s_waitcnt lgkmcnt(4)
  v_mfma_f32_16x16x32_bf16 v[224:227], a[88:91], a[16:19], v[224:227]
  ds_read_b128 a[80:83], v4 offset:28672
  v_cndmask_b32 v24, v24, v23, s[42:43]
  v_mfma_f32_16x16x32_bf16 v[228:231], a[88:91], v[48:51], v[228:231]
  v_mfma_f32_16x16x32_bf16 v[224:227], a[92:95], a[20:23], v[224:227]
  ds_read_b128 a[84:87], v4 offset:29696
  v_mov_b32 v23, v28
  s_add_u32 s68, s68, 293888
  v_mfma_f32_16x16x32_bf16 v[228:231], a[92:95], v[52:55], v[228:231]
  buffer_load_dwordx4 v12, s[20:23], s68 offen offset:1024 lds
  s_waitcnt lgkmcnt(4)
  v_mfma_f32_16x16x32_bf16 v[224:227], a[96:99], a[24:27], v[224:227]
  ds_read_b128 a[88:91], v4 offset:30720
  v_accvgpr_read_b32 v28, a250
  v_mfma_f32_16x16x32_bf16 v[228:231], a[96:99], v[56:59], v[228:231]
  v_mfma_f32_16x16x32_bf16 v[224:227], a[100:103], a[28:31], v[224:227]
  ds_read_b128 a[92:95], v4 offset:31744
  v_accvgpr_read_b32 v29, a251
  s_add_u32 s68, s68, 293888
  v_mfma_f32_16x16x32_bf16 v[228:231], a[100:103], v[60:63], v[228:231]
  buffer_load_dwordx4 v12, s[20:23], s68 offen offset:2048 lds
  s_waitcnt lgkmcnt(4)
  v_mfma_f32_16x16x32_bf16 v[224:227], a[72:75], a[32:35], v[224:227]
  ds_read_b128 a[96:99], v4 offset:32768
  v_accvgpr_write_b32 a252, v28
  v_mfma_f32_16x16x32_bf16 v[228:231], a[72:75], v[64:67], v[228:231]
  v_mfma_f32_16x16x32_bf16 v[224:227], a[76:79], a[36:39], v[224:227]
  ds_read_b128 a[100:103], v4 offset:33792
  v_accvgpr_write_b32 a253, v29
  s_add_u32 s68, s68, 293888
  v_mfma_f32_16x16x32_bf16 v[228:231], a[76:79], v[68:71], v[228:231]
  buffer_load_dwordx4 v12, s[20:23], s68 offen offset:3072 lds
  s_waitcnt lgkmcnt(4)
  v_mfma_f32_16x16x32_bf16 v[224:227], a[80:83], a[40:43], v[224:227]
  ds_read_b128 a[72:75], v4 offset:34816
  v_and_b32 v26, 3, v0
  v_mfma_f32_16x16x32_bf16 v[228:231], a[80:83], v[72:75], v[228:231]
  s_add_u32 s68, s68, 297984
  v_mfma_f32_16x16x32_bf16 v[224:227], a[84:87], a[44:47], v[224:227]
  ds_read_b128 a[76:79], v4 offset:35840
  v_lshlrev_b32 v26, 2, v26
  s_add_u32 m0, s65, 45056
  v_mfma_f32_16x16x32_bf16 v[228:231], a[84:87], v[76:79], v[228:231]
  buffer_load_dwordx4 v12, s[20:23], s68 offen lds
  s_waitcnt lgkmcnt(4)
  v_mfma_f32_16x16x32_bf16 v[224:227], a[88:91], a[48:51], v[224:227]
  ds_read_b128 a[80:83], v4 offset:36864
  v_mfma_f32_16x16x32_bf16 v[228:231], a[88:91], v[80:83], v[228:231]
  v_mfma_f32_16x16x32_bf16 v[224:227], a[92:95], a[52:55], v[224:227]
  ds_read_b128 a[84:87], v4 offset:37888
  v_mfma_f32_16x16x32_bf16 v[228:231], a[92:95], v[84:87], v[228:231]
  s_waitcnt lgkmcnt(4)
  v_mfma_f32_16x16x32_bf16 v[224:227], a[96:99], a[56:59], v[224:227]
  ds_read_b128 a[88:91], v4 offset:38912
  buffer_load_dword v31, v16, s[36:39], 0 offen sc1
  v_mfma_f32_16x16x32_bf16 v[228:231], a[96:99], v[88:91], v[228:231]
  v_mfma_f32_16x16x32_bf16 v[224:227], a[100:103], a[60:63], v[224:227]
  ds_read_b128 a[92:95], v4 offset:39936
  v_mfma_f32_16x16x32_bf16 v[228:231], a[100:103], v[92:95], v[228:231]
  s_waitcnt lgkmcnt(4)
  v_mfma_f32_16x16x32_bf16 v[224:227], a[72:75], a[64:67], v[224:227]
  ds_read_b128 a[96:99], v4 offset:40960
  v_mfma_f32_16x16x32_bf16 v[228:231], a[72:75], v[96:99], v[228:231]
  v_mfma_f32_16x16x32_bf16 v[224:227], a[76:79], a[68:71], v[224:227]
  ds_read_b128 a[100:103], v4 offset:41984
  v_mfma_f32_16x16x32_bf16 v[228:231], a[76:79], v[100:103], v[228:231]
  s_waitcnt lgkmcnt(4)
  v_mfma_f32_16x16x32_bf16 v[232:235], a[80:83], a[0:3], 0
  ds_read_b128 a[72:75], v4 offset:43008
  v_mfma_f32_16x16x32_bf16 v[236:239], a[80:83], v[32:35], 0
  v_mfma_f32_16x16x32_bf16 v[152:155], a[84:87], a[0:3], 0
  ds_read_b128 a[76:79], v4 offset:44032
  v_mfma_f32_16x16x32_bf16 v[156:159], a[84:87], v[32:35], 0
  v_mul_f32 v28, 0x3fb8aa3b, v5
  v_max3_f32 v29, v248, v249, v250
  v_max3_f32 v29, v29, v251, v240
  v_max3_f32 v29, v29, v241, v242
  s_waitcnt lgkmcnt(4)
  v_mfma_f32_16x16x32_bf16 v[232:235], a[88:91], a[4:7], v[232:235]
  ds_read_b128 a[80:83], v4 offset:45056
  v_max3_f32 v29, v29, v243, v208
  v_max3_f32 v29, v29, v209, v210
  v_max3_f32 v29, v29, v211, v216
  v_max3_f32 v29, v29, v217, v218
  v_mfma_f32_16x16x32_bf16 v[236:239], a[88:91], v[36:39], v[236:239]
  v_max3_f32 v29, v29, v219, v224
  v_max_f32 v29, v29, v225
  v_min3_f32 v30, v248, v249, v250
  v_min3_f32 v30, v30, v251, v240
  v_min3_f32 v30, v30, v241, v242
  v_mfma_f32_16x16x32_bf16 v[152:155], a[92:95], a[4:7], v[152:155]
  ds_read_b128 a[84:87], v4 offset:46080
  v_min3_f32 v30, v30, v243, v208
  v_min3_f32 v30, v30, v209, v210
  v_min3_f32 v30, v30, v211, v216
  v_min3_f32 v30, v30, v217, v218
  v_mfma_f32_16x16x32_bf16 v[156:159], a[92:95], v[36:39], v[156:159]
  v_min3_f32 v30, v30, v219, v224
  v_min_f32 v30, v30, v225
  v_mul_f32 v29, v29, v28
  v_mul_f32 v30, v30, v28
  s_waitcnt lgkmcnt(4)
  v_mfma_f32_16x16x32_bf16 v[232:235], a[96:99], a[8:11], v[232:235]
  ds_read_b128 a[88:91], v4 offset:47104
  v_fma_f32 v160, v248, v28, -v29
  v_fma_f32 v248, -v248, v28, v30
  v_fma_f32 v161, v249, v28, -v29
  v_fma_f32 v249, -v249, v28, v30
  v_mfma_f32_16x16x32_bf16 v[236:239], a[96:99], v[40:43], v[236:239]
  v_fma_f32 v162, v250, v28, -v29
  v_fma_f32 v250, -v250, v28, v30
  v_fma_f32 v163, v251, v28, -v29
  v_fma_f32 v251, -v251, v28, v30
  v_fma_f32 v164, v240, v28, -v29
  v_mfma_f32_16x16x32_bf16 v[152:155], a[100:103], a[8:11], v[152:155]
  ds_read_b128 a[92:95], v4 offset:48128
  v_fma_f32 v240, -v240, v28, v30
  v_fma_f32 v165, v241, v28, -v29
  v_fma_f32 v241, -v241, v28, v30
  v_fma_f32 v166, v242, v28, -v29
  v_mfma_f32_16x16x32_bf16 v[156:159], a[100:103], v[40:43], v[156:159]
  v_fma_f32 v242, -v242, v28, v30
  v_fma_f32 v167, v243, v28, -v29
  v_fma_f32 v243, -v243, v28, v30
  v_fma_f32 v168, v208, v28, -v29
  s_waitcnt lgkmcnt(4)
  v_mfma_f32_16x16x32_bf16 v[232:235], a[72:75], a[12:15], v[232:235]
  ds_read_b128 a[96:99], v4 offset:49152
  v_fma_f32 v208, -v208, v28, v30
  v_fma_f32 v169, v209, v28, -v29
  v_fma_f32 v209, -v209, v28, v30
  v_fma_f32 v170, v210, v28, -v29
  v_mfma_f32_16x16x32_bf16 v[236:239], a[72:75], v[44:47], v[236:239]
  v_fma_f32 v210, -v210, v28, v30
  v_fma_f32 v171, v211, v28, -v29
  v_fma_f32 v211, -v211, v28, v30
  v_fma_f32 v172, v216, v28, -v29
  v_fma_f32 v216, -v216, v28, v30
  v_mfma_f32_16x16x32_bf16 v[152:155], a[76:79], a[12:15], v[152:155]
  ds_read_b128 a[100:103], v4 offset:50176
  v_fma_f32 v173, v217, v28, -v29
  v_fma_f32 v217, -v217, v28, v30
  v_fma_f32 v174, v218, v28, -v29
  v_fma_f32 v218, -v218, v28, v30
  v_mfma_f32_16x16x32_bf16 v[156:159], a[76:79], v[44:47], v[156:159]
  v_fma_f32 v175, v219, v28, -v29
  v_fma_f32 v219, -v219, v28, v30
  v_fma_f32 v14, v224, v28, -v29
  v_fma_f32 v224, -v224, v28, v30
  s_waitcnt lgkmcnt(4)
  v_mfma_f32_16x16x32_bf16 v[232:235], a[80:83], a[16:19], v[232:235]
  ds_read_b128 a[72:75], v4 offset:51200
  v_fma_f32 v15, v225, v28, -v29
  v_fma_f32 v225, -v225, v28, v30
  v_exp_f32 v160, v160
  v_mfma_f32_16x16x32_bf16 v[236:239], a[80:83], v[48:51], v[236:239]
  v_exp_f32 v248, v248
  v_exp_f32 v161, v161
  v_exp_f32 v249, v249
  v_mfma_f32_16x16x32_bf16 v[152:155], a[84:87], a[16:19], v[152:155]
  ds_read_b128 a[76:79], v4 offset:52224
  v_exp_f32 v162, v162
  v_exp_f32 v250, v250
  v_mfma_f32_16x16x32_bf16 v[156:159], a[84:87], v[48:51], v[156:159]
  v_exp_f32 v163, v163
  v_exp_f32 v251, v251
  s_waitcnt lgkmcnt(4)
  v_mfma_f32_16x16x32_bf16 v[232:235], a[88:91], a[20:23], v[232:235]
  ds_read_b128 a[80:83], v4 offset:53248
  v_exp_f32 v164, v164
  v_exp_f32 v240, v240
  v_mfma_f32_16x16x32_bf16 v[236:239], a[88:91], v[52:55], v[236:239]
  v_exp_f32 v165, v165
  v_exp_f32 v241, v241
  v_exp_f32 v166, v166
  v_mfma_f32_16x16x32_bf16 v[152:155], a[92:95], a[20:23], v[152:155]
  ds_read_b128 a[84:87], v4 offset:54272
  s_waitcnt vmcnt(0)
  v_cmp_ne_u32 vcc, v7, v31
  s_cbranch_vccz L_ok3
  s_mov_b32 s83, 0x8000
L_spin3:
  buffer_load_dword v31, v16, s[36:39], 0 offen sc1
  s_waitcnt vmcnt(0)
  v_cmp_ne_u32 vcc, v7, v31
  s_cbranch_vccz L_ok3
  s_sub_u32 s83, s83, 1
  s_cbranch_scc0 L_spin3
  buffer_store_dword v1, off, s[32:35], 0 offset:40 sc1
  s_waitcnt vmcnt(0)
L_ok3:
  v_mfma_f32_16x16x32_bf16 v[156:159], a[92:95], v[52:55], v[156:159]
  v_exp_f32 v242, v242
  v_exp_f32 v167, v167
  s_add_u32 s10, s9, 160768
  s_waitcnt lgkmcnt(4)
  v_mfma_f32_16x16x32_bf16 v[232:235], a[96:99], a[24:27], v[232:235]
  s_barrier
  ds_read_b128 a[88:91], v1
  v_exp_f32 v243, v243
  v_exp_f32 v168, v168
  buffer_load_dwordx4 a[244:247], v1, s[36:39], s10 offen sc1
  v_mfma_f32_16x16x32_bf16 v[236:239], a[96:99], v[56:59], v[236:239]
  v_exp_f32 v208, v208
  v_exp_f32 v169, v169
  v_exp_f32 v209, v209
  s_add_u32 s68, s68, 294912
  s_add_u32 m0, s65, 73728
  v_mfma_f32_16x16x32_bf16 v[152:155], a[100:103], a[24:27], v[152:155]
  ds_read_b128 a[92:95], v1 offset:1024
  v_exp_f32 v170, v170
  v_exp_f32 v210, v210
  buffer_load_dwordx4 v12, s[20:23], s68 offen lds
  v_mfma_f32_16x16x32_bf16 v[156:159], a[100:103], v[56:59], v[156:159]
  v_exp_f32 v171, v171
  v_exp_f32 v211, v211
  s_add_u32 s68, s68, 293888
  s_waitcnt lgkmcnt(4)
  v_mfma_f32_16x16x32_bf16 v[232:235], a[72:75], a[28:31], v[232:235]
  ds_read_b128 a[96:99], v1 offset:2048
  v_exp_f32 v172, v172
  v_exp_f32 v216, v216
  buffer_load_dwordx4 v12, s[20:23], s68 offen offset:1024 lds
  v_mfma_f32_16x16x32_bf16 v[236:239], a[72:75], v[60:63], v[236:239]
  v_exp_f32 v173, v173
  v_exp_f32 v217, v217
  v_exp_f32 v174, v174
  s_add_u32 s68, s68, 293888
  v_mfma_f32_16x16x32_bf16 v[152:155], a[76:79], a[28:31], v[152:155]
  ds_read_b128 a[100:103], v1 offset:3072
  v_exp_f32 v218, v218
  v_exp_f32 v175, v175
  buffer_load_dwordx4 v12, s[20:23], s68 offen offset:2048 lds
  v_mfma_f32_16x16x32_bf16 v[156:159], a[76:79], v[60:63], v[156:159]
  v_exp_f32 v219, v219
  v_exp_f32 v14, v14
  s_add_u32 s68, s68, 293888
  s_waitcnt lgkmcnt(4)
  v_mfma_f32_16x16x32_bf16 v[232:235], a[80:83], a[32:35], v[232:235]
  ds_read_b128 a[72:75], v1 offset:4096
  v_exp_f32 v224, v224
  v_exp_f32 v15, v15
  buffer_load_dwordx4 v12, s[20:23], s68 offen offset:3072 lds
  v_mfma_f32_16x16x32_bf16 v[236:239], a[80:83], v[64:67], v[236:239]
  v_exp_f32 v225, v225
  v_add_f32 v29, v160, v161
  v_add_f32 v30, v248, v249
  v_add_f32 v29, v29, v162
  s_add_u32 s68, s68, 297984
  s_add_u32 m0, s65, 77824
  v_mfma_f32_16x16x32_bf16 v[152:155], a[84:87], a[32:35], v[152:155]
  ds_read_b128 a[76:79], v1 offset:5120
  v_add_f32 v30, v30, v250
  v_add_f32 v29, v29, v163
  v_add_f32 v30, v30, v251
  v_add_f32 v29, v29, v164
  buffer_load_dwordx4 v12, s[20:23], s68 offen lds
  v_mfma_f32_16x16x32_bf16 v[156:159], a[84:87], v[64:67], v[156:159]
  v_add_f32 v30, v30, v240
  v_add_f32 v29, v29, v165
  v_add_f32 v30, v30, v241
  v_add_f32 v29, v29, v166
  s_add_u32 s68, s68, 293888
  s_waitcnt lgkmcnt(4)
  v_mfma_f32_16x16x32_bf16 v[232:235], a[88:91], a[36:39], v[232:235]
  ds_read_b128 a[80:83], v1 offset:6144
  v_add_f32 v30, v30, v242
  v_add_f32 v29, v29, v167
  v_add_f32 v30, v30, v243
  v_add_f32 v29, v29, v168
  buffer_load_dwordx4 v12, s[20:23], s68 offen offset:1024 lds
  v_mfma_f32_16x16x32_bf16 v[236:239], a[88:91], v[68:71], v[236:239]
  v_add_f32 v30, v30, v208
  v_add_f32 v29, v29, v169
  v_add_f32 v30, v30, v209
  v_add_f32 v29, v29, v170
  v_add_f32 v30, v30, v210
  s_add_u32 s68, s68, 293888
  v_mfma_f32_16x16x32_bf16 v[152:155], a[92:95], a[36:39], v[152:155]
  ds_read_b128 a[84:87], v1 offset:7168
  v_add_f32 v29, v29, v171
  v_add_f32 v30, v30, v211
  v_add_f32 v29, v29, v172
  v_add_f32 v30, v30, v216
  buffer_load_dwordx4 v12, s[20:23], s68 offen offset:2048 lds
  v_mfma_f32_16x16x32_bf16 v[156:159], a[92:95], v[68:71], v[156:159]
  v_add_f32 v29, v29, v173
  v_add_f32 v30, v30, v217
  v_add_f32 v29, v29, v174
  v_add_f32 v30, v30, v218
  s_add_u32 s68, s68, 293888
  s_waitcnt lgkmcnt(4)
  v_mfma_f32_16x16x32_bf16 v[232:235], a[96:99], a[40:43], v[232:235]
  ds_read_b128 a[88:91], v1 offset:8192
  v_add_f32 v29, v29, v175
  v_add_f32 v30, v30, v219
  v_add_f32 v29, v29, v14
  v_add_f32 v30, v30, v224
L_pg4:
  s_cbranch_execz L_pg8
  buffer_load_dwordx4 v12, s[20:23], s68 offen offset:3072 lds
  s_add_u32 s68, s68, 297984
  v_mfma_f32_16x16x32_bf16 v[236:239], a[96:99], v[72:75], v[236:239]
  v_add_f32 v29, v29, v15
  v_add_f32 v30, v30, v225
  v_rcp_f32 v29, v29
  v_rcp_f32 v30, v30
  s_add_u32 m0, s65, 81920
  v_mfma_f32_16x16x32_bf16 v[152:155], a[100:103], a[40:43], v[152:155]
  ds_read_b128 a[92:95], v1 offset:9216
  v_mul_f32 v160, v29, v160
  v_mul_f32 v248, v30, v248
  v_mul_f32 v161, v29, v161
  v_mul_f32 v249, v30, v249
  buffer_load_dwordx4 v12, s[20:23], s68 offen lds
  v_mfma_f32_16x16x32_bf16 v[156:159], a[100:103], v[72:75], v[156:159]
  v_mul_f32 v162, v29, v162
  v_mul_f32 v250, v30, v250
  v_mul_f32 v163, v29, v163
  v_mul_f32 v251, v30, v251
  s_add_u32 s10, s9, 151552
  s_waitcnt lgkmcnt(4)
  v_mfma_f32_16x16x32_bf16 v[232:235], a[72:75], a[44:47], v[232:235]
  ds_read_b128 a[96:99], v1 offset:10240
  v_mul_f32 v164, v29, v164
  v_mul_f32 v240, v30, v240
  v_mul_f32 v165, v29, v165
  v_mul_f32 v241, v30, v241
  buffer_load_dwordx4 a[240:243], v1, s[36:39], s10 offen sc1
  v_mfma_f32_16x16x32_bf16 v[236:239], a[72:75], v[76:79], v[236:239]
  v_mul_f32 v166, v29, v166
  v_mul_f32 v242, v30, v242
  v_mul_f32 v167, v29, v167
  v_mul_f32 v243, v30, v243
  v_mul_f32 v168, v29, v168
  s_add_u32 s10, s9, 142336
  v_mfma_f32_16x16x32_bf16 v[152:155], a[76:79], a[44:47], v[152:155]
  ds_read_b128 a[100:103], v1 offset:11264
  v_mul_f32 v208, v30, v208
  v_mul_f32 v169, v29, v169
  v_mul_f32 v209, v30, v209
  v_mul_f32 v170, v29, v170
  buffer_load_dwordx4 a[236:239], v1, s[36:39], s10 offen sc1
  v_mfma_f32_16x16x32_bf16 v[156:159], a[76:79], v[76:79], v[156:159]
  v_mul_f32 v210, v30, v210
  v_mul_f32 v171, v29, v171
  v_mul_f32 v211, v30, v211
  v_mul_f32 v172, v29, v172
  s_add_u32 s10, s9, 133120
  s_waitcnt lgkmcnt(4)
  v_mfma_f32_16x16x32_bf16 v[232:235], a[80:83], a[48:51], v[232:235]
  ds_read_b128 a[72:75], v1 offset:12288
  v_mul_f32 v216, v30, v216
  v_mul_f32 v173, v29, v173
  v_mul_f32 v217, v30, v217
  v_mul_f32 v174, v29, v174
  buffer_load_dwordx4 a[232:235], v1, s[36:39], s10 offen sc1
  v_mfma_f32_16x16x32_bf16 v[236:239], a[80:83], v[80:83], v[236:239]
  v_mul_f32 v218, v30, v218
  v_mul_f32 v175, v29, v175
  v_mul_f32 v219, v30, v219
  v_mul_f32 v14, v29, v14
  v_mul_f32 v224, v30, v224
  s_add_u32 s10, s9, 123904
  v_mfma_f32_16x16x32_bf16 v[152:155], a[84:87], a[48:51], v[152:155]
  ds_read_b128 a[76:79], v1 offset:13312
  v_mul_f32 v15, v29, v15
  v_mul_f32 v225, v30, v225
  v_cvt_pk_bf16_f32 v160, v160, v161
  v_cvt_pk_bf16_f32 v161, v162, v163
  buffer_load_dwordx4 a[228:231], v1, s[36:39], s10 offen sc1
  v_mfma_f32_16x16x32_bf16 v[156:159], a[84:87], v[80:83], v[156:159]
  ds_write_b64 v17, v[160:161]
  v_cvt_pk_bf16_f32 v162, v164, v165
  v_cvt_pk_bf16_f32 v163, v166, v167
  ds_write_b64 v17, v[162:163] offset:8
  s_add_u32 s10, s9, 114688
  s_waitcnt lgkmcnt(6)
  v_mfma_f32_16x16x32_bf16 v[232:235], a[88:91], a[52:55], v[232:235]
  ds_read_b128 a[80:83], v1 offset:14336
  v_cvt_pk_bf16_f32 v164, v168, v169
  v_cvt_pk_bf16_f32 v165, v170, v171
  ds_write_b64 v17, v[164:165] offset:16
  v_cvt_pk_bf16_f32 v166, v172, v173
  buffer_load_dwordx4 a[224:227], v1, s[36:39], s10 offen sc1
  v_mfma_f32_16x16x32_bf16 v[236:239], a[88:91], v[84:87], v[236:239]
  v_cvt_pk_bf16_f32 v167, v174, v175
  ds_write_b64 v17, v[166:167] offset:24
  v_cvt_pk_bf16_f32 v168, v14, v15
  v_cvt_pk_bf16_f32 v169, v248, v249
  ds_write_b64 v17, v[168:169] offset:32
  s_add_u32 s10, s9, 105472
  v_mfma_f32_16x16x32_bf16 v[152:155], a[92:95], a[52:55], v[152:155]
  ds_read_b128 a[84:87], v1 offset:15360
  v_cvt_pk_bf16_f32 v170, v250, v251
  v_cvt_pk_bf16_f32 v171, v240, v241
  ds_write_b64 v17, v[170:171] offset:40
  v_cvt_pk_bf16_f32 v172, v242, v243
  buffer_load_dwordx4 a[220:223], v1, s[36:39], s10 offen sc1
  v_mfma_f32_16x16x32_bf16 v[156:159], a[92:95], v[84:87], v[156:159]
  v_cvt_pk_bf16_f32 v173, v208, v209
  ds_write_b64 v17, v[172:173] offset:48
  v_cvt_pk_bf16_f32 v174, v210, v211
  v_cvt_pk_bf16_f32 v175, v216, v217
  s_add_u32 s10, s9, 96256
  s_waitcnt lgkmcnt(11)
  v_mfma_f32_16x16x32_bf16 v[232:235], a[96:99], a[56:59], v[232:235]
  ds_read_b128 a[88:91], v1 offset:16384
  ds_write_b64 v17, v[174:175] offset:56
  v_cvt_pk_bf16_f32 v14, v218, v219
  v_cvt_pk_bf16_f32 v15, v224, v225
  ds_write_b64 v17, v[14:15] offset:64
  buffer_load_dwordx4 a[216:219], v1, s[36:39], s10 offen sc1
  v_mfma_f32_16x16x32_bf16 v[236:239], a[96:99], v[88:91], v[236:239]
  v_mul_f32 v28, 0x3fb8aa3b, v6
  v_max3_f32 v29, v252, v253, v254
  v_max3_f32 v29, v29, v255, v244
  v_max3_f32 v29, v29, v245, v246
  v_max3_f32 v29, v29, v247, v212
  s_add_u32 s10, s9, 87040
  v_mfma_f32_16x16x32_bf16 v[152:155], a[100:103], a[56:59], v[152:155]
  ds_read_b128 a[92:95], v1 offset:17408
  v_max3_f32 v29, v29, v213, v214
  v_max3_f32 v29, v29, v215, v220
  v_max3_f32 v29, v29, v221, v222
  v_max3_f32 v29, v29, v223, v228
  buffer_load_dwordx4 a[212:215], v1, s[36:39], s10 offen sc1
  v_mfma_f32_16x16x32_bf16 v[156:159], a[100:103], v[88:91], v[156:159]
  v_subrev_u32 v2, 73728, v2
  v_max_f32 v29, v29, v229
  v_min3_f32 v30, v252, v253, v254
  v_min3_f32 v30, v30, v255, v244
  s_waitcnt lgkmcnt(13)
  v_mfma_f32_16x16x32_bf16 v[232:235], a[72:75], a[60:63], v[232:235]
  s_barrier
  ds_read_b64_tr_b16 a[96:97], v2 offset:36864
  v_min3_f32 v30, v30, v245, v246
  v_min3_f32 v30, v30, v247, v212
  v_min3_f32 v30, v30, v213, v214
  s_add_u32 s10, s9, 77824
  v_mfma_f32_16x16x32_bf16 v[236:239], a[72:75], v[92:95], v[236:239]
  ds_read_b64_tr_b16 a[98:99], v2 offset:55296
  v_subrev_u32 v3, 73728, v3
  v_min3_f32 v30, v30, v215, v220
  v_min3_f32 v30, v30, v221, v222
  v_min3_f32 v30, v30, v223, v228
  buffer_load_dwordx4 a[208:211], v1, s[36:39], s10 offen sc1
  v_mfma_f32_16x16x32_bf16 v[152:155], a[76:79], a[60:63], v[152:155]
  ds_read_b64_tr_b16 a[100:101], v3 offset:36864
  v_min_f32 v30, v30, v229
  v_mul_f32 v29, v29, v28
  v_mul_f32 v30, v30, v28
  v_fma_f32 v160, v252, v28, -v29
  v_mfma_f32_16x16x32_bf16 v[156:159], a[76:79], v[92:95], v[156:159]
  ds_read_b64_tr_b16 a[102:103], v3 offset:55296
  v_subrev_u32 v8, 73728, v8
  v_fma_f32 v252, -v252, v28, v30
  v_fma_f32 v161, v253, v28, -v29
  buffer_load_dword v31, v26, s[36:39], s11 offen sc1
  s_waitcnt lgkmcnt(10)
  v_mfma_f32_16x16x32_bf16 v[232:235], a[80:83], a[64:67], v[232:235]
  ds_read_b64_tr_b16 a[72:73], v8 offset:36864
  v_fma_f32 v253, -v253, v28, v30
  v_fma_f32 v162, v254, v28, -v29
  v_fma_f32 v254, -v254, v28, v30
  v_fma_f32 v163, v255, v28, -v29
  s_sub_u32 s68, s68, 5013888
  s_add_u32 m0, s65, 0
  v_mfma_f32_16x16x32_bf16 v[236:239], a[80:83], v[96:99], v[236:239]
  ds_read_b64_tr_b16 a[74:75], v8 offset:55296
  v_subrev_u32 v9, 73728, v9
  v_fma_f32 v255, -v255, v28, v30
  v_fma_f32 v164, v244, v28, -v29
  v_fma_f32 v244, -v244, v28, v30
  buffer_load_dwordx4 v13, s[20:23], s68 offen lds
  v_mfma_f32_16x16x32_bf16 v[152:155], a[84:87], a[64:67], v[152:155]
  ds_read_b64_tr_b16 a[76:77], v9 offset:36864
  v_fma_f32 v165, v245, v28, -v29
  v_fma_f32 v245, -v245, v28, v30
  v_fma_f32 v166, v246, v28, -v29
  v_fma_f32 v246, -v246, v28, v30
  s_add_u32 s68, s68, 588800
  v_mfma_f32_16x16x32_bf16 v[156:159], a[84:87], v[96:99], v[156:159]
  ds_read_b64_tr_b16 a[78:79], v9 offset:55296
  v_fma_f32 v167, v247, v28, -v29
  v_fma_f32 v247, -v247, v28, v30
  v_fma_f32 v168, v212, v28, -v29
  buffer_load_dwordx4 v13, s[20:23], s68 offen offset:1024 lds
  s_waitcnt lgkmcnt(8)
  v_mfma_f32_16x16x32_bf16 v[232:235], a[88:91], a[68:71], v[232:235]
  ds_read_b64_tr_b16 a[80:81], v2 offset:37888
  v_fma_f32 v212, -v212, v28, v30
  v_fma_f32 v169, v213, v28, -v29
  v_fma_f32 v213, -v213, v28, v30
  v_fma_f32 v170, v214, v28, -v29
  s_add_u32 s68, s68, 588800
  v_mfma_f32_16x16x32_bf16 v[236:239], a[88:91], v[100:103], v[236:239]
  ds_read_b64_tr_b16 a[82:83], v2 offset:56320
  v_fma_f32 v214, -v214, v28, v30
  v_fma_f32 v171, v215, v28, -v29
  v_fma_f32 v215, -v215, v28, v30
  v_fma_f32 v172, v220, v28, -v29
  buffer_load_dwordx4 v13, s[20:23], s68 offen offset:2048 lds
  v_mfma_f32_16x16x32_bf16 v[152:155], a[92:95], a[68:71], v[152:155]
  ds_read_b64_tr_b16 a[84:85], v3 offset:37888
  v_fma_f32 v220, -v220, v28, v30
  v_fma_f32 v173, v221, v28, -v29
  v_fma_f32 v221, -v221, v28, v30
  v_fma_f32 v174, v222, v28, -v29
  s_add_u32 s68, s68, 588800
  v_mfma_f32_16x16x32_bf16 v[156:159], a[92:95], v[100:103], v[156:159]
  ds_read_b64_tr_b16 a[86:87], v3 offset:56320
  v_fma_f32 v222, -v222, v28, v30
  v_fma_f32 v175, v223, v28, -v29
  v_fma_f32 v223, -v223, v28, v30
  buffer_load_dwordx4 v13, s[20:23], s68 offen offset:3072 lds
  s_waitcnt lgkmcnt(8)
  v_mfma_f32_16x16x32_bf16 v[176:179], a[96:99], a[0:3], 0
  ds_read_b64_tr_b16 a[88:89], v8 offset:37888
  v_fma_f32 v14, v228, v28, -v29
  v_fma_f32 v228, -v228, v28, v30
  v_fma_f32 v15, v229, v28, -v29
  v_fma_f32 v229, -v229, v28, v30
  s_add_u32 s68, s68, 592896
  s_add_u32 m0, s65, 4096
  v_mfma_f32_16x16x32_bf16 v[180:183], a[96:99], v[32:35], 0
  ds_read_b64_tr_b16 a[90:91], v8 offset:56320
  v_exp_f32 v160, v160
  v_exp_f32 v252, v252
  buffer_load_dwordx4 v13, s[20:23], s68 offen lds
  v_mfma_f32_16x16x32_bf16 v[184:187], a[100:103], a[0:3], 0
  ds_read_b64_tr_b16 a[92:93], v9 offset:37888
  v_exp_f32 v161, v161
  v_exp_f32 v253, v253
  s_add_u32 s10, s9, 68608
  v_mfma_f32_16x16x32_bf16 v[188:191], a[100:103], v[32:35], 0
  ds_read_b64_tr_b16 a[94:95], v9 offset:56320
  v_exp_f32 v162, v162
  v_exp_f32 v254, v254
  buffer_load_dwordx4 a[204:207], v1, s[36:39], s10 offen sc1
  s_waitcnt lgkmcnt(8)
  v_mfma_f32_16x16x32_bf16 v[192:195], a[72:75], a[0:3], 0
  ds_read_b64_tr_b16 a[96:97], v2 offset:38912
  v_exp_f32 v163, v163
  v_exp_f32 v255, v255
  s_add_u32 s68, s68, 588800
  v_mfma_f32_16x16x32_bf16 v[196:199], a[72:75], v[32:35], 0
  ds_read_b64_tr_b16 a[98:99], v2 offset:57344
  v_exp_f32 v164, v164
  v_exp_f32 v244, v244
  buffer_load_dwordx4 v13, s[20:23], s68 offen offset:1024 lds
  v_mfma_f32_16x16x32_bf16 v[200:203], a[76:79], a[0:3], 0
  ds_read_b64_tr_b16 a[100:101], v3 offset:38912
  v_exp_f32 v165, v165
  v_exp_f32 v245, v245
  s_add_u32 s10, s9, 59392
  v_mfma_f32_16x16x32_bf16 v[204:207], a[76:79], v[32:35], 0
  ds_read_b64_tr_b16 a[102:103], v3 offset:57344
  v_exp_f32 v166, v166
  v_exp_f32 v246, v246
  buffer_load_dwordx4 a[200:203], v1, s[36:39], s10 offen sc1
  s_waitcnt lgkmcnt(8)
  v_mfma_f32_16x16x32_bf16 v[176:179], a[80:83], a[4:7], v[176:179]
  ds_read_b64_tr_b16 a[72:73], v8 offset:38912
  v_exp_f32 v167, v167
  v_exp_f32 v247, v247
  s_add_u32 s68, s68, 588800
  v_mfma_f32_16x16x32_bf16 v[180:183], a[80:83], v[36:39], v[180:183]
  ds_read_b64_tr_b16 a[74:75], v8 offset:57344
  v_exp_f32 v168, v168
  v_exp_f32 v212, v212
  buffer_load_dwordx4 v13, s[20:23], s68 offen offset:2048 lds
  v_mfma_f32_16x16x32_bf16 v[184:187], a[84:87], a[4:7], v[184:187]
  ds_read_b64_tr_b16 a[76:77], v9 offset:38912
  v_exp_f32 v169, v169
  v_exp_f32 v213, v213
  s_add_u32 s10, s9, 50176
  v_mfma_f32_16x16x32_bf16 v[188:191], a[84:87], v[36:39], v[188:191]
  ds_read_b64_tr_b16 a[78:79], v9 offset:57344
  v_exp_f32 v170, v170
  v_exp_f32 v214, v214
  buffer_load_dwordx4 a[196:199], v1, s[36:39], s10 offen sc1
  s_waitcnt lgkmcnt(8)
  v_mfma_f32_16x16x32_bf16 v[192:195], a[88:91], a[4:7], v[192:195]
  ds_read_b64_tr_b16 a[80:81], v2 offset:39936
  v_exp_f32 v171, v171
  v_exp_f32 v215, v215
  s_add_u32 s68, s68, 588800
  v_mfma_f32_16x16x32_bf16 v[196:199], a[88:91], v[36:39], v[196:199]
  ds_read_b64_tr_b16 a[82:83], v2 offset:58368
  v_exp_f32 v172, v172
  v_exp_f32 v220, v220
  buffer_load_dwordx4 v13, s[20:23], s68 offen offset:3072 lds
  v_mfma_f32_16x16x32_bf16 v[200:203], a[92:95], a[4:7], v[200:203]
  ds_read_b64_tr_b16 a[84:85], v3 offset:39936
  v_exp_f32 v173, v173
  v_exp_f32 v221, v221
  s_add_u32 s10, s9, 40960
  v_mfma_f32_16x16x32_bf16 v[204:207], a[92:95], v[36:39], v[204:207]
  ds_read_b64_tr_b16 a[86:87], v3 offset:58368
  v_exp_f32 v174, v174
  v_exp_f32 v222, v222
  buffer_load_dwordx4 a[192:195], v1, s[36:39], s10 offen sc1
  s_add_u32 s68, s68, 592896
  s_waitcnt lgkmcnt(8)
  v_mfma_f32_16x16x32_bf16 v[176:179], a[96:99], a[8:11], v[176:179]
  ds_read_b64_tr_b16 a[88:89], v8 offset:39936
  v_exp_f32 v175, v175
  v_exp_f32 v223, v223
  s_waitcnt vmcnt(12)
  v_cmp_ne_u32 vcc, v7, v31
  s_cbranch_vccz L_ok4
  s_mov_b32 s83, 0x8000
L_spin4:
  buffer_load_dword v31, v26, s[36:39], s11 offen sc1
  s_waitcnt vmcnt(0)
  v_cmp_ne_u32 vcc, v7, v31
  s_cbranch_vccz L_ok4
  s_sub_u32 s83, s83, 1
  s_cbranch_scc0 L_spin4
  buffer_store_dword v1, off, s[32:35], 0 offset:24 sc1
  s_waitcnt vmcnt(0)
L_ok4:
  v_mfma_f32_16x16x32_bf16 v[180:183], a[96:99], v[40:43], v[180:183]
  ds_read_b64_tr_b16 a[90:91], v8 offset:58368
  v_exp_f32 v14, v14
  v_exp_f32 v228, v228
  s_add_u32 m0, s65, 8192
  s_nop 0
  buffer_load_dwordx4 v13, s[20:23], s68 offen lds
  v_mfma_f32_16x16x32_bf16 v[184:187], a[100:103], a[8:11], v[184:187]
  ds_read_b64_tr_b16 a[92:93], v9 offset:39936
  v_exp_f32 v15, v15
  v_exp_f32 v229, v229
  v_mfma_f32_16x16x32_bf16 v[188:191], a[100:103], v[40:43], v[188:191]
  ds_read_b64_tr_b16 a[94:95], v9 offset:58368
  v_add_f32 v29, v160, v161
  v_add_f32 v30, v252, v253
  v_add_f32 v29, v29, v162
  buffer_load_dwordx4 a[104:107], v1, s[36:39], s91 offen sc1
  s_waitcnt lgkmcnt(8)
  v_mfma_f32_16x16x32_bf16 v[192:195], a[72:75], a[8:11], v[192:195]
  ds_read_b64_tr_b16 a[96:97], v2 offset:40960
  v_add_f32 v30, v30, v254
  v_add_f32 v29, v29, v163
  v_add_f32 v30, v30, v255
  v_add_f32 v29, v29, v164
  s_add_u32 s10, s9, 31744
  v_mfma_f32_16x16x32_bf16 v[196:199], a[72:75], v[40:43], v[196:199]
  ds_read_b64_tr_b16 a[98:99], v2 offset:59392
  v_add_f32 v30, v30, v244
  v_add_f32 v29, v29, v165
  v_add_f32 v30, v30, v245
  v_add_f32 v29, v29, v166
  buffer_load_dwordx4 a[188:191], v1, s[36:39], s10 offen sc1
  v_mfma_f32_16x16x32_bf16 v[200:203], a[76:79], a[8:11], v[200:203]
  ds_read_b64_tr_b16 a[100:101], v3 offset:40960
  v_add_f32 v30, v30, v246
  v_add_f32 v29, v29, v167
  v_add_f32 v30, v30, v247
  v_add_f32 v29, v29, v168
  s_add_u32 s10, s9, 22528
  v_mfma_f32_16x16x32_bf16 v[204:207], a[76:79], v[40:43], v[204:207]
  ds_read_b64_tr_b16 a[102:103], v3 offset:59392
  v_add_f32 v30, v30, v212
  v_add_f32 v29, v29, v169
  v_add_f32 v30, v30, v213
  buffer_load_dwordx4 a[184:187], v1, s[36:39], s10 offen sc1
  s_waitcnt lgkmcnt(8)
  v_mfma_f32_16x16x32_bf16 v[176:179], a[80:83], a[12:15], v[176:179]
  ds_read_b64_tr_b16 a[72:73], v8 offset:40960
  v_add_f32 v29, v29, v170
  v_add_f32 v30, v30, v214
  v_add_f32 v29, v29, v171
  v_add_f32 v30, v30, v215
  v_mfma_f32_16x16x32_bf16 v[180:183], a[80:83], v[44:47], v[180:183]
  ds_read_b64_tr_b16 a[74:75], v8 offset:59392
  v_add_f32 v29, v29, v172
  v_add_f32 v30, v30, v220
  v_add_f32 v29, v29, v173
  v_add_f32 v30, v30, v221
  buffer_load_dwordx4 a[108:111], v1, s[36:39], s91 offen offset:1024 sc1
  v_mfma_f32_16x16x32_bf16 v[184:187], a[84:87], a[12:15], v[184:187]
  ds_read_b64_tr_b16 a[76:77], v9 offset:40960
  v_add_f32 v29, v29, v174
  v_add_f32 v30, v30, v222
  v_add_f32 v29, v29, v175
  v_add_f32 v30, v30, v223
  s_add_u32 s10, s9, 13312
  v_mfma_f32_16x16x32_bf16 v[188:191], a[84:87], v[44:47], v[188:191]
  ds_read_b64_tr_b16 a[78:79], v9 offset:59392
  v_add_f32 v29, v29, v14
  v_add_f32 v30, v30, v228
  v_add_f32 v29, v29, v15
  buffer_load_dwordx4 a[180:183], v1, s[36:39], s10 offen sc1
  s_waitcnt lgkmcnt(8)
  v_mfma_f32_16x16x32_bf16 v[192:195], a[88:91], a[12:15], v[192:195]
  ds_read_b64_tr_b16 a[80:81], v2 offset:41984
  v_add_f32 v30, v30, v229
  v_rcp_f32 v29, v29
  v_rcp_f32 v30, v30
  s_add_u32 s10, s9, 4096
  v_mfma_f32_16x16x32_bf16 v[196:199], a[88:91], v[44:47], v[196:199]
  ds_read_b64_tr_b16 a[82:83], v2 offset:60416
  v_mul_f32 v160, v29, v160
  v_mul_f32 v252, v30, v252
  v_mul_f32 v161, v29, v161
  v_mul_f32 v253, v30, v253
  buffer_load_dwordx4 a[176:179], v1, s[36:39], s10 offen sc1
  v_mfma_f32_16x16x32_bf16 v[200:203], a[92:95], a[12:15], v[200:203]
  ds_read_b64_tr_b16 a[84:85], v3 offset:41984
  v_mul_f32 v162, v29, v162
  v_mul_f32 v254, v30, v254
  v_mul_f32 v163, v29, v163
  v_mul_f32 v255, v30, v255
  v_mfma_f32_16x16x32_bf16 v[204:207], a[92:95], v[44:47], v[204:207]
  ds_read_b64_tr_b16 a[86:87], v3 offset:60416
  v_mul_f32 v164, v29, v164
  v_mul_f32 v244, v30, v244
  v_mul_f32 v165, v29, v165
  buffer_load_dwordx4 a[112:115], v1, s[36:39], s91 offen offset:2048 sc1
  s_waitcnt lgkmcnt(8)
  v_mfma_f32_16x16x32_bf16 v[176:179], a[96:99], a[16:19], v[176:179]
  ds_read_b64_tr_b16 a[88:89], v8 offset:41984
  v_mul_f32 v245, v30, v245
  v_mul_f32 v166, v29, v166
  v_mul_f32 v246, v30, v246
  v_mul_f32 v167, v29, v167
  s_add_u32 s10, s9, 156672
  v_mfma_f32_16x16x32_bf16 v[180:183], a[96:99], v[48:51], v[180:183]
  ds_read_b64_tr_b16 a[90:91], v8 offset:60416
  v_mul_f32 v247, v30, v247
  v_mul_f32 v168, v29, v168
  v_mul_f32 v212, v30, v212
  v_mul_f32 v169, v29, v169
  buffer_load_dwordx4 a[172:175], v1, s[36:39], s10 offen sc1
  v_mfma_f32_16x16x32_bf16 v[184:187], a[100:103], a[16:19], v[184:187]
  ds_read_b64_tr_b16 a[92:93], v9 offset:41984
  v_mul_f32 v213, v30, v213
  v_mul_f32 v170, v29, v170
  v_mul_f32 v214, v30, v214
  v_mul_f32 v171, v29, v171
  s_add_u32 s10, s9, 147456
  v_mfma_f32_16x16x32_bf16 v[188:191], a[100:103], v[48:51], v[188:191]
  ds_read_b64_tr_b16 a[94:95], v9 offset:60416
  v_mul_f32 v215, v30, v215
  v_mul_f32 v172, v29, v172
  v_mul_f32 v220, v30, v220
  buffer_load_dwordx4 a[168:171], v1, s[36:39], s10 offen sc1
  s_waitcnt lgkmcnt(8)
  v_mfma_f32_16x16x32_bf16 v[192:195], a[72:75], a[16:19], v[192:195]
  ds_read_b64_tr_b16 a[96:97], v2 offset:43008
  v_mul_f32 v173, v29, v173
  v_mul_f32 v221, v30, v221
  v_mul_f32 v174, v29, v174
  v_mul_f32 v222, v30, v222
  v_mfma_f32_16x16x32_bf16 v[196:199], a[72:75], v[48:51], v[196:199]
  ds_read_b64_tr_b16 a[98:99], v2 offset:61440
  v_mul_f32 v175, v29, v175
  v_mul_f32 v223, v30, v223
  v_mul_f32 v14, v29, v14
  v_mul_f32 v228, v30, v228
  buffer_load_dwordx4 a[116:119], v1, s[36:39], s91 offen offset:3072 sc1
  v_mfma_f32_16x16x32_bf16 v[200:203], a[76:79], a[16:19], v[200:203]
  ds_read_b64_tr_b16 a[100:101], v3 offset:43008
  v_mul_f32 v15, v29, v15
  v_mul_f32 v229, v30, v229
  v_cvt_pk_bf16_f32 v160, v160, v161
  v_cvt_pk_bf16_f32 v161, v162, v163
  s_add_u32 s10, s9, 138240
  v_mfma_f32_16x16x32_bf16 v[204:207], a[76:79], v[48:51], v[204:207]
  ds_read_b64_tr_b16 a[102:103], v3 offset:61440
  ds_write_b64 v17, v[160:161] offset:4736
  v_cvt_pk_bf16_f32 v162, v164, v165
  v_cvt_pk_bf16_f32 v163, v166, v167
  buffer_load_dwordx4 a[164:167], v1, s[36:39], s10 offen sc1
  s_waitcnt lgkmcnt(9)
  v_mfma_f32_16x16x32_bf16 v[176:179], a[80:83], a[20:23], v[176:179]
  ds_read_b64_tr_b16 a[72:73], v8 offset:43008
  ds_write_b64 v17, v[162:163] offset:4744
  v_cvt_pk_bf16_f32 v164, v168, v169
  v_cvt_pk_bf16_f32 v165, v170, v171
  ds_write_b64 v17, v[164:165] offset:4752
  s_add_u32 s10, s9, 129024
  v_mfma_f32_16x16x32_bf16 v[180:183], a[80:83], v[52:55], v[180:183]
  ds_read_b64_tr_b16 a[74:75], v8 offset:61440
  v_cvt_pk_bf16_f32 v166, v172, v173
  v_cvt_pk_bf16_f32 v167, v174, v175
  ds_write_b64 v17, v[166:167] offset:4760
  v_cvt_pk_bf16_f32 v168, v14, v15
  buffer_load_dwordx4 a[160:163], v1, s[36:39], s10 offen sc1
  v_mfma_f32_16x16x32_bf16 v[184:187], a[84:87], a[20:23], v[184:187]
  ds_read_b64_tr_b16 a[76:77], v9 offset:43008
  v_cvt_pk_bf16_f32 v169, v252, v253
  ds_write_b64 v17, v[168:169] offset:4768
  v_cvt_pk_bf16_f32 v170, v254, v255
  v_cvt_pk_bf16_f32 v171, v244, v245
  s_add_u32 s16, s91, 4096
  v_mfma_f32_16x16x32_bf16 v[188:191], a[84:87], v[52:55], v[188:191]
  ds_read_b64_tr_b16 a[78:79], v9 offset:61440
  ds_write_b64 v17, v[170:171] offset:4776
  v_cvt_pk_bf16_f32 v172, v246, v247
  v_cvt_pk_bf16_f32 v173, v212, v213
  buffer_load_dwordx4 a[120:123], v1, s[36:39], s16 offen sc1
  s_waitcnt lgkmcnt(14)
  v_mfma_f32_16x16x32_bf16 v[192:195], a[88:91], a[20:23], v[192:195]
  ds_read_b64_tr_b16 a[80:81], v2 offset:44032
  ds_write_b64 v17, v[172:173] offset:4784
  v_cvt_pk_bf16_f32 v174, v214, v215
  v_cvt_pk_bf16_f32 v175, v220, v221
  ds_write_b64 v17, v[174:175] offset:4792
  s_add_u32 s10, s9, 119808
  v_mfma_f32_16x16x32_bf16 v[196:199], a[88:91], v[52:55], v[196:199]
  ds_read_b64_tr_b16 a[82:83], v2 offset:62464
  v_cvt_pk_bf16_f32 v14, v222, v223
  v_cvt_pk_bf16_f32 v15, v228, v229
  ds_write_b64 v17, v[14:15] offset:4800
  v_mul_f32 v232, v5, v232
  buffer_load_dwordx4 a[156:159], v1, s[36:39], s10 offen sc1
  v_mfma_f32_16x16x32_bf16 v[200:203], a[92:95], a[20:23], v[200:203]
  ds_read_b64_tr_b16 a[84:85], v3 offset:44032
  v_mul_f32 v233, v5, v233
  v_mul_f32 v234, v5, v234
  v_mul_f32 v235, v5, v235
  v_cvt_pk_bf16_f32 v232, v232, v233
  s_add_u32 s10, s9, 110592
  v_mfma_f32_16x16x32_bf16 v[204:207], a[92:95], v[52:55], v[204:207]
  ds_read_b64_tr_b16 a[86:87], v3 offset:62464
  v_cvt_pk_bf16_f32 v233, v234, v235
  ds_write_b64 v18, v[232:233]
  v_mul_f32 v152, v5, v152
  buffer_load_dwordx4 a[152:155], v1, s[36:39], s10 offen sc1
  s_waitcnt lgkmcnt(14)
  v_mfma_f32_16x16x32_bf16 v[176:179], a[96:99], a[24:27], v[176:179]
  ds_read_b64_tr_b16 a[88:89], v8 offset:44032
  v_mul_f32 v153, v5, v153
  v_mul_f32 v154, v5, v154
  v_mul_f32 v155, v5, v155
  v_cvt_pk_bf16_f32 v152, v152, v153
  v_mfma_f32_16x16x32_bf16 v[180:183], a[96:99], v[56:59], v[180:183]
  ds_read_b64_tr_b16 a[90:91], v8 offset:62464
  v_cvt_pk_bf16_f32 v153, v154, v155
  ds_write_b64 v18, v[152:153] offset:32
  v_mul_f32 v226, v5, v226
  v_mul_f32 v227, v5, v227
  buffer_load_dwordx4 a[124:127], v1, s[36:39], s16 offen offset:1024 sc1
  v_mfma_f32_16x16x32_bf16 v[184:187], a[100:103], a[24:27], v[184:187]
  ds_read_b64_tr_b16 a[92:93], v9 offset:44032
  v_cvt_pk_bf16_f32 v227, v226, v227
  v_mov_b32 v226, 0x3f803f80
  ds_write_b64 v18, v[226:227] offset:64
  v_mul_f32 v236, v6, v236
  s_add_u32 s10, s9, 101376
  v_mfma_f32_16x16x32_bf16 v[188:191], a[100:103], v[56:59], v[188:191]
  ds_read_b64_tr_b16 a[94:95], v9 offset:62464
  v_mul_f32 v237, v6, v237
  v_mul_f32 v238, v6, v238
  v_mul_f32 v239, v6, v239
  buffer_load_dwordx4 a[148:151], v1, s[36:39], s10 offen sc1
  s_waitcnt lgkmcnt(14)
  v_mfma_f32_16x16x32_bf16 v[192:195], a[72:75], a[24:27], v[192:195]
  ds_read_b64_tr_b16 a[96:97], v2 offset:45056
  v_cvt_pk_bf16_f32 v236, v236, v237
  v_cvt_pk_bf16_f32 v237, v238, v239
  ds_write_b64 v18, v[236:237] offset:1664
  v_mul_f32 v156, v6, v156
  v_mfma_f32_16x16x32_bf16 v[196:199], a[72:75], v[56:59], v[196:199]
  ds_read_b64_tr_b16 a[98:99], v2 offset:63488
  v_mul_f32 v157, v6, v157
  v_mul_f32 v158, v6, v158
  v_mul_f32 v159, v6, v159
  v_cvt_pk_bf16_f32 v156, v156, v157
  v_mfma_f32_16x16x32_bf16 v[200:203], a[76:79], a[24:27], v[200:203]
  ds_read_b64_tr_b16 a[100:101], v3 offset:45056
  v_cvt_pk_bf16_f32 v157, v158, v159
  ds_write_b64 v18, v[156:157] offset:1696
  v_mul_f32 v230, v6, v230
  v_mul_f32 v231, v6, v231
  buffer_load_dwordx4 a[128:131], v1, s[36:39], s16 offen offset:2048 sc1
  v_mfma_f32_16x16x32_bf16 v[204:207], a[76:79], v[56:59], v[204:207]
  ds_read_b64_tr_b16 a[102:103], v3 offset:63488
  v_cvt_pk_bf16_f32 v231, v230, v231
  v_mov_b32 v230, 0x3f803f80
  ds_write_b64 v18, v[230:231] offset:1728
  s_waitcnt lgkmcnt(14)
  v_mfma_f32_16x16x32_bf16 v[176:179], a[80:83], a[28:31], v[176:179]
  ds_read_b64_tr_b16 a[72:73], v8 offset:45056
  s_add_u32 s10, s9, 92160
  buffer_load_dwordx4 a[144:147], v1, s[36:39], s10 offen sc1
  v_mfma_f32_16x16x32_bf16 v[180:183], a[80:83], v[60:63], v[180:183]
  ds_read_b64_tr_b16 a[74:75], v8 offset:63488
  v_mfma_f32_16x16x32_bf16 v[184:187], a[84:87], a[28:31], v[184:187]
  ds_read_b64_tr_b16 a[76:77], v9 offset:45056
  v_mfma_f32_16x16x32_bf16 v[188:191], a[84:87], v[60:63], v[188:191]
  ds_read_b64_tr_b16 a[78:79], v9 offset:63488
  v_add_u32 v2, 73728, v2
  s_waitcnt lgkmcnt(11)
  v_mfma_f32_16x16x32_bf16 v[192:195], a[88:91], a[28:31], v[192:195]
  s_waitcnt lgkmcnt(4)
  s_barrier
  ds_read_b64_tr_b16 a[80:81], v2
  buffer_load_dwordx4 a[132:135], v1, s[36:39], s16 offen offset:3072 sc1
  v_mfma_f32_16x16x32_bf16 v[196:199], a[88:91], v[60:63], v[196:199]
  ds_read_b64_tr_b16 a[82:83], v2 offset:18432
  v_add_u32 v3, 73728, v3
  ds_read_b64_tr_b16 v[152:153], v19
  ds_read_b64_tr_b16 v[154:155], v19 offset:4736
  v_mfma_f32_16x16x32_bf16 v[200:203], a[92:95], a[28:31], v[200:203]
  ds_read_b64_tr_b16 a[84:85], v3
  ds_read_b64_tr_b16 v[156:157], v21
  s_mul_i32 s69, s63, 331776
  s_add_u32 s69, s69, 4194304
  v_mfma_f32_16x16x32_bf16 v[204:207], a[92:95], v[60:63], v[204:207]
  ds_read_b64_tr_b16 a[86:87], v3 offset:18432
  v_add_u32 v8, 73728, v8
  s_add_u32 s69, s69, s65
  s_add_u32 m0, s65, 36864
  v_mfma_f32_16x16x32_bf16 v[176:179], a[96:99], a[32:35], v[176:179]
  ds_read_b64_tr_b16 a[88:89], v8
L_pg5:
  s_cbranch_execz L_pg9
  ds_read_b64_tr_b16 v[158:159], v21 offset:1664
  buffer_load_dwordx4 v1, s[36:39], s69 offen sc1 lds
  v_mfma_f32_16x16x32_bf16 v[180:183], a[96:99], v[64:67], v[180:183]
  ds_read_b64_tr_b16 a[90:91], v8 offset:18432
  v_add_u32 v9, 73728, v9
  ds_read_b64_tr_b16 v[160:161], v22
  v_mfma_f32_16x16x32_bf16 v[184:187], a[100:103], a[32:35], v[184:187]
  ds_read_b64_tr_b16 a[92:93], v9
  ds_read_b64_tr_b16 v[162:163], v22 offset:1664
  v_mfma_f32_16x16x32_bf16 v[188:191], a[100:103], v[64:67], v[188:191]
  ds_read_b64_tr_b16 a[94:95], v9 offset:18432
  ds_read_b64_tr_b16 v[164:165], v20
  s_add_u32 s16, s91, 8192
  s_waitcnt lgkmcnt(14)
  v_mfma_f32_16x16x32_bf16 v[192:195], a[72:75], a[32:35], v[192:195]
  ds_read_b64_tr_b16 a[96:97], v2 offset:1024
  ds_read_b64_tr_b16 v[166:167], v20 offset:4736
  buffer_load_dwordx4 a[136:139], v1, s[36:39], s16 offen sc1
  v_mfma_f32_16x16x32_bf16 v[196:199], a[72:75], v[64:67], v[196:199]
  ds_read_b64_tr_b16 a[98:99], v2 offset:19456
  ds_read_b64_tr_b16 v[208:209], v19 offset:9472
  v_mfma_f32_16x16x32_bf16 v[200:203], a[76:79], a[32:35], v[200:203]
  ds_read_b64_tr_b16 a[100:101], v3 offset:1024
  ds_read_b64_tr_b16 v[210:211], v19 offset:14208
  v_mfma_f32_16x16x32_bf16 v[204:207], a[76:79], v[64:67], v[204:207]
  ds_read_b64_tr_b16 a[102:103], v3 offset:19456
  ds_read_b64_tr_b16 v[212:213], v21 offset:3328
  s_waitcnt lgkmcnt(14)
  v_mfma_f32_16x16x32_bf16 v[176:179], a[80:83], a[36:39], v[176:179]
  ds_read_b64_tr_b16 a[72:73], v8 offset:1024
  ds_read_b64_tr_b16 v[214:215], v21 offset:4992
  buffer_load_dwordx4 v1, s[36:39], s69 offen offset:1024 sc1 lds
  v_mfma_f32_16x16x32_bf16 v[180:183], a[80:83], v[68:71], v[180:183]
  ds_read_b64_tr_b16 a[74:75], v8 offset:19456
  ds_read_b64_tr_b16 v[216:217], v22 offset:3328
  v_mfma_f32_16x16x32_bf16 v[184:187], a[84:87], a[36:39], v[184:187]
  ds_read_b64_tr_b16 a[76:77], v9 offset:1024
  ds_read_b64_tr_b16 v[218:219], v22 offset:4992
  v_mfma_f32_16x16x32_bf16 v[188:191], a[84:87], v[68:71], v[188:191]
  ds_read_b64_tr_b16 a[78:79], v9 offset:19456
  ds_read_b64_tr_b16 v[220:221], v20 offset:9472
  s_waitcnt lgkmcnt(14)
  v_mfma_f32_16x16x32_bf16 v[192:195], a[88:91], a[36:39], v[192:195]
  ds_read_b64_tr_b16 a[80:81], v2 offset:2048
  ds_read_b64_tr_b16 v[222:223], v20 offset:14208
  v_mfma_f32_16x16x32_bf16 v[240:243], v[152:155], v[156:159], 0
  buffer_load_dwordx4 a[140:143], v1, s[36:39], s16 offen offset:1024 sc1
  v_mfma_f32_16x16x32_bf16 v[196:199], a[88:91], v[68:71], v[196:199]
  ds_read_b64_tr_b16 a[82:83], v2 offset:20480
  ds_read_b64_tr_b16 v[224:225], v19 offset:18944
  v_mfma_f32_16x16x32_bf16 v[244:247], v[152:155], v[160:163], 0
  v_mfma_f32_16x16x32_bf16 v[200:203], a[92:95], a[36:39], v[200:203]
  ds_read_b64_tr_b16 a[84:85], v3 offset:2048
  ds_read_b64_tr_b16 v[226:227], v19 offset:23680
  v_mfma_f32_16x16x32_bf16 v[248:251], v[164:167], v[156:159], 0
  v_mfma_f32_16x16x32_bf16 v[204:207], a[92:95], v[68:71], v[204:207]
  ds_read_b64_tr_b16 a[86:87], v3 offset:20480
  ds_read_b64_tr_b16 v[228:229], v21 offset:6656
  s_waitcnt lgkmcnt(14)
  v_mfma_f32_16x16x32_bf16 v[176:179], a[96:99], a[40:43], v[176:179]
  ds_read_b64_tr_b16 a[88:89], v8 offset:2048
  ds_read_b64_tr_b16 v[230:231], v21 offset:8320
  buffer_load_dwordx4 v1, s[36:39], s69 offen offset:2048 sc1 lds
  v_mfma_f32_16x16x32_bf16 v[180:183], a[96:99], v[72:75], v[180:183]
  ds_read_b64_tr_b16 a[90:91], v8 offset:20480
  ds_read_b64_tr_b16 v[232:233], v22 offset:6656
  v_mfma_f32_16x16x32_bf16 v[184:187], a[100:103], a[40:43], v[184:187]
  ds_read_b64_tr_b16 a[92:93], v9 offset:2048
  ds_read_b64_tr_b16 v[234:235], v22 offset:8320
  v_mfma_f32_16x16x32_bf16 v[240:243], v[208:211], v[212:215], v[240:243]
  v_mfma_f32_16x16x32_bf16 v[188:191], a[100:103], v[72:75], v[188:191]
  ds_read_b64_tr_b16 a[94:95], v9 offset:20480
  ds_read_b64_tr_b16 v[236:237], v20 offset:18944
  s_waitcnt lgkmcnt(14)
  v_mfma_f32_16x16x32_bf16 v[244:247], v[208:211], v[216:219], v[244:247]
  v_mfma_f32_16x16x32_bf16 v[192:195], a[72:75], a[40:43], v[192:195]
  ds_read_b64_tr_b16 a[96:97], v2 offset:3072
  ds_read_b64_tr_b16 v[238:239], v20 offset:23680
  ds_read_b64_tr_b16 v[152:153], v19 offset:28416
  v_mfma_f32_16x16x32_bf16 v[248:251], v[220:223], v[212:215], v[248:251]
  buffer_load_dwordx4 v1, s[36:39], s69 offen offset:3072 sc1 lds
  v_mfma_f32_16x16x32_bf16 v[196:199], a[72:75], v[72:75], v[196:199]
  ds_read_b64_tr_b16 a[98:99], v2 offset:21504
  ds_read_b64_tr_b16 v[154:155], v19 offset:33152
  v_mfma_f32_16x16x32_bf16 v[200:203], a[76:79], a[40:43], v[200:203]
  ds_read_b64_tr_b16 a[100:101], v3 offset:3072
  ds_read_b64_tr_b16 v[156:157], v21 offset:9984
  s_add_u32 s84, s69, 4096
  v_mfma_f32_16x16x32_bf16 v[204:207], a[76:79], v[72:75], v[204:207]
  ds_read_b64_tr_b16 a[102:103], v3 offset:21504
  ds_read_b64_tr_b16 v[158:159], v21 offset:11648
  s_add_u32 m0, s65, 40960
  s_waitcnt lgkmcnt(14)
  v_mfma_f32_16x16x32_bf16 v[176:179], a[80:83], a[44:47], v[176:179]
  ds_read_b64_tr_b16 a[72:73], v8 offset:3072
  ds_read_b64_tr_b16 v[160:161], v22 offset:9984
  buffer_load_dwordx4 v1, s[36:39], s84 offen sc1 lds
  v_mfma_f32_16x16x32_bf16 v[180:183], a[80:83], v[76:79], v[180:183]
  ds_read_b64_tr_b16 a[74:75], v8 offset:21504
  ds_read_b64_tr_b16 v[162:163], v22 offset:11648
  v_mfma_f32_16x16x32_bf16 v[184:187], a[84:87], a[44:47], v[184:187]
  ds_read_b64_tr_b16 a[76:77], v9 offset:3072
  ds_read_b64_tr_b16 v[164:165], v20 offset:28416
  v_mfma_f32_16x16x32_bf16 v[240:243], v[224:227], v[228:231], v[240:243]
  v_mfma_f32_16x16x32_bf16 v[188:191], a[84:87], v[76:79], v[188:191]
  ds_read_b64_tr_b16 a[78:79], v9 offset:21504
  ds_read_b64_tr_b16 v[166:167], v20 offset:33152
  s_waitcnt lgkmcnt(14)
  v_mfma_f32_16x16x32_bf16 v[244:247], v[224:227], v[232:235], v[244:247]
  v_mfma_f32_16x16x32_bf16 v[192:195], a[88:91], a[44:47], v[192:195]
  ds_read_b64_tr_b16 a[80:81], v2 offset:4096
  v_mfma_f32_16x16x32_bf16 v[248:251], v[236:239], v[228:231], v[248:251]
  v_mfma_f32_16x16x32_bf16 v[196:199], a[88:91], v[76:79], v[196:199]
  ds_read_b64_tr_b16 a[82:83], v2 offset:22528
  buffer_load_dwordx4 v1, s[36:39], s84 offen offset:1024 sc1 lds
  v_mfma_f32_16x16x32_bf16 v[200:203], a[92:95], a[44:47], v[200:203]
  ds_read_b64_tr_b16 a[84:85], v3 offset:4096
  v_mfma_f32_16x16x32_bf16 v[204:207], a[92:95], v[76:79], v[204:207]
  ds_read_b64_tr_b16 a[86:87], v3 offset:22528
  s_waitcnt lgkmcnt(13)
  v_mfma_f32_16x16x32_bf16 v[176:179], a[96:99], a[48:51], v[176:179]
  ds_read_b64_tr_b16 a[88:89], v8 offset:4096
  v_mfma_f32_16x16x32_bf16 v[180:183], a[96:99], v[80:83], v[180:183]
  ds_read_b64_tr_b16 a[90:91], v8 offset:22528
  s_waitcnt lgkmcnt(14)
  v_mfma_f32_16x16x32_bf16 v[240:243], v[152:155], v[156:159], v[240:243]
  buffer_load_dwordx4 v1, s[36:39], s84 offen offset:2048 sc1 lds
  v_mfma_f32_16x16x32_bf16 v[184:187], a[100:103], a[48:51], v[184:187]
  ds_read_b64_tr_b16 a[92:93], v9 offset:4096
  s_waitcnt lgkmcnt(11)
  v_mfma_f32_16x16x32_bf16 v[244:247], v[152:155], v[160:163], v[244:247]
  v_mfma_f32_16x16x32_bf16 v[188:191], a[100:103], v[80:83], v[188:191]
  ds_read_b64_tr_b16 a[94:95], v9 offset:22528
  s_waitcnt lgkmcnt(8)
  v_mfma_f32_16x16x32_bf16 v[248:251], v[164:167], v[156:159], v[248:251]
  v_mfma_f32_16x16x32_bf16 v[192:195], a[72:75], a[48:51], v[192:195]
  ds_read_b64_tr_b16 a[96:97], v2 offset:5120
  v_mfma_f32_16x16x32_bf16 v[196:199], a[72:75], v[80:83], v[196:199]
  ds_read_b64_tr_b16 a[98:99], v2 offset:23552
  buffer_load_dwordx4 v1, s[36:39], s84 offen offset:3072 sc1 lds
  v_mfma_f32_16x16x32_bf16 v[200:203], a[76:79], a[48:51], v[200:203]
  ds_read_b64_tr_b16 a[100:101], v3 offset:5120
  v_cvt_pk_bf16_f32 v240, v240, v241
  v_mfma_f32_16x16x32_bf16 v[204:207], a[76:79], v[80:83], v[204:207]
  ds_read_b64_tr_b16 a[102:103], v3 offset:23552
  v_cvt_pk_bf16_f32 v241, v242, v243
  s_waitcnt lgkmcnt(8)
  v_mfma_f32_16x16x32_bf16 v[176:179], a[80:83], a[52:55], v[176:179]
  ds_read_b64_tr_b16 a[72:73], v8 offset:5120
  v_cvt_pk_bf16_f32 v244, v244, v245
  v_mfma_f32_16x16x32_bf16 v[180:183], a[80:83], v[84:87], v[180:183]
  ds_read_b64_tr_b16 a[74:75], v8 offset:23552
  v_cvt_pk_bf16_f32 v245, v246, v247
  buffer_store_dwordx2 v[240:241], v23, s[36:39], 0 offen sc1
  v_mfma_f32_16x16x32_bf16 v[184:187], a[84:87], a[52:55], v[184:187]
  ds_read_b64_tr_b16 a[76:77], v9 offset:5120
  v_cvt_pk_bf16_f32 v248, v248, v249
  v_mfma_f32_16x16x32_bf16 v[188:191], a[84:87], v[84:87], v[188:191]
  ds_read_b64_tr_b16 a[78:79], v9 offset:23552
  v_cvt_pk_bf16_f32 v249, v250, v251
  buffer_store_dwordx2 v[244:245], v24, s[36:39], 0 offen sc1
  s_waitcnt lgkmcnt(8)
  v_mfma_f32_16x16x32_bf16 v[192:195], a[88:91], a[52:55], v[192:195]
  ds_read_b64_tr_b16 a[80:81], v2 offset:6144
  v_mfma_f32_16x16x32_bf16 v[196:199], a[88:91], v[84:87], v[196:199]
  ds_read_b64_tr_b16 a[82:83], v2 offset:24576
  buffer_store_dwordx2 v[248:249], v25, s[36:39], 0 offen sc1
  v_mfma_f32_16x16x32_bf16 v[200:203], a[92:95], a[52:55], v[200:203]
  ds_read_b64_tr_b16 a[84:85], v3 offset:6144
  s_add_u32 s84, s69, 8192
  v_mfma_f32_16x16x32_bf16 v[204:207], a[92:95], v[84:87], v[204:207]
  ds_read_b64_tr_b16 a[86:87], v3 offset:24576
  s_add_u32 m0, s65, 45056
  s_waitcnt lgkmcnt(8)
  v_mfma_f32_16x16x32_bf16 v[176:179], a[96:99], a[56:59], v[176:179]
  ds_read_b64_tr_b16 a[88:89], v8 offset:6144
  buffer_load_dwordx4 v1, s[36:39], s84 offen sc1 lds
  v_mfma_f32_16x16x32_bf16 v[180:183], a[96:99], v[88:91], v[180:183]
  ds_read_b64_tr_b16 a[90:91], v8 offset:24576
  v_mfma_f32_16x16x32_bf16 v[184:187], a[100:103], a[56:59], v[184:187]
  ds_read_b64_tr_b16 a[92:93], v9 offset:6144
  v_mfma_f32_16x16x32_bf16 v[188:191], a[100:103], v[88:91], v[188:191]
  ds_read_b64_tr_b16 a[94:95], v9 offset:24576
  s_waitcnt lgkmcnt(8)
  v_mfma_f32_16x16x32_bf16 v[192:195], a[72:75], a[56:59], v[192:195]
  ds_read_b64_tr_b16 a[96:97], v2 offset:7168
  v_mfma_f32_16x16x32_bf16 v[196:199], a[72:75], v[88:91], v[196:199]
  ds_read_b64_tr_b16 a[98:99], v2 offset:25600
  v_mfma_f32_16x16x32_bf16 v[200:203], a[76:79], a[56:59], v[200:203]
  ds_read_b64_tr_b16 a[100:101], v3 offset:7168
  v_mfma_f32_16x16x32_bf16 v[204:207], a[76:79], v[88:91], v[204:207]
  ds_read_b64_tr_b16 a[102:103], v3 offset:25600
  s_waitcnt lgkmcnt(8)
  v_mfma_f32_16x16x32_bf16 v[176:179], a[80:83], a[60:63], v[176:179]
  ds_read_b64_tr_b16 a[72:73], v8 offset:7168
  v_mfma_f32_16x16x32_bf16 v[180:183], a[80:83], v[92:95], v[180:183]
  ds_read_b64_tr_b16 a[74:75], v8 offset:25600
  v_mfma_f32_16x16x32_bf16 v[184:187], a[84:87], a[60:63], v[184:187]
  ds_read_b64_tr_b16 a[76:77], v9 offset:7168
  v_mfma_f32_16x16x32_bf16 v[188:191], a[84:87], v[92:95], v[188:191]
  ds_read_b64_tr_b16 a[78:79], v9 offset:25600
  s_waitcnt lgkmcnt(8)
  v_mfma_f32_16x16x32_bf16 v[192:195], a[88:91], a[60:63], v[192:195]
  ds_read_b64_tr_b16 a[80:81], v2 offset:8192
  v_mfma_f32_16x16x32_bf16 v[196:199], a[88:91], v[92:95], v[196:199]
  ds_read_b64_tr_b16 a[82:83], v2 offset:26624
  v_mfma_f32_16x16x32_bf16 v[200:203], a[92:95], a[60:63], v[200:203]
  ds_read_b64_tr_b16 a[84:85], v3 offset:8192
  v_mfma_f32_16x16x32_bf16 v[204:207], a[92:95], v[92:95], v[204:207]
  ds_read_b64_tr_b16 a[86:87], v3 offset:26624
  s_waitcnt lgkmcnt(8)
  v_mfma_f32_16x16x32_bf16 v[176:179], a[96:99], a[64:67], v[176:179]
  ds_read_b64_tr_b16 a[88:89], v8 offset:8192
  v_mfma_f32_16x16x32_bf16 v[180:183], a[96:99], v[96:99], v[180:183]
  ds_read_b64_tr_b16 a[90:91], v8 offset:26624
  v_mfma_f32_16x16x32_bf16 v[184:187], a[100:103], a[64:67], v[184:187]
  ds_read_b64_tr_b16 a[92:93], v9 offset:8192
  v_mfma_f32_16x16x32_bf16 v[188:191], a[100:103], v[96:99], v[188:191]
  ds_read_b64_tr_b16 a[94:95], v9 offset:26624
  s_waitcnt lgkmcnt(8)
  v_mfma_f32_16x16x32_bf16 v[192:195], a[72:75], a[64:67], v[192:195]
  s_waitcnt vmcnt(34)
  s_barrier
  ds_read_b64_tr_b16 a[96:97], v10
  v_mfma_f32_16x16x32_bf16 v[196:199], a[72:75], v[96:99], v[196:199]
  ds_read_b64_tr_b16 a[98:99], v10 offset:9216
  s_add_u32 s84, s69, 36864
  s_add_u32 m0, s65, 73728
  v_mfma_f32_16x16x32_bf16 v[200:203], a[76:79], a[64:67], v[200:203]
  ds_read_b64_tr_b16 a[100:101], v11
  buffer_load_dwordx4 v1, s[36:39], s84 offen sc1 lds
  v_mfma_f32_16x16x32_bf16 v[204:207], a[76:79], v[96:99], v[204:207]
  ds_read_b64_tr_b16 a[102:103], v11 offset:9216
  s_waitcnt lgkmcnt(8)
  v_mfma_f32_16x16x32_bf16 v[176:179], a[80:83], a[68:71], v[176:179]
  ds_read_b64_tr_b16 a[72:73], v10 offset:18432
  v_mfma_f32_16x16x32_bf16 v[180:183], a[80:83], v[100:103], v[180:183]
  ds_read_b64_tr_b16 a[74:75], v10 offset:27648
  v_mfma_f32_16x16x32_bf16 v[184:187], a[84:87], a[68:71], v[184:187]
  ds_read_b64_tr_b16 a[76:77], v11 offset:18432
  buffer_load_dwordx4 v1, s[36:39], s84 offen offset:1024 sc1 lds
  v_mfma_f32_16x16x32_bf16 v[188:191], a[84:87], v[100:103], v[188:191]
  ds_read_b64_tr_b16 a[78:79], v11 offset:27648
  s_waitcnt lgkmcnt(8)
  v_mfma_f32_16x16x32_bf16 v[192:195], a[88:91], a[68:71], v[192:195]
  ds_read_b64_tr_b16 a[80:81], v10 offset:1024
  v_mfma_f32_16x16x32_bf16 v[196:199], a[88:91], v[100:103], v[196:199]
  ds_read_b64_tr_b16 a[82:83], v10 offset:10240
  v_mfma_f32_16x16x32_bf16 v[200:203], a[92:95], a[68:71], v[200:203]
  ds_read_b64_tr_b16 a[84:85], v11 offset:1024
  buffer_load_dwordx4 v1, s[36:39], s84 offen offset:2048 sc1 lds
  v_mfma_f32_16x16x32_bf16 v[204:207], a[92:95], v[100:103], v[204:207]
  ds_read_b64_tr_b16 a[86:87], v11 offset:10240
  s_waitcnt lgkmcnt(8)
  v_mfma_f32_16x16x32_bf16 v[208:211], a[96:99], a[0:3], 0
  ds_read_b64_tr_b16 a[88:89], v10 offset:19456
  v_mfma_f32_16x16x32_bf16 v[212:215], a[96:99], v[32:35], 0
  ds_read_b64_tr_b16 a[90:91], v10 offset:28672
  v_mfma_f32_16x16x32_bf16 v[216:219], a[100:103], a[0:3], 0
  ds_read_b64_tr_b16 a[92:93], v11 offset:19456
  buffer_load_dwordx4 v1, s[36:39], s84 offen offset:3072 sc1 lds
  v_mfma_f32_16x16x32_bf16 v[220:223], a[100:103], v[32:35], 0
  ds_read_b64_tr_b16 a[94:95], v11 offset:28672
  s_waitcnt lgkmcnt(8)
  v_mfma_f32_16x16x32_bf16 v[208:211], a[72:75], a[4:7], v[208:211]
  ds_read_b64_tr_b16 a[96:97], v10 offset:2048
  v_cvt_pk_bf16_f32 v152, v176, v177
  s_add_u32 s84, s69, 40960
  v_mfma_f32_16x16x32_bf16 v[212:215], a[72:75], v[36:39], v[212:215]
  ds_read_b64_tr_b16 a[98:99], v10 offset:11264
  v_cvt_pk_bf16_f32 v153, v178, v179
  s_add_u32 m0, s65, 77824
  v_mfma_f32_16x16x32_bf16 v[216:219], a[76:79], a[4:7], v[216:219]
  ds_read_b64_tr_b16 a[100:101], v11 offset:2048
  buffer_load_dwordx4 v1, s[36:39], s84 offen sc1 lds
  v_mfma_f32_16x16x32_bf16 v[220:223], a[76:79], v[36:39], v[220:223]
  ds_read_b64_tr_b16 a[102:103], v11 offset:11264
  s_waitcnt lgkmcnt(8)
  v_mfma_f32_16x16x32_bf16 v[208:211], a[80:83], a[8:11], v[208:211]
  ds_read_b64_tr_b16 a[72:73], v10 offset:20480
  v_cvt_pk_bf16_f32 v154, v184, v185
  v_mfma_f32_16x16x32_bf16 v[212:215], a[80:83], v[40:43], v[212:215]
  ds_read_b64_tr_b16 a[74:75], v10 offset:29696
  v_cvt_pk_bf16_f32 v155, v186, v187
  v_mfma_f32_16x16x32_bf16 v[216:219], a[84:87], a[8:11], v[216:219]
  ds_read_b64_tr_b16 a[76:77], v11 offset:20480
  buffer_load_dwordx4 v1, s[36:39], s84 offen offset:1024 sc1 lds
  v_mfma_f32_16x16x32_bf16 v[220:223], a[84:87], v[40:43], v[220:223]
  ds_read_b64_tr_b16 a[78:79], v11 offset:29696
  s_waitcnt lgkmcnt(8)
  v_mfma_f32_16x16x32_bf16 v[208:211], a[88:91], a[12:15], v[208:211]
  ds_read_b64_tr_b16 a[80:81], v10 offset:3072
  v_pk_max_i16 v152, v152, 0
  v_mfma_f32_16x16x32_bf16 v[212:215], a[88:91], v[44:47], v[212:215]
  ds_read_b64_tr_b16 a[82:83], v10 offset:12288
  v_pk_max_i16 v153, v153, 0
  v_mfma_f32_16x16x32_bf16 v[216:219], a[92:95], a[12:15], v[216:219]
  ds_read_b64_tr_b16 a[84:85], v11 offset:3072
  buffer_load_dwordx4 v1, s[36:39], s84 offen offset:2048 sc1 lds
  v_mfma_f32_16x16x32_bf16 v[220:223], a[92:95], v[44:47], v[220:223]
  ds_read_b64_tr_b16 a[86:87], v11 offset:12288
  s_waitcnt lgkmcnt(8)
  v_mfma_f32_16x16x32_bf16 v[208:211], a[96:99], a[16:19], v[208:211]
  ds_read_b64_tr_b16 a[88:89], v10 offset:21504
  v_pk_max_i16 v154, v154, 0
  v_mfma_f32_16x16x32_bf16 v[212:215], a[96:99], v[48:51], v[212:215]
  ds_read_b64_tr_b16 a[90:91], v10 offset:30720
  v_pk_max_i16 v155, v155, 0
  s_add_u32 s82, s82, 2048
  v_mfma_f32_16x16x32_bf16 v[216:219], a[100:103], a[16:19], v[216:219]
  ds_read_b64_tr_b16 a[92:93], v11 offset:21504
  buffer_store_dwordx4 v[152:155], v1, s[36:39], s82 offen sc1
  v_mfma_f32_16x16x32_bf16 v[220:223], a[100:103], v[48:51], v[220:223]
  ds_read_b64_tr_b16 a[94:95], v11 offset:30720
  s_waitcnt lgkmcnt(8)
  v_mfma_f32_16x16x32_bf16 v[208:211], a[72:75], a[20:23], v[208:211]
  ds_read_b64_tr_b16 a[96:97], v10 offset:4096
  v_cvt_pk_bf16_f32 v156, v180, v181
  v_mfma_f32_16x16x32_bf16 v[212:215], a[72:75], v[52:55], v[212:215]
  ds_read_b64_tr_b16 a[98:99], v10 offset:13312
  v_mfma_f32_16x16x32_bf16 v[216:219], a[76:79], a[20:23], v[216:219]
  ds_read_b64_tr_b16 a[100:101], v11 offset:4096
  v_cvt_pk_bf16_f32 v157, v182, v183
  buffer_load_dwordx4 v1, s[36:39], s84 offen offset:3072 sc1 lds
  v_mfma_f32_16x16x32_bf16 v[220:223], a[76:79], v[52:55], v[220:223]
  ds_read_b64_tr_b16 a[102:103], v11 offset:13312
  s_waitcnt lgkmcnt(8)
  v_mfma_f32_16x16x32_bf16 v[208:211], a[80:83], a[24:27], v[208:211]
  ds_read_b64_tr_b16 a[72:73], v10 offset:22528
  v_cvt_pk_bf16_f32 v158, v188, v189
  v_mfma_f32_16x16x32_bf16 v[212:215], a[80:83], v[56:59], v[212:215]
  ds_read_b64_tr_b16 a[74:75], v10 offset:31744
  s_waitcnt vmcnt(10)
  v_mfma_f32_16x16x32_bf16 v[216:219], a[84:87], a[24:27], v[216:219]
  ds_read_b64_tr_b16 a[76:77], v11 offset:22528
  v_cvt_pk_bf16_f32 v159, v190, v191
  buffer_store_dword v7, v27, s[36:39], s13 offen sc1
  v_mfma_f32_16x16x32_bf16 v[220:223], a[84:87], v[56:59], v[220:223]
  ds_read_b64_tr_b16 a[78:79], v11 offset:31744
  s_add_u32 s84, s69, 45056
  s_waitcnt lgkmcnt(8)
  v_mfma_f32_16x16x32_bf16 v[208:211], a[88:91], a[28:31], v[208:211]
  ds_read_b64_tr_b16 a[80:81], v10 offset:5120
  v_pk_max_i16 v156, v156, 0
  s_add_u32 m0, s65, 81920
  v_mfma_f32_16x16x32_bf16 v[212:215], a[88:91], v[60:63], v[212:215]
  ds_read_b64_tr_b16 a[82:83], v10 offset:14336
  buffer_load_dwordx4 v1, s[36:39], s84 offen sc1 lds
  v_mfma_f32_16x16x32_bf16 v[216:219], a[92:95], a[28:31], v[216:219]
  ds_read_b64_tr_b16 a[84:85], v11 offset:5120
  v_pk_max_i16 v157, v157, 0
  v_mfma_f32_16x16x32_bf16 v[220:223], a[92:95], v[60:63], v[220:223]
  ds_read_b64_tr_b16 a[86:87], v11 offset:14336
  s_waitcnt lgkmcnt(8)
  v_mfma_f32_16x16x32_bf16 v[208:211], a[96:99], a[32:35], v[208:211]
  ds_read_b64_tr_b16 a[88:89], v10 offset:23552
  v_pk_max_i16 v158, v158, 0
  v_mfma_f32_16x16x32_bf16 v[212:215], a[96:99], v[64:67], v[212:215]
  ds_read_b64_tr_b16 a[90:91], v10 offset:32768
  v_mfma_f32_16x16x32_bf16 v[216:219], a[100:103], a[32:35], v[216:219]
  ds_read_b64_tr_b16 a[92:93], v11 offset:23552
  v_pk_max_i16 v159, v159, 0
  v_mfma_f32_16x16x32_bf16 v[220:223], a[100:103], v[64:67], v[220:223]
  ds_read_b64_tr_b16 a[94:95], v11 offset:32768
  s_waitcnt lgkmcnt(8)
  v_mfma_f32_16x16x32_bf16 v[208:211], a[72:75], a[36:39], v[208:211]
  ds_read_b64_tr_b16 a[96:97], v10 offset:6144
  buffer_store_dwordx4 v[156:159], v1, s[36:39], s82 offen offset:1024 sc1
  v_mfma_f32_16x16x32_bf16 v[212:215], a[72:75], v[68:71], v[212:215]
  ds_read_b64_tr_b16 a[98:99], v10 offset:15360
  v_cvt_pk_bf16_f32 v160, v192, v193
  v_mfma_f32_16x16x32_bf16 v[216:219], a[76:79], a[36:39], v[216:219]
  ds_read_b64_tr_b16 a[100:101], v11 offset:6144
  v_cvt_pk_bf16_f32 v161, v194, v195
  v_mfma_f32_16x16x32_bf16 v[220:223], a[76:79], v[68:71], v[220:223]
  ds_read_b64_tr_b16 a[102:103], v11 offset:15360
  s_waitcnt lgkmcnt(8)
  v_mfma_f32_16x16x32_bf16 v[208:211], a[80:83], a[40:43], v[208:211]
  ds_read_b64_tr_b16 a[72:73], v10 offset:24576
  v_mfma_f32_16x16x32_bf16 v[212:215], a[80:83], v[72:75], v[212:215]
  ds_read_b64_tr_b16 a[74:75], v10 offset:33792
  v_cvt_pk_bf16_f32 v162, v200, v201
  v_mfma_f32_16x16x32_bf16 v[216:219], a[84:87], a[40:43], v[216:219]
  ds_read_b64_tr_b16 a[76:77], v11 offset:24576
  v_cvt_pk_bf16_f32 v163, v202, v203
  v_mfma_f32_16x16x32_bf16 v[220:223], a[84:87], v[72:75], v[220:223]
  ds_read_b64_tr_b16 a[78:79], v11 offset:33792
  s_waitcnt lgkmcnt(8)
  v_mfma_f32_16x16x32_bf16 v[208:211], a[88:91], a[44:47], v[208:211]
  ds_read_b64_tr_b16 a[80:81], v10 offset:7168
  v_mfma_f32_16x16x32_bf16 v[212:215], a[88:91], v[76:79], v[212:215]
  ds_read_b64_tr_b16 a[82:83], v10 offset:16384
  v_pk_max_i16 v160, v160, 0
  v_mfma_f32_16x16x32_bf16 v[216:219], a[92:95], a[44:47], v[216:219]
  ds_read_b64_tr_b16 a[84:85], v11 offset:7168
  v_pk_max_i16 v161, v161, 0
  v_mfma_f32_16x16x32_bf16 v[220:223], a[92:95], v[76:79], v[220:223]
  ds_read_b64_tr_b16 a[86:87], v11 offset:16384
  s_waitcnt lgkmcnt(8)
  v_mfma_f32_16x16x32_bf16 v[208:211], a[96:99], a[48:51], v[208:211]
  ds_read_b64_tr_b16 a[88:89], v10 offset:25600
  v_mfma_f32_16x16x32_bf16 v[212:215], a[96:99], v[80:83], v[212:215]
  ds_read_b64_tr_b16 a[90:91], v10 offset:34816
  v_pk_max_i16 v162, v162, 0
  buffer_load_dwordx4 a[40:43], v1, s[36:39], s16 offen offset:2048 sc1
  v_mfma_f32_16x16x32_bf16 v[216:219], a[100:103], a[48:51], v[216:219]
  ds_read_b64_tr_b16 a[92:93], v11 offset:25600
  v_pk_max_i16 v163, v163, 0
  v_mfma_f32_16x16x32_bf16 v[220:223], a[100:103], v[80:83], v[220:223]
  ds_read_b64_tr_b16 a[94:95], v11 offset:34816
  s_waitcnt lgkmcnt(8)
  v_mfma_f32_16x16x32_bf16 v[208:211], a[72:75], a[52:55], v[208:211]
  ds_read_b64_tr_b16 a[96:97], v10 offset:8192
  v_mfma_f32_16x16x32_bf16 v[212:215], a[72:75], v[84:87], v[212:215]
  ds_read_b64_tr_b16 a[98:99], v10 offset:17408
  v_cvt_pk_bf16_f32 v164, v196, v197
  s_add_u32 s82, s82, 2048
  v_mfma_f32_16x16x32_bf16 v[216:219], a[76:79], a[52:55], v[216:219]
  ds_read_b64_tr_b16 a[100:101], v11 offset:8192
  buffer_store_dwordx4 v[160:163], v1, s[36:39], s82 offen sc1
  v_mfma_f32_16x16x32_bf16 v[220:223], a[76:79], v[84:87], v[220:223]
  ds_read_b64_tr_b16 a[102:103], v11 offset:17408
  s_waitcnt lgkmcnt(8)
  v_mfma_f32_16x16x32_bf16 v[208:211], a[80:83], a[56:59], v[208:211]
  ds_read_b64_tr_b16 a[72:73], v10 offset:26624
  v_cvt_pk_bf16_f32 v165, v198, v199
  v_mfma_f32_16x16x32_bf16 v[212:215], a[80:83], v[88:91], v[212:215]
  ds_read_b64_tr_b16 a[74:75], v10 offset:35840
  v_cvt_pk_bf16_f32 v166, v204, v205
  v_mfma_f32_16x16x32_bf16 v[216:219], a[84:87], a[56:59], v[216:219]
  ds_read_b64_tr_b16 a[76:77], v11 offset:26624
  buffer_load_dwordx4 a[44:47], v1, s[36:39], s16 offen offset:3072 sc1
  v_mfma_f32_16x16x32_bf16 v[220:223], a[84:87], v[88:91], v[220:223]
  ds_read_b64_tr_b16 a[78:79], v11 offset:35840
  s_waitcnt lgkmcnt(8)
  v_mfma_f32_16x16x32_bf16 v[208:211], a[88:91], a[60:63], v[208:211]
  s_waitcnt vmcnt(15)
  s_barrier
  ds_read_b128 a[80:83], v1 offset:36864
  s_add_u32 s84, s69, 73728
  v_mfma_f32_16x16x32_bf16 v[212:215], a[88:91], v[92:95], v[212:215]
  v_cvt_pk_bf16_f32 v167, v206, v207
  s_lshl2_add_u32 s86, s63, s64
  s_add_u32 m0, s65, 0
  v_mfma_f32_16x16x32_bf16 v[216:219], a[92:95], a[60:63], v[216:219]
  ds_read_b128 a[84:87], v1 offset:37888
  v_pk_max_i16 v164, v164, 0
  buffer_load_dwordx4 v1, s[36:39], s84 offen sc1 lds
  v_mfma_f32_16x16x32_bf16 v[220:223], a[92:95], v[92:95], v[220:223]
  s_lshl_b32 s88, s86, 12
  s_waitcnt lgkmcnt(6)
  v_mfma_f32_16x16x32_bf16 v[208:211], a[96:99], a[64:67], v[208:211]
  ds_read_b128 a[88:91], v1 offset:38912
  v_pk_max_i16 v165, v165, 0
  v_mfma_f32_16x16x32_bf16 v[212:215], a[96:99], v[96:99], v[212:215]
  v_pk_max_i16 v166, v166, 0
  v_mfma_f32_16x16x32_bf16 v[216:219], a[100:103], a[64:67], v[216:219]
  ds_read_b128 a[92:95], v1 offset:39936
  s_lshl_b32 s86, s86, 13
  buffer_load_dwordx4 v1, s[36:39], s84 offen offset:1024 sc1 lds
  v_mfma_f32_16x16x32_bf16 v[220:223], a[100:103], v[96:99], v[220:223]
  v_pk_max_i16 v167, v167, 0
  s_waitcnt lgkmcnt(4)
  v_mfma_f32_16x16x32_bf16 v[208:211], a[72:75], a[68:71], v[208:211]
  ds_read_b128 a[96:99], v1 offset:40960
  s_add_u32 s86, s86, 33554432
  v_mfma_f32_16x16x32_bf16 v[212:215], a[72:75], v[100:103], v[212:215]
  v_mfma_f32_16x16x32_bf16 v[216:219], a[76:79], a[68:71], v[216:219]
  ds_read_b128 a[100:103], v1 offset:41984
  s_add_u32 s88, s88, 34603008
  v_mfma_f32_16x16x32_bf16 v[220:223], a[76:79], v[100:103], v[220:223]
  buffer_store_dwordx4 v[164:167], v1, s[36:39], s82 offen offset:1024 sc1
  s_waitcnt lgkmcnt(4)
  v_mfma_f32_16x16x32_bf16 v[32:35], a[80:83], v[104:107], 0
  ds_read_b128 a[72:75], v1 offset:43008
  v_and_b32 v16, 15, v0
  v_mfma_f32_16x16x32_bf16 v[36:39], a[80:83], v[108:111], 0
  v_lshrrev_b32 v29, 4, v0
  v_mfma_f32_16x16x32_bf16 v[48:51], a[84:87], v[104:107], 0
  ds_read_b128 a[76:79], v1 offset:44032
  v_mfma_f32_16x16x32_bf16 v[52:55], a[84:87], v[108:111], 0
  v_cvt_pk_bf16_f32 v168, v208, v209
  buffer_load_dwordx4 v1, s[36:39], s84 offen offset:2048 sc1 lds
  s_waitcnt lgkmcnt(4)
  v_mfma_f32_16x16x32_bf16 v[64:67], a[88:91], v[104:107], 0
  ds_read_b128 a[80:83], v1 offset:45056
  v_cvt_pk_bf16_f32 v169, v210, v211
  v_mfma_f32_16x16x32_bf16 v[68:71], a[88:91], v[108:111], 0
  v_lshlrev_b32 v24, 2, v16
  v_mfma_f32_16x16x32_bf16 v[80:83], a[92:95], v[104:107], 0
  ds_read_b128 a[84:87], v1 offset:46080
  v_cvt_pk_bf16_f32 v170, v216, v217
  v_mfma_f32_16x16x32_bf16 v[84:87], a[92:95], v[108:111], 0
  s_mov_b32 s40, 28
  buffer_load_dwordx4 v1, s[36:39], s84 offen offset:3072 sc1 lds
  s_waitcnt lgkmcnt(4)
  v_mfma_f32_16x16x32_bf16 v[40:43], a[96:99], v[104:107], 0
  ds_read_b128 a[88:91], v1 offset:47104
  v_cvt_pk_bf16_f32 v171, v218, v219
  v_mfma_f32_16x16x32_bf16 v[44:47], a[96:99], v[108:111], 0
  s_add_u32 s84, s69, 77824
  v_mfma_f32_16x16x32_bf16 v[56:59], a[100:103], v[104:107], 0
  ds_read_b128 a[92:95], v1 offset:48128
  v_pk_max_i16 v168, v168, 0
  s_add_u32 m0, s65, 4096
  v_mfma_f32_16x16x32_bf16 v[60:63], a[100:103], v[108:111], 0
  s_cmp_eq_u32 s64, 1
  s_cmov_b32 s40, 18
  buffer_load_dwordx4 v1, s[36:39], s84 offen sc1 lds
  s_waitcnt lgkmcnt(4)
  v_mfma_f32_16x16x32_bf16 v[72:75], a[72:75], v[104:107], 0
  ds_read_b128 a[96:99], v1 offset:49152
  v_pk_max_i16 v169, v169, 0
  v_mfma_f32_16x16x32_bf16 v[76:79], a[72:75], v[108:111], 0
  v_mfma_f32_16x16x32_bf16 v[88:91], a[76:79], v[104:107], 0
  ds_read_b128 a[100:103], v1 offset:50176
  v_pk_max_i16 v170, v170, 0
  v_mfma_f32_16x16x32_bf16 v[92:95], a[76:79], v[108:111], 0
  s_cmp_eq_u32 s64, 3
  s_cmov_b32 s40, 12
  buffer_load_dwordx4 v1, s[36:39], s84 offen offset:1024 sc1 lds
  s_waitcnt lgkmcnt(4)
  v_mfma_f32_16x16x32_bf16 v[96:99], a[80:83], v[104:107], 0
  ds_read_b128 a[72:75], v1 offset:51200
  v_pk_max_i16 v171, v171, 0
  v_mfma_f32_16x16x32_bf16 v[100:103], a[80:83], v[108:111], 0
  v_and_b32 v28, 31, v0
  v_mfma_f32_16x16x32_bf16 v[32:35], a[84:87], v[112:115], v[32:35]
  ds_read_b128 a[76:79], v1 offset:52224
  v_cvt_pk_bf16_f32 v172, v212, v213
  v_mfma_f32_16x16x32_bf16 v[36:39], a[84:87], v[116:119], v[36:39]
  v_cvt_pk_bf16_f32 v173, v214, v215
  s_add_u32 s82, s82, 2048
  s_waitcnt lgkmcnt(4)
  v_mfma_f32_16x16x32_bf16 v[48:51], a[88:91], v[112:115], v[48:51]
  ds_read_b128 a[80:83], v1 offset:53248
  buffer_store_dwordx4 v[168:171], v1, s[36:39], s82 offen sc1
  v_mfma_f32_16x16x32_bf16 v[52:55], a[88:91], v[116:119], v[52:55]
  v_cvt_pk_bf16_f32 v174, v220, v221
  v_cmp_gt_u32 vcc, s40, v28
  s_nop 1
  v_cndmask_b32 v23, 1073741824, v1, vcc
  v_mfma_f32_16x16x32_bf16 v[64:67], a[92:95], v[112:115], v[64:67]
  ds_read_b128 a[84:87], v1 offset:54272
L_pg6:
  s_cbranch_execz L_pg10
  v_lshlrev_b32 v28, 3, v28
  v_mfma_f32_16x16x32_bf16 v[68:71], a[92:95], v[116:119], v[68:71]
  v_cvt_pk_bf16_f32 v175, v222, v223
  s_waitcnt lgkmcnt(4)
  v_mfma_f32_16x16x32_bf16 v[80:83], a[96:99], v[112:115], v[80:83]
  ds_read_b128 a[88:91], v4
  buffer_load_dwordx4 v1, s[36:39], s84 offen offset:2048 sc1 lds
  v_mfma_f32_16x16x32_bf16 v[84:87], a[96:99], v[116:119], v[84:87]
  v_pk_max_i16 v172, v172, 0
  v_lshrrev_b32 v30, 5, v0
  v_mfma_f32_16x16x32_bf16 v[40:43], a[100:103], v[112:115], v[40:43]
  ds_read_b128 a[92:95], v4 offset:1024
  v_mfma_f32_16x16x32_bf16 v[44:47], a[100:103], v[116:119], v[44:47]
  v_pk_max_i16 v173, v173, 0
  s_waitcnt lgkmcnt(4)
  v_mfma_f32_16x16x32_bf16 v[56:59], a[72:75], v[112:115], v[56:59]
  ds_read_b128 a[96:99], v4 offset:2048
  v_lshl_add_u32 v28, v30, 2, v28
  buffer_load_dwordx4 v1, s[36:39], s84 offen offset:3072 sc1 lds
  v_mfma_f32_16x16x32_bf16 v[60:63], a[72:75], v[116:119], v[60:63]
  v_pk_max_i16 v174, v174, 0
  s_lshl_b32 s40, s64, 8
  v_mfma_f32_16x16x32_bf16 v[72:75], a[76:79], v[112:115], v[72:75]
  ds_read_b128 a[100:103], v4 offset:3072
  v_mfma_f32_16x16x32_bf16 v[76:79], a[76:79], v[116:119], v[76:79]
  v_pk_max_i16 v175, v175, 0
  s_waitcnt lgkmcnt(4)
  v_mfma_f32_16x16x32_bf16 v[88:91], a[80:83], v[112:115], v[88:91]
  ds_read_b128 a[72:75], v4 offset:4096
  s_add_u32 s40, s40, 150528
  v_mfma_f32_16x16x32_bf16 v[92:95], a[80:83], v[116:119], v[92:95]
  v_add_u32 v17, s40, v28
  buffer_store_dwordx4 v[172:175], v1, s[36:39], s82 offen offset:1024 sc1
  v_mfma_f32_16x16x32_bf16 v[96:99], a[84:87], v[112:115], v[96:99]
  ds_read_b128 a[76:79], v4 offset:5120
  v_mfma_f32_16x16x32_bf16 v[100:103], a[84:87], v[116:119], v[100:103]
  s_bfe_u32 s40, s63, 0x20001
  s_waitcnt lgkmcnt(4)
  v_mfma_f32_16x16x32_bf16 v[32:35], a[88:91], v[120:123], v[32:35]
  ds_read_b128 a[80:83], v4 offset:6144
  s_add_u32 s84, s69, 81920
  s_add_u32 m0, s65, 8192
  v_mfma_f32_16x16x32_bf16 v[36:39], a[88:91], v[124:127], v[36:39]
  s_lshl_b32 s40, s40, 8
  buffer_load_dwordx4 v1, s[36:39], s84 offen sc1 lds
  v_mfma_f32_16x16x32_bf16 v[48:51], a[92:95], v[120:123], v[48:51]
  ds_read_b128 a[84:87], v4 offset:7168
  s_and_b32 s41, s63, 1
  v_mfma_f32_16x16x32_bf16 v[52:55], a[92:95], v[124:127], v[52:55]
  s_waitcnt lgkmcnt(4)
  v_mfma_f32_16x16x32_bf16 v[64:67], a[96:99], v[120:123], v[64:67]
  ds_read_b128 a[88:91], v4 offset:8192
  s_lshl3_add_u32 s40, s41, s40
  v_mfma_f32_16x16x32_bf16 v[68:71], a[96:99], v[124:127], v[68:71]
  v_lshlrev_b32 v28, 4, v16
  buffer_load_dwordx4 v[176:179], v1, s[36:39], s92 offen sc1
  v_mfma_f32_16x16x32_bf16 v[80:83], a[100:103], v[120:123], v[80:83]
  ds_read_b128 a[92:95], v4 offset:9216
  v_mfma_f32_16x16x32_bf16 v[84:87], a[100:103], v[124:127], v[84:87]
  v_lshl_add_u32 v28, v29, 2, v28
  s_waitcnt lgkmcnt(4)
  v_mfma_f32_16x16x32_bf16 v[40:43], a[72:75], v[120:123], v[40:43]
  ds_read_b128 a[96:99], v4 offset:10240
  v_mfma_f32_16x16x32_bf16 v[44:47], a[72:75], v[124:127], v[44:47]
  v_add_u32 v28, s40, v28
  buffer_load_dwordx4 v[180:183], v1, s[36:39], s92 offen offset:1024 sc1
  v_mfma_f32_16x16x32_bf16 v[56:59], a[76:79], v[120:123], v[56:59]
  ds_read_b128 a[100:103], v4 offset:11264
  v_cmp_gt_u32 vcc, 32, v0
  s_nop 1
  v_cndmask_b32 v15, 1073741824, v28, vcc
  v_mfma_f32_16x16x32_bf16 v[60:63], a[76:79], v[124:127], v[60:63]
  s_waitcnt lgkmcnt(4)
  v_mfma_f32_16x16x32_bf16 v[72:75], a[80:83], v[120:123], v[72:75]
  ds_read_b128 a[72:75], v4 offset:12288
  s_and_b32 s41, s64, 1
  v_mfma_f32_16x16x32_bf16 v[76:79], a[80:83], v[124:127], v[76:79]
  s_mul_i32 s41, s41, 18432
  buffer_load_dwordx4 v[184:187], v1, s[36:39], s92 offen offset:2048 sc1
  v_mfma_f32_16x16x32_bf16 v[88:91], a[84:87], v[120:123], v[88:91]
  ds_read_b128 a[76:79], v4 offset:13312
  v_mfma_f32_16x16x32_bf16 v[92:95], a[84:87], v[124:127], v[92:95]
  s_add_u32 s40, s41, 110592
  s_waitcnt lgkmcnt(4)
  v_mfma_f32_16x16x32_bf16 v[96:99], a[88:91], v[120:123], v[96:99]
  ds_read_b128 a[80:83], v4 offset:14336
  v_mfma_f32_16x16x32_bf16 v[100:103], a[88:91], v[124:127], v[100:103]
  v_add_u32 v19, s40, v1
  buffer_load_dwordx4 v[188:191], v1, s[36:39], s92 offen offset:3072 sc1
  v_mfma_f32_16x16x32_bf16 v[32:35], a[92:95], v[128:131], v[32:35]
  ds_read_b128 a[84:87], v4 offset:15360
  s_sub_u32 s40, 129024, s41
  v_mfma_f32_16x16x32_bf16 v[36:39], a[92:95], v[132:135], v[36:39]
  s_waitcnt lgkmcnt(4)
  v_mfma_f32_16x16x32_bf16 v[48:51], a[96:99], v[128:131], v[48:51]
  ds_read_b128 a[88:91], v4 offset:16384
  v_add_u32 v20, s40, v1
  v_mfma_f32_16x16x32_bf16 v[52:55], a[96:99], v[132:135], v[52:55]
  s_add_u32 s85, s92, 4096
  buffer_load_dwordx4 v[192:195], v1, s[36:39], s85 offen sc1
  v_mfma_f32_16x16x32_bf16 v[64:67], a[100:103], v[128:131], v[64:67]
  ds_read_b128 a[92:95], v4 offset:17408
  v_mul_u32_u24 v28, 1152, v16
  v_mfma_f32_16x16x32_bf16 v[68:71], a[100:103], v[132:135], v[68:71]
  v_lshl_add_u32 v21, v29, 4, v28
  s_waitcnt lgkmcnt(4)
  v_mfma_f32_16x16x32_bf16 v[80:83], a[72:75], v[128:131], v[80:83]
  s_waitcnt vmcnt(21)
  s_barrier
  ds_read_b128 a[96:99], v4 offset:18432
  v_mfma_f32_16x16x32_bf16 v[84:87], a[72:75], v[132:135], v[84:87]
  buffer_load_dwordx4 v[196:199], v1, s[36:39], s85 offen offset:1024 sc1
  v_mfma_f32_16x16x32_bf16 v[40:43], a[76:79], v[128:131], v[40:43]
  ds_read_b128 a[100:103], v4 offset:19456
  v_lshl_add_u32 v22, v29, 3, v28
  v_mfma_f32_16x16x32_bf16 v[44:47], a[76:79], v[132:135], v[44:47]
  s_cmp_lt_u32 s64, 2
  s_cselect_b32 s40, 0, 1073741824
  s_waitcnt lgkmcnt(4)
  v_mfma_f32_16x16x32_bf16 v[56:59], a[80:83], v[128:131], v[56:59]
  ds_read_b128 a[72:75], v4 offset:20480
  s_add_u32 s84, s69, 110592
  s_add_u32 m0, s65, 36864
  v_mfma_f32_16x16x32_bf16 v[60:63], a[80:83], v[132:135], v[60:63]
  v_add_u32 v22, s40, v22
  buffer_load_dwordx4 v1, s[36:39], s84 offen sc1 lds
  v_mfma_f32_16x16x32_bf16 v[72:75], a[84:87], v[128:131], v[72:75]
  ds_read_b128 a[76:79], v4 offset:21504
  v_mfma_f32_16x16x32_bf16 v[76:79], a[84:87], v[132:135], v[76:79]
  s_lshl2_add_u32 s40, s60, s61
  s_waitcnt lgkmcnt(4)
  v_mfma_f32_16x16x32_bf16 v[88:91], a[88:91], v[128:131], v[88:91]
  ds_read_b128 a[80:83], v4 offset:22528
  s_mul_i32 s40, s40, 36864
  v_mfma_f32_16x16x32_bf16 v[92:95], a[88:91], v[132:135], v[92:95]
  buffer_load_dwordx4 v1, s[36:39], s84 offen offset:1024 sc1 lds
  v_mfma_f32_16x16x32_bf16 v[96:99], a[92:95], v[128:131], v[96:99]
  ds_read_b128 a[84:87], v4 offset:23552
  s_mul_i32 s42, s62, 288
  v_mfma_f32_16x16x32_bf16 v[100:103], a[92:95], v[132:135], v[100:103]
  s_add_u32 s40, s40, s42
  s_waitcnt lgkmcnt(4)
  v_mfma_f32_16x16x32_bf16 v[32:35], a[96:99], v[136:139], v[32:35]
  ds_read_b128 a[88:91], v4 offset:24576
  v_mfma_f32_16x16x32_bf16 v[36:39], a[96:99], v[140:143], v[36:39]
  s_add_u32 s43, s40, s41
  buffer_load_dwordx4 v1, s[36:39], s84 offen offset:2048 sc1 lds
  v_mfma_f32_16x16x32_bf16 v[48:51], a[100:103], v[136:139], v[48:51]
  ds_read_b128 a[92:95], v4 offset:25600
  v_mfma_f32_16x16x32_bf16 v[52:55], a[100:103], v[140:143], v[52:55]
  s_add_u32 s97, s43, 256
  s_waitcnt lgkmcnt(4)
  v_mfma_f32_16x16x32_bf16 v[64:67], a[72:75], v[136:139], v[64:67]
  ds_read_b128 a[96:99], v4 offset:26624
  s_lshl_b32 s42, s64, 6
  v_mfma_f32_16x16x32_bf16 v[68:71], a[72:75], v[140:143], v[68:71]
  buffer_load_dwordx4 v1, s[36:39], s84 offen offset:3072 sc1 lds
  v_mfma_f32_16x16x32_bf16 v[80:83], a[76:79], v[136:139], v[80:83]
  ds_read_b128 a[100:103], v4 offset:27648
  s_add_u32 s96, s43, s42
  v_mfma_f32_16x16x32_bf16 v[84:87], a[76:79], v[140:143], v[84:87]
  s_sub_u32 s40, s40, s41
  s_waitcnt lgkmcnt(4)
  v_mfma_f32_16x16x32_bf16 v[40:43], a[80:83], v[136:139], v[40:43]
  ds_read_b128 a[72:75], v4 offset:28672
  s_add_u32 s84, s69, 114688
  s_add_u32 m0, s65, 40960
  v_mfma_f32_16x16x32_bf16 v[44:47], a[80:83], v[140:143], v[44:47]
  s_add_u32 s40, s40, s42
  buffer_load_dwordx4 v1, s[36:39], s84 offen sc1 lds
  v_mfma_f32_16x16x32_bf16 v[56:59], a[84:87], v[136:139], v[56:59]
  ds_read_b128 a[76:79], v4 offset:29696
  v_mfma_f32_16x16x32_bf16 v[60:63], a[84:87], v[140:143], v[60:63]
  s_add_u32 s89, s40, 18432
  s_waitcnt lgkmcnt(4)
  v_mfma_f32_16x16x32_bf16 v[72:75], a[88:91], v[136:139], v[72:75]
  ds_read_b128 a[80:83], v4 offset:30720
  s_lshl_b32 s40, s64, 5
  v_mfma_f32_16x16x32_bf16 v[76:79], a[88:91], v[140:143], v[76:79]
  s_waitcnt vmcnt(12)
  buffer_store_dword v7, v27, s[36:39], s12 offen offset:64 sc1
  v_mfma_f32_16x16x32_bf16 v[88:91], a[92:95], v[136:139], v[88:91]
  ds_read_b128 a[84:87], v4 offset:31744
  v_add_u32 v28, s40, v16
  v_mfma_f32_16x16x32_bf16 v[92:95], a[92:95], v[140:143], v[92:95]
  v_mul_u32_u24 v28, 296, v28
  s_waitcnt lgkmcnt(4)
  v_mfma_f32_16x16x32_bf16 v[96:99], a[96:99], v[136:139], v[96:99]
  ds_read_b128 a[88:91], v4 offset:32768
  buffer_load_dwordx4 v1, s[36:39], s84 offen offset:1024 sc1 lds
  v_mfma_f32_16x16x32_bf16 v[100:103], a[96:99], v[140:143], v[100:103]
  v_add_u32 v28, 110592, v28
  v_mfma_f32_16x16x32_bf16 v[32:35], a[100:103], v[144:147], v[32:35]
  ds_read_b128 a[92:95], v4 offset:33792
  v_mfma_f32_16x16x32_bf16 v[36:39], a[100:103], v[148:151], v[36:39]
  v_lshl_add_u32 v13, v29, 4, v28
  s_waitcnt lgkmcnt(4)
  v_mfma_f32_16x16x32_bf16 v[48:51], a[72:75], v[144:147], v[48:51]
  ds_read_b128 a[96:99], v4 offset:34816
  v_and_b32 v30, 1, v29
  v_mfma_f32_16x16x32_bf16 v[52:55], a[72:75], v[148:151], v[52:55]
  buffer_load_dwordx4 v1, s[36:39], s84 offen offset:2048 sc1 lds
  v_mfma_f32_16x16x32_bf16 v[64:67], a[76:79], v[144:147], v[64:67]
  ds_read_b128 a[100:103], v4 offset:35840
  v_mul_u32_u24 v30, 72, v30
  v_mfma_f32_16x16x32_bf16 v[68:71], a[76:79], v[148:151], v[68:71]
  v_add3_u32 v14, v28, v30, 64
  s_waitcnt lgkmcnt(4)
  v_mfma_f32_16x16x32_bf16 v[80:83], a[80:83], v[144:147], v[80:83]
  ds_read_b128 a[72:75], v4 offset:36864
  v_mfma_f32_16x16x32_bf16 v[84:87], a[80:83], v[148:151], v[84:87]
  v_and_b32 v28, 3, v0
  buffer_load_dwordx4 v1, s[36:39], s84 offen offset:3072 sc1 lds
  v_mfma_f32_16x16x32_bf16 v[40:43], a[84:87], v[144:147], v[40:43]
  ds_read_b128 a[76:79], v4 offset:37888
  v_mfma_f32_16x16x32_bf16 v[44:47], a[84:87], v[148:151], v[44:47]
  v_subrev_u32 v28, 1, v28
  s_add_u32 s84, s69, 118784
  s_waitcnt lgkmcnt(4)
  v_mfma_f32_16x16x32_bf16 v[56:59], a[88:91], v[144:147], v[56:59]
  ds_read_b128 a[80:83], v4 offset:38912
  v_max_i32 v28, 0, v28
  v_mfma_f32_16x16x32_bf16 v[60:63], a[88:91], v[148:151], v[60:63]
  s_add_u32 m0, s65, 45056
  s_nop 0
  buffer_load_dwordx4 v1, s[36:39], s84 offen sc1 lds
  v_mfma_f32_16x16x32_bf16 v[72:75], a[92:95], v[144:147], v[72:75]
  ds_read_b128 a[84:87], v4 offset:39936
  v_mad_u32_u24 v28, v29, 3, v28
  v_mfma_f32_16x16x32_bf16 v[76:79], a[92:95], v[148:151], v[76:79]
  s_waitcnt lgkmcnt(4)
  v_mfma_f32_16x16x32_bf16 v[88:91], a[96:99], v[144:147], v[88:91]
  ds_read_b128 a[88:91], v4 offset:40960
  v_lshlrev_b32 v28, 3, v28
  v_mfma_f32_16x16x32_bf16 v[92:95], a[96:99], v[148:151], v[92:95]
  v_add_u32 v28, 150528, v28
  buffer_load_dwordx4 v[200:203], v1, s[36:39], s85 offen offset:2048 sc1
  v_mfma_f32_16x16x32_bf16 v[96:99], a[100:103], v[144:147], v[96:99]
  ds_read_b128 a[92:95], v4 offset:41984
  v_mfma_f32_16x16x32_bf16 v[100:103], a[100:103], v[148:151], v[100:103]
  v_mov_b32 v30, 150776
  s_waitcnt lgkmcnt(4)
  v_mfma_f32_16x16x32_bf16 v[32:35], a[72:75], v[152:155], v[32:35]
  ds_read_b128 a[96:99], v4 offset:43008
  s_mov_b32 s40, 0x111d111d
  v_mfma_f32_16x16x32_bf16 v[36:39], a[72:75], v[156:159], v[36:39]
  buffer_load_dwordx4 v[204:207], v1, s[36:39], s85 offen offset:3072 sc1
  v_mfma_f32_16x16x32_bf16 v[48:51], a[76:79], v[152:155], v[48:51]
  ds_read_b128 a[100:103], v4 offset:44032
  s_mov_b32 s41, 0x111d111d
  v_mfma_f32_16x16x32_bf16 v[52:55], a[76:79], v[156:159], v[52:55]
  s_waitcnt lgkmcnt(4)
  v_mfma_f32_16x16x32_bf16 v[64:67], a[80:83], v[152:155], v[64:67]
  ds_read_b128 a[72:75], v4 offset:45056
  v_cndmask_b32 v8, v30, v28, s[40:41]
  s_add_u32 s85, s92, 8192
  v_mfma_f32_16x16x32_bf16 v[68:71], a[80:83], v[156:159], v[68:71]
  s_mov_b32 s42, 0x22e222e2
  buffer_load_dwordx4 v[208:211], v1, s[36:39], s85 offen sc1
  v_mfma_f32_16x16x32_bf16 v[80:83], a[84:87], v[152:155], v[80:83]
  ds_read_b128 a[76:79], v4 offset:46080
  v_mfma_f32_16x16x32_bf16 v[84:87], a[84:87], v[156:159], v[84:87]
  s_mov_b32 s43, 0x22e222e2
  s_waitcnt lgkmcnt(4)
  v_mfma_f32_16x16x32_bf16 v[40:43], a[88:91], v[152:155], v[40:43]
  ds_read_b128 a[80:83], v4 offset:47104
  v_cndmask_b32 v9, v30, v28, s[42:43]
  v_mfma_f32_16x16x32_bf16 v[44:47], a[88:91], v[156:159], v[44:47]
  buffer_load_dwordx4 v[212:215], v1, s[36:39], s85 offen offset:1024 sc1
  v_mfma_f32_16x16x32_bf16 v[56:59], a[92:95], v[152:155], v[56:59]
  ds_read_b128 a[84:87], v4 offset:48128
  v_add_u32 v28, 96, v28
  v_mfma_f32_16x16x32_bf16 v[60:63], a[92:95], v[156:159], v[60:63]
  s_waitcnt lgkmcnt(4)
  v_mfma_f32_16x16x32_bf16 v[72:75], a[96:99], v[152:155], v[72:75]
  ds_read_b128 a[88:91], v4 offset:49152
  s_mov_b32 s40, 0x22e2111d
  v_mfma_f32_16x16x32_bf16 v[76:79], a[96:99], v[156:159], v[76:79]
  s_mov_b32 s41, 0x0
  buffer_load_dwordx4 v[216:219], v1, s[36:39], s85 offen offset:2048 sc1
  v_mfma_f32_16x16x32_bf16 v[88:91], a[100:103], v[152:155], v[88:91]
  ds_read_b128 a[92:95], v4 offset:50176
  v_mfma_f32_16x16x32_bf16 v[92:95], a[100:103], v[156:159], v[92:95]
  v_cndmask_b32 v12, v30, v28, s[40:41]
  s_waitcnt lgkmcnt(4)
  v_mfma_f32_16x16x32_bf16 v[96:99], a[72:75], v[152:155], v[96:99]
  ds_read_b128 a[96:99], v4 offset:51200
  v_lshlrev_b32 v28, 3, v16
  v_mfma_f32_16x16x32_bf16 v[100:103], a[72:75], v[156:159], v[100:103]
  buffer_load_dword v31, v24, s[36:39], s14 offen sc1
  v_mfma_f32_16x16x32_bf16 v[32:35], a[76:79], v[160:163], v[32:35]
  ds_read_b128 a[100:103], v4 offset:52224
  v_add_u32 v28, 150624, v28
  v_mfma_f32_16x16x32_bf16 v[36:39], a[76:79], v[164:167], v[36:39]
  buffer_load_dwordx4 v[220:223], v1, s[36:39], s85 offen offset:3072 sc1
  s_waitcnt lgkmcnt(4)
  v_mfma_f32_16x16x32_bf16 v[48:51], a[80:83], v[160:163], v[48:51]
  ds_read_b128 a[72:75], v4 offset:53248
  s_mov_b32 s42, 0xffff
  v_mfma_f32_16x16x32_bf16 v[52:55], a[80:83], v[164:167], v[52:55]
  s_mov_b32 s43, 0x0
  v_mfma_f32_16x16x32_bf16 v[64:67], a[84:87], v[160:163], v[64:67]
  ds_read_b128 a[76:79], v4 offset:54272
  v_mfma_f32_16x16x32_bf16 v[68:71], a[84:87], v[164:167], v[68:71]
  v_cndmask_b32 v10, v30, v28, s[42:43]
  buffer_load_dwordx4 a[0:3], v1, s[36:39], s93 offen sc1
  s_waitcnt lgkmcnt(4)
  v_mfma_f32_16x16x32_bf16 v[80:83], a[88:91], v[160:163], v[80:83]
  s_waitcnt vmcnt(24)
  s_barrier
  ds_read_b128 a[80:83], v1
  v_mfma_f32_16x16x32_bf16 v[84:87], a[88:91], v[164:167], v[84:87]
  s_mov_b32 s40, 0xffff0000
  v_mfma_f32_16x16x32_bf16 v[40:43], a[92:95], v[160:163], v[40:43]
  ds_read_b128 a[84:87], v1 offset:1024
  s_add_u32 s84, s69, 147456
  v_mfma_f32_16x16x32_bf16 v[44:47], a[92:95], v[164:167], v[44:47]
  s_mov_b32 s41, 0x0
  s_add_u32 m0, s65, 73728
  s_waitcnt lgkmcnt(4)
  v_mfma_f32_16x16x32_bf16 v[56:59], a[96:99], v[160:163], v[56:59]
  ds_read_b128 a[88:91], v1 offset:2048
  buffer_load_dwordx4 v1, s[36:39], s84 offen sc1 lds
  v_mfma_f32_16x16x32_bf16 v[60:63], a[96:99], v[164:167], v[60:63]
  v_cndmask_b32 v11, v30, v28, s[40:41]
  v_mfma_f32_16x16x32_bf16 v[72:75], a[100:103], v[160:163], v[72:75]
  ds_read_b128 a[92:95], v1 offset:3072
  s_lshr_b32 s40, s64, 1
  v_mfma_f32_16x16x32_bf16 v[76:79], a[100:103], v[164:167], v[76:79]
  s_waitcnt lgkmcnt(4)
  v_mfma_f32_16x16x32_bf16 v[88:91], a[72:75], v[160:163], v[88:91]
  ds_read_b128 a[96:99], v1 offset:4096
  s_lshl_b32 s40, s40, 10
  v_mfma_f32_16x16x32_bf16 v[92:95], a[72:75], v[164:167], v[92:95]
  s_and_b32 s41, s64, 1
  buffer_load_dwordx4 v1, s[36:39], s84 offen offset:1024 sc1 lds
  v_mfma_f32_16x16x32_bf16 v[96:99], a[76:79], v[160:163], v[96:99]
  ds_read_b128 a[100:103], v1 offset:5120
  v_mfma_f32_16x16x32_bf16 v[100:103], a[76:79], v[164:167], v[100:103]
  s_lshl3_add_u32 s40, s41, s40
  s_waitcnt lgkmcnt(4)
  v_mfma_f32_16x16x32_bf16 v[32:35], a[80:83], v[168:171], v[32:35]
  ds_read_b128 a[72:75], v1 offset:6144
  v_mfma_f32_16x16x32_bf16 v[36:39], a[80:83], v[172:175], v[36:39]
  s_add_u32 s40, s40, 148480
  buffer_load_dwordx4 v1, s[36:39], s84 offen offset:2048 sc1 lds
  v_mfma_f32_16x16x32_bf16 v[48:51], a[84:87], v[168:171], v[48:51]
  ds_read_b128 a[76:79], v1 offset:7168
  v_add_u32 v16, s40, v1
  v_mfma_f32_16x16x32_bf16 v[52:55], a[84:87], v[172:175], v[52:55]
  s_waitcnt lgkmcnt(4)
  v_mfma_f32_16x16x32_bf16 v[64:67], a[88:91], v[168:171], v[64:67]
  ds_read_b128 a[80:83], v1 offset:8192
  v_add_u32 v18, 148480, v1
  v_mfma_f32_16x16x32_bf16 v[68:71], a[88:91], v[172:175], v[68:71]
  buffer_load_dwordx4 v1, s[36:39], s84 offen offset:3072 sc1 lds
  v_mfma_f32_16x16x32_bf16 v[80:83], a[92:95], v[168:171], v[80:83]
  ds_read_b128 a[84:87], v1 offset:9216
  s_waitcnt vmcnt(6)
  v_cmp_ne_u32 vcc, v7, v31
  s_cbranch_vccz L_ok6
  s_mov_b32 s83, 0x8000
L_spin6:
  buffer_load_dword v31, v24, s[36:39], s14 offen sc1
  s_waitcnt vmcnt(0)
  v_cmp_ne_u32 vcc, v7, v31
  s_cbranch_vccz L_ok6
  s_sub_u32 s83, s83, 1
  s_cbranch_scc0 L_spin6
  buffer_store_dword v1, off, s[32:35], 0 offset:28 sc1
  s_waitcnt vmcnt(0)
L_ok6:
  v_mfma_f32_16x16x32_bf16 v[84:87], a[92:95], v[172:175], v[84:87]
  s_waitcnt lgkmcnt(4)
  v_mfma_f32_16x16x32_bf16 v[40:43], a[96:99], v[168:171], v[40:43]
  ds_read_b128 a[88:91], v1 offset:10240
  v_mfma_f32_16x16x32_bf16 v[44:47], a[96:99], v[172:175], v[44:47]
  buffer_load_dwordx4 v[104:107], v1, s[36:39], s86 offen sc1
  v_mfma_f32_16x16x32_bf16 v[56:59], a[100:103], v[168:171], v[56:59]
  ds_read_b128 a[92:95], v1 offset:11264
  v_mfma_f32_16x16x32_bf16 v[60:63], a[100:103], v[172:175], v[60:63]
  s_waitcnt lgkmcnt(4)
  v_mfma_f32_16x16x32_bf16 v[72:75], a[72:75], v[168:171], v[72:75]
  ds_read_b128 a[96:99], v1 offset:12288
  v_mfma_f32_16x16x32_bf16 v[76:79], a[72:75], v[172:175], v[76:79]
  buffer_load_dwordx4 v[108:111], v1, s[36:39], s86 offen offset:1024 sc1
  v_mfma_f32_16x16x32_bf16 v[88:91], a[76:79], v[168:171], v[88:91]
  ds_read_b128 a[100:103], v1 offset:13312
  v_mfma_f32_16x16x32_bf16 v[92:95], a[76:79], v[172:175], v[92:95]
  s_waitcnt lgkmcnt(4)
  v_mfma_f32_16x16x32_bf16 v[96:99], a[80:83], v[168:171], v[96:99]
  ds_read_b128 a[72:75], v1 offset:14336
  v_mfma_f32_16x16x32_bf16 v[100:103], a[80:83], v[172:175], v[100:103]
  buffer_load_dwordx4 v[112:115], v1, s[36:39], s86 offen offset:2048 sc1
  v_mfma_f32_16x16x32_bf16 v[32:35], a[84:87], a[104:107], v[32:35]
  ds_read_b128 a[76:79], v1 offset:15360
  v_mfma_f32_16x16x32_bf16 v[36:39], a[84:87], a[108:111], v[36:39]
  s_waitcnt lgkmcnt(4)
  v_mfma_f32_16x16x32_bf16 v[48:51], a[88:91], a[104:107], v[48:51]
  ds_read_b128 a[80:83], v1 offset:16384
  v_mfma_f32_16x16x32_bf16 v[52:55], a[88:91], a[108:111], v[52:55]
  buffer_load_dword v31, v26, s[36:39], s11 offen offset:64 sc1
  v_mfma_f32_16x16x32_bf16 v[64:67], a[92:95], a[104:107], v[64:67]
  ds_read_b128 a[84:87], v1 offset:17408
  v_mfma_f32_16x16x32_bf16 v[68:71], a[92:95], a[108:111], v[68:71]
  buffer_load_dwordx4 v[116:119], v1, s[36:39], s86 offen offset:3072 sc1
  s_waitcnt lgkmcnt(4)
  v_mfma_f32_16x16x32_bf16 v[80:83], a[96:99], a[104:107], v[80:83]
  ds_read_b128 a[88:91], v1 offset:18432
  v_mfma_f32_16x16x32_bf16 v[84:87], a[96:99], a[108:111], v[84:87]
  v_mfma_f32_16x16x32_bf16 v[40:43], a[100:103], a[104:107], v[40:43]
  ds_read_b128 a[92:95], v1 offset:19456
  s_add_u32 s87, s86, 4096
  v_mfma_f32_16x16x32_bf16 v[44:47], a[100:103], a[108:111], v[44:47]
  buffer_load_dwordx4 v[120:123], v1, s[36:39], s87 offen sc1
  s_waitcnt lgkmcnt(4)
  v_mfma_f32_16x16x32_bf16 v[56:59], a[72:75], a[104:107], v[56:59]
  ds_read_b128 a[96:99], v1 offset:20480
  v_mfma_f32_16x16x32_bf16 v[60:63], a[72:75], a[108:111], v[60:63]
  v_mfma_f32_16x16x32_bf16 v[72:75], a[76:79], a[104:107], v[72:75]
  ds_read_b128 a[100:103], v1 offset:21504
  v_mfma_f32_16x16x32_bf16 v[76:79], a[76:79], a[108:111], v[76:79]
  buffer_load_dwordx4 v[124:127], v1, s[36:39], s87 offen offset:1024 sc1
  s_waitcnt lgkmcnt(4)
  v_mfma_f32_16x16x32_bf16 v[88:91], a[80:83], a[104:107], v[88:91]
  ds_read_b128 a[72:75], v1 offset:22528
  v_mfma_f32_16x16x32_bf16 v[92:95], a[80:83], a[108:111], v[92:95]
  v_mfma_f32_16x16x32_bf16 v[96:99], a[84:87], a[104:107], v[96:99]
  ds_read_b128 a[76:79], v1 offset:23552
  v_mfma_f32_16x16x32_bf16 v[100:103], a[84:87], a[108:111], v[100:103]
  buffer_load_dwordx4 v[128:131], v1, s[36:39], s87 offen offset:2048 sc1
  s_waitcnt lgkmcnt(4)
  v_mfma_f32_16x16x32_bf16 v[32:35], a[88:91], a[112:115], v[32:35]
  ds_read_b128 a[80:83], v1 offset:24576
  v_mfma_f32_16x16x32_bf16 v[36:39], a[88:91], a[116:119], v[36:39]
  v_mfma_f32_16x16x32_bf16 v[48:51], a[92:95], a[112:115], v[48:51]
  ds_read_b128 a[84:87], v1 offset:25600
  v_mfma_f32_16x16x32_bf16 v[52:55], a[92:95], a[116:119], v[52:55]
  buffer_load_dwordx4 v[132:135], v1, s[36:39], s87 offen offset:3072 sc1
  s_waitcnt lgkmcnt(4)
  v_mfma_f32_16x16x32_bf16 v[64:67], a[96:99], a[112:115], v[64:67]
  ds_read_b128 a[88:91], v1 offset:26624
  v_mfma_f32_16x16x32_bf16 v[68:71], a[96:99], a[116:119], v[68:71]
  v_mfma_f32_16x16x32_bf16 v[80:83], a[100:103], a[112:115], v[80:83]
  ds_read_b128 a[92:95], v1 offset:27648
  v_mfma_f32_16x16x32_bf16 v[84:87], a[100:103], a[116:119], v[84:87]
  buffer_load_dwordx4 v[136:139], v23, s[36:39], s88 offen sc1
  s_waitcnt lgkmcnt(4)
  v_mfma_f32_16x16x32_bf16 v[40:43], a[72:75], a[112:115], v[40:43]
  ds_read_b128 a[96:99], v1 offset:28672
  v_mfma_f32_16x16x32_bf16 v[44:47], a[72:75], a[116:119], v[44:47]
  v_mfma_f32_16x16x32_bf16 v[56:59], a[76:79], a[112:115], v[56:59]
  ds_read_b128 a[100:103], v1 offset:29696
  s_waitcnt vmcnt(6)
  v_cmp_ne_u32 vcc, v7, v31
  s_cbranch_vccz L_ok5
  s_mov_b32 s83, 0x8000
L_spin5:
  buffer_load_dword v31, v26, s[36:39], s11 offen offset:64 sc1
  s_waitcnt vmcnt(0)
  v_cmp_ne_u32 vcc, v7, v31
  s_cbranch_vccz L_ok5
  s_sub_u32 s83, s83, 1
  s_cbranch_scc0 L_spin5
  buffer_store_dword v1, off, s[32:35], 0 offset:44 sc1
  s_waitcnt vmcnt(0)
L_ok5:
  v_mfma_f32_16x16x32_bf16 v[60:63], a[76:79], a[116:119], v[60:63]
  buffer_load_dwordx4 v[140:143], v23, s[36:39], s88 offen offset:1024 sc1
  s_waitcnt lgkmcnt(4)
  v_mfma_f32_16x16x32_bf16 v[72:75], a[80:83], a[112:115], v[72:75]
  ds_read_b128 a[72:75], v1 offset:30720
  v_mfma_f32_16x16x32_bf16 v[76:79], a[80:83], a[116:119], v[76:79]
  v_mfma_f32_16x16x32_bf16 v[88:91], a[84:87], a[112:115], v[88:91]
  ds_read_b128 a[76:79], v1 offset:31744
  v_mfma_f32_16x16x32_bf16 v[92:95], a[84:87], a[116:119], v[92:95]
  buffer_load_dwordx4 v[144:147], v23, s[36:39], s88 offen offset:2048 sc1
  s_waitcnt lgkmcnt(4)
  v_mfma_f32_16x16x32_bf16 v[96:99], a[88:91], a[112:115], v[96:99]
  ds_read_b128 a[80:83], v1 offset:32768
  v_mfma_f32_16x16x32_bf16 v[100:103], a[88:91], a[116:119], v[100:103]
  v_mfma_f32_16x16x32_bf16 v[32:35], a[92:95], a[120:123], v[32:35]
  ds_read_b128 a[84:87], v1 offset:33792
  v_mfma_f32_16x16x32_bf16 v[36:39], a[92:95], a[124:127], v[36:39]
  buffer_load_dwordx4 v[148:151], v23, s[36:39], s88 offen offset:3072 sc1
  s_waitcnt lgkmcnt(4)
  v_mfma_f32_16x16x32_bf16 v[48:51], a[96:99], a[120:123], v[48:51]
  ds_read_b128 a[88:91], v1 offset:34816
  v_mfma_f32_16x16x32_bf16 v[52:55], a[96:99], a[124:127], v[52:55]
  s_add_u32 s84, s69, 151552
  v_mfma_f32_16x16x32_bf16 v[64:67], a[100:103], a[120:123], v[64:67]
  ds_read_b128 a[92:95], v1 offset:35840
  s_add_u32 m0, s65, 77824
  v_mfma_f32_16x16x32_bf16 v[68:71], a[100:103], a[124:127], v[68:71]
  buffer_load_dwordx4 v1, s[36:39], s84 offen sc1 lds
  s_waitcnt lgkmcnt(4)
  v_mfma_f32_16x16x32_bf16 v[80:83], a[72:75], a[120:123], v[80:83]
  s_barrier
  ds_read_b128 a[96:99], v1 offset:36864
  v_mfma_f32_16x16x32_bf16 v[84:87], a[72:75], a[124:127], v[84:87]
  v_mfma_f32_16x16x32_bf16 v[40:43], a[76:79], a[120:123], v[40:43]
  ds_read_b128 a[100:103], v1 offset:37888
  v_mfma_f32_16x16x32_bf16 v[44:47], a[76:79], a[124:127], v[44:47]
  buffer_load_dwordx4 v1, s[36:39], s84 offen offset:1024 sc1 lds
  s_waitcnt lgkmcnt(4)
  v_mfma_f32_16x16x32_bf16 v[56:59], a[80:83], a[120:123], v[56:59]
  ds_read_b128 a[72:75], v1 offset:38912
  s_lshl2_add_u32 s40, s60, s64
  v_mfma_f32_16x16x32_bf16 v[60:63], a[80:83], a[124:127], v[60:63]
  v_mfma_f32_16x16x32_bf16 v[72:75], a[84:87], a[120:123], v[72:75]
  ds_read_b128 a[76:79], v1 offset:39936
  s_lshl_b32 s94, s40, 6
  v_mfma_f32_16x16x32_bf16 v[76:79], a[84:87], a[124:127], v[76:79]
  buffer_load_dwordx4 v1, s[36:39], s84 offen offset:2048 sc1 lds
  s_waitcnt lgkmcnt(4)
  v_mfma_f32_16x16x32_bf16 v[88:91], a[88:91], a[120:123], v[88:91]
  ds_read_b128 a[80:83], v1 offset:40960
  s_lshl2_add_u32 s94, s63, s94
  v_mfma_f32_16x16x32_bf16 v[92:95], a[88:91], a[124:127], v[92:95]
  v_mfma_f32_16x16x32_bf16 v[96:99], a[92:95], a[120:123], v[96:99]
  ds_read_b128 a[84:87], v1 offset:41984
  s_add_u32 s94, s94, 20480
  s_add_u32 s17, s91, 12288
  v_mfma_f32_16x16x32_bf16 v[100:103], a[92:95], a[124:127], v[100:103]
  buffer_load_dwordx4 a[48:51], v1, s[36:39], s17 offen sc1
  s_waitcnt lgkmcnt(4)
  v_mfma_f32_16x16x32_bf16 v[32:35], a[96:99], a[128:131], v[32:35]
  ds_read_b128 a[88:91], v1 offset:43008
  v_mfma_f32_16x16x32_bf16 v[36:39], a[96:99], a[132:135], v[36:39]
  s_mul_i32 s40, s40, 36864
  v_mfma_f32_16x16x32_bf16 v[48:51], a[100:103], a[128:131], v[48:51]
  ds_read_b128 a[92:95], v1 offset:44032
  v_mfma_f32_16x16x32_bf16 v[52:55], a[100:103], a[132:135], v[52:55]
  s_add_u32 s40, s40, 37748736
  s_waitcnt lgkmcnt(4)
  v_mfma_f32_16x16x32_bf16 v[64:67], a[72:75], a[128:131], v[64:67]
  ds_read_b128 a[96:99], v1 offset:45056
  buffer_load_dwordx4 a[52:55], v1, s[36:39], s17 offen offset:1024 sc1
  v_mfma_f32_16x16x32_bf16 v[68:71], a[72:75], a[132:135], v[68:71]
  s_lshr_b32 s44, s63, 3
  v_mfma_f32_16x16x32_bf16 v[80:83], a[76:79], a[128:131], v[80:83]
  ds_read_b128 a[100:103], v1 offset:46080
  v_mfma_f32_16x16x32_bf16 v[84:87], a[76:79], a[132:135], v[84:87]
  s_waitcnt lgkmcnt(4)
  v_mfma_f32_16x16x32_bf16 v[40:43], a[80:83], a[128:131], v[40:43]
  ds_read_b128 a[72:75], v1 offset:47104
  s_add_u32 s44, s44, 16
  v_mfma_f32_16x16x32_bf16 v[44:47], a[80:83], a[132:135], v[44:47]
  buffer_load_dwordx4 v1, s[36:39], s84 offen offset:3072 sc1 lds
  v_mfma_f32_16x16x32_bf16 v[56:59], a[84:87], a[128:131], v[56:59]
  ds_read_b128 a[76:79], v1 offset:48128
  s_lshl_b32 s44, s44, 10
  v_mfma_f32_16x16x32_bf16 v[60:63], a[84:87], a[132:135], v[60:63]
  s_add_u32 s84, s69, 155648
  s_waitcnt lgkmcnt(4)
  v_mfma_f32_16x16x32_bf16 v[72:75], a[88:91], a[128:131], v[72:75]
  ds_read_b128 a[80:83], v1 offset:49152
  s_add_u32 s44, s44, s40
  v_mfma_f32_16x16x32_bf16 v[76:79], a[88:91], a[132:135], v[76:79]
  s_add_u32 m0, s65, 81920
  s_nop 0
  buffer_load_dwordx4 v1, s[36:39], s84 offen sc1 lds
  v_mfma_f32_16x16x32_bf16 v[88:91], a[92:95], a[128:131], v[88:91]
  ds_read_b128 a[84:87], v1 offset:50176
  s_add_u32 s45, s44, 18432
  v_mfma_f32_16x16x32_bf16 v[92:95], a[92:95], a[132:135], v[92:95]
  s_waitcnt lgkmcnt(4)
  v_mfma_f32_16x16x32_bf16 v[96:99], a[96:99], a[128:131], v[96:99]
  ds_read_b128 a[88:91], v1 offset:51200
  v_mfma_f32_16x16x32_bf16 v[100:103], a[96:99], a[132:135], v[100:103]
  s_lshl_b32 s42, s63, 10
  buffer_load_dwordx4 a[56:59], v1, s[36:39], s17 offen offset:2048 sc1
  v_mfma_f32_16x16x32_bf16 v[32:35], a[100:103], a[136:139], v[32:35]
  ds_read_b128 a[92:95], v1 offset:52224
  v_mfma_f32_16x16x32_bf16 v[36:39], a[100:103], a[140:143], v[36:39]
  s_add_u32 s42, s42, s40
  s_waitcnt lgkmcnt(4)
  v_mfma_f32_16x16x32_bf16 v[48:51], a[72:75], a[136:139], v[48:51]
  ds_read_b128 a[96:99], v1 offset:53248
  v_mfma_f32_16x16x32_bf16 v[52:55], a[72:75], a[140:143], v[52:55]
  s_add_u32 s43, s42, 18432
L_pg7:
  s_cbranch_execz L_pgret
  buffer_load_dwordx4 a[60:63], v1, s[36:39], s17 offen offset:3072 sc1
  v_mfma_f32_16x16x32_bf16 v[64:67], a[76:79], a[136:139], v[64:67]
  ds_read_b128 a[100:103], v1 offset:54272
  v_mfma_f32_16x16x32_bf16 v[68:71], a[76:79], a[140:143], v[68:71]
  s_waitcnt lgkmcnt(4)
  v_mfma_f32_16x16x32_bf16 v[80:83], a[80:83], a[136:139], v[80:83]
  ds_read_b128 a[72:75], v4
  s_mov_b64 s[40:41], 0xffff
  v_mfma_f32_16x16x32_bf16 v[84:87], a[80:83], a[140:143], v[84:87]
  s_add_u32 s17, s91, 16384
  buffer_load_dwordx4 a[64:67], v1, s[36:39], s17 offen sc1
  v_mfma_f32_16x16x32_bf16 v[40:43], a[84:87], a[136:139], v[40:43]
  ds_read_b128 a[76:79], v4 offset:1024
  s_lshl2_add_u32 s86, s60, s61
  v_mfma_f32_16x16x32_bf16 v[44:47], a[84:87], a[140:143], v[44:47]
  s_waitcnt lgkmcnt(4)
  v_mfma_f32_16x16x32_bf16 v[56:59], a[88:91], a[136:139], v[56:59]
  ds_read_b128 a[80:83], v4 offset:2048
  s_lshl_b32 s95, s86, 6
  v_mfma_f32_16x16x32_bf16 v[60:63], a[88:91], a[140:143], v[60:63]
  buffer_load_dwordx4 a[68:71], v1, s[36:39], s17 offen offset:1024 sc1
  v_mfma_f32_16x16x32_bf16 v[72:75], a[92:95], a[136:139], v[72:75]
  ds_read_b128 a[84:87], v4 offset:3072
  s_add_u32 s95, s95, 20480
  v_mfma_f32_16x16x32_bf16 v[76:79], a[92:95], a[140:143], v[76:79]
  s_add_u32 s84, s69, 184320
  s_waitcnt lgkmcnt(4)
  v_mfma_f32_16x16x32_bf16 v[88:91], a[96:99], a[136:139], v[88:91]
  ds_read_b128 a[88:91], v4 offset:4096
  s_add_u32 m0, s65, 0
  v_mfma_f32_16x16x32_bf16 v[92:95], a[96:99], a[140:143], v[92:95]
  s_mul_i32 s86, s86, 36864
  buffer_load_dwordx4 v1, s[36:39], s84 offen sc1 lds
  v_mfma_f32_16x16x32_bf16 v[96:99], a[100:103], a[136:139], v[96:99]
  ds_read_b128 a[92:95], v4 offset:5120
  v_mfma_f32_16x16x32_bf16 v[248:251], a[250:253], v[104:107], 0
  v_mfma_f32_16x16x32_bf16 v[248:251], a[250:253], v[108:111], v[248:251]
  v_mfma_f32_16x16x32_bf16 v[100:103], a[100:103], a[140:143], v[100:103]
  v_mfma_f32_16x16x32_bf16 v[248:251], a[250:253], v[112:115], v[248:251]
  s_waitcnt vmcnt(20)
  v_mfma_f32_16x16x32_bf16 v[248:251], a[250:253], v[116:119], v[248:251]
  s_waitcnt lgkmcnt(4)
  v_mfma_f32_16x16x32_bf16 v[32:35], a[72:75], a[40:43], v[32:35]
  ds_read_b128 a[96:99], v4 offset:6144
  s_waitcnt vmcnt(19)
  v_mfma_f32_16x16x32_bf16 v[248:251], a[250:253], v[120:123], v[248:251]
  s_waitcnt vmcnt(18)
  v_mfma_f32_16x16x32_bf16 v[248:251], a[250:253], v[124:127], v[248:251]
  v_mfma_f32_16x16x32_bf16 v[36:39], a[72:75], a[44:47], v[36:39]
  s_waitcnt vmcnt(17)
  v_mfma_f32_16x16x32_bf16 v[248:251], a[250:253], v[128:131], v[248:251]
  s_waitcnt vmcnt(16)
  v_mfma_f32_16x16x32_bf16 v[248:251], a[250:253], v[132:135], v[248:251]
  buffer_load_dwordx4 v1, s[36:39], s84 offen offset:1024 sc1 lds
  v_mfma_f32_16x16x32_bf16 v[48:51], a[76:79], a[40:43], v[48:51]
  ds_read_b128 a[100:103], v4 offset:7168
  s_waitcnt vmcnt(16)
  v_mfma_f32_16x16x32_bf16 v[252:255], a[250:253], v[136:139], 0
  s_waitcnt vmcnt(15)
  v_mfma_f32_16x16x32_bf16 v[252:255], a[250:253], v[140:143], v[252:255]
  v_mfma_f32_16x16x32_bf16 v[52:55], a[76:79], a[44:47], v[52:55]
  s_waitcnt vmcnt(14)
  v_mfma_f32_16x16x32_bf16 v[252:255], a[250:253], v[144:147], v[252:255]
  s_waitcnt vmcnt(13)
  v_mfma_f32_16x16x32_bf16 v[252:255], a[250:253], v[148:151], v[252:255]
  s_waitcnt lgkmcnt(4)
  v_mfma_f32_16x16x32_bf16 v[64:67], a[80:83], a[40:43], v[64:67]
  ds_read_b128 a[72:75], v4 offset:8192
  v_mfma_f32_16x16x32_bf16 v[68:71], a[80:83], a[44:47], v[68:71]
  s_add_u32 s86, s86, 37748736
  buffer_load_dwordx4 v1, s[36:39], s84 offen offset:2048 sc1 lds
  v_mfma_f32_16x16x32_bf16 v[80:83], a[84:87], a[40:43], v[80:83]
  ds_read_b128 a[76:79], v4 offset:9216
  v_cvt_pk_bf16_f32 v248, v248, v249
  v_mfma_f32_16x16x32_bf16 v[84:87], a[84:87], a[44:47], v[84:87]
  v_cvt_pk_bf16_f32 v249, v250, v251
  s_waitcnt lgkmcnt(4)
  v_mfma_f32_16x16x32_bf16 v[40:43], a[88:91], a[40:43], v[40:43]
  ds_read_b128 a[80:83], v4 offset:10240
  v_mfma_f32_16x16x32_bf16 v[44:47], a[88:91], a[44:47], v[44:47]
  ds_write_b64 v16, v[248:249]
  s_add_u32 s86, s86, s65
  v_mfma_f32_16x16x32_bf16 v[56:59], a[92:95], a[40:43], v[56:59]
  ds_read_b128 a[84:87], v4 offset:11264
  buffer_load_dwordx4 v1, s[36:39], s84 offen offset:3072 sc1 lds
  v_mfma_f32_16x16x32_bf16 v[60:63], a[92:95], a[44:47], v[60:63]
  v_permlane32_swap_b32 v252, v254
  s_waitcnt lgkmcnt(5)
  v_mfma_f32_16x16x32_bf16 v[72:75], a[96:99], a[40:43], v[72:75]
  ds_read_b128 a[88:91], v4 offset:12288
  v_mfma_f32_16x16x32_bf16 v[76:79], a[96:99], a[44:47], v[76:79]
  v_permlane32_swap_b32 v253, v255
  s_mul_i32 s88, s64, 46080
  s_add_u32 s84, s69, 188416
  v_mfma_f32_16x16x32_bf16 v[88:91], a[100:103], a[40:43], v[88:91]
  ds_read_b128 a[92:95], v4 offset:13312
  v_add_f32 v252, v252, v254
  s_add_u32 m0, s65, 4096
  v_mfma_f32_16x16x32_bf16 v[92:95], a[100:103], a[44:47], v[92:95]
  buffer_load_dwordx4 v1, s[36:39], s84 offen sc1 lds
  s_waitcnt lgkmcnt(5)
  v_mfma_f32_16x16x32_bf16 v[96:99], a[72:75], a[40:43], v[96:99]
  ds_read_b128 a[96:99], v4 offset:14336
  v_add_f32 v253, v253, v255
  v_mfma_f32_16x16x32_bf16 v[100:103], a[72:75], a[44:47], v[100:103]
  s_add_u32 s88, s88, s98
  s_waitcnt vmcnt(12)
  v_mfma_f32_16x16x32_bf16 v[32:35], a[76:79], a[48:51], v[32:35]
  ds_read_b128 a[100:103], v4 offset:15360
  v_cvt_pk_bf16_f32 v252, v252, v253
  s_waitcnt vmcnt(11)
  v_mfma_f32_16x16x32_bf16 v[36:39], a[76:79], a[52:55], v[36:39]
  buffer_load_dwordx4 v1, s[36:39], s84 offen offset:1024 sc1 lds
  s_waitcnt lgkmcnt(4)
  v_mfma_f32_16x16x32_bf16 v[48:51], a[80:83], a[48:51], v[48:51]
  ds_read_b128 a[72:75], v4 offset:16384
  ds_write_b32 v17, v252
  v_mfma_f32_16x16x32_bf16 v[52:55], a[80:83], a[52:55], v[52:55]
  s_add_u32 s88, s88, 8192
  v_mfma_f32_16x16x32_bf16 v[64:67], a[84:87], a[48:51], v[64:67]
  ds_read_b128 a[76:79], v4 offset:17408
  v_mfma_f32_16x16x32_bf16 v[68:71], a[84:87], a[52:55], v[68:71]
  buffer_load_dwordx4 v1, s[36:39], s84 offen offset:2048 sc1 lds
  s_waitcnt lgkmcnt(5)
  v_mfma_f32_16x16x32_bf16 v[80:83], a[88:91], a[48:51], v[80:83]
  s_waitcnt vmcnt(11) lgkmcnt(1)
  s_barrier
  ds_read_b128 a[80:83], v4 offset:18432
  v_mfma_f32_16x16x32_bf16 v[84:87], a[88:91], a[52:55], v[84:87]
  ds_read_b128 v[104:107], v18
  v_mfma_f32_16x16x32_bf16 v[40:43], a[92:95], a[48:51], v[40:43]
  ds_read_b128 a[84:87], v4 offset:19456
  ds_read_b128 v[108:111], v18 offset:1024
  v_mfma_f32_16x16x32_bf16 v[44:47], a[92:95], a[52:55], v[44:47]
  ds_read_b64 v[112:113], v8
  buffer_load_dwordx4 v1, s[36:39], s84 offen offset:3072 sc1 lds
  v_mfma_f32_16x16x32_bf16 v[56:59], a[96:99], a[48:51], v[56:59]
  ds_read_b128 a[88:91], v4 offset:20480
  ds_read_b64 v[114:115], v8 offset:256
  v_mfma_f32_16x16x32_bf16 v[60:63], a[96:99], a[52:55], v[60:63]
  ds_read_b64 v[116:117], v9 offset:512
  s_add_u32 s84, s69, 192512
  v_mfma_f32_16x16x32_bf16 v[72:75], a[100:103], a[48:51], v[72:75]
  ds_read_b128 a[92:95], v4 offset:21504
  ds_read_b64 v[118:119], v9 offset:768
  s_add_u32 m0, s65, 8192
  v_mfma_f32_16x16x32_bf16 v[76:79], a[100:103], a[52:55], v[76:79]
  ds_read_b64 v[120:121], v10
  buffer_load_dwordx4 v1, s[36:39], s84 offen sc1 lds
  s_waitcnt lgkmcnt(11)
  v_mfma_f32_16x16x32_bf16 v[88:91], a[72:75], a[48:51], v[88:91]
  ds_read_b128 a[96:99], v4 offset:22528
  ds_read_b64 v[122:123], v11 offset:512
  v_mfma_f32_16x16x32_bf16 v[92:95], a[72:75], a[52:55], v[92:95]
  ds_read_b64 v[124:125], v12 offset:256
  s_add_u32 s84, s69, 221184
  v_mfma_f32_16x16x32_bf16 v[96:99], a[76:79], a[48:51], v[96:99]
  ds_read_b128 a[100:103], v4 offset:23552
  ds_read_b64 v[128:129], v13
  s_add_u32 m0, s65, 36864
  v_mfma_f32_16x16x32_bf16 v[100:103], a[76:79], a[52:55], v[100:103]
  buffer_load_dwordx4 v1, s[36:39], s84 offen sc1 lds
  s_waitcnt vmcnt(13) lgkmcnt(13)
  v_mfma_f32_16x16x32_bf16 v[32:35], a[80:83], a[56:59], v[32:35]
  ds_read_b128 a[72:75], v4 offset:24576
  ds_read_b64 v[130:131], v13 offset:8
  s_waitcnt vmcnt(12)
  v_mfma_f32_16x16x32_bf16 v[36:39], a[80:83], a[60:63], v[36:39]
  ds_read_b64 v[132:133], v13 offset:72
  v_mfma_f32_16x16x32_bf16 v[48:51], a[84:87], a[56:59], v[48:51]
  ds_read_b128 a[76:79], v4 offset:25600
  ds_read_b64 v[134:135], v13 offset:80
  v_mfma_f32_16x16x32_bf16 v[52:55], a[84:87], a[60:63], v[52:55]
  ds_read_b64 v[136:137], v14
  buffer_load_dwordx4 v1, s[36:39], s84 offen offset:1024 sc1 lds
  s_waitcnt lgkmcnt(13)
  v_mfma_f32_16x16x32_bf16 v[64:67], a[88:91], a[56:59], v[64:67]
  ds_read_b128 a[80:83], v4 offset:26624
  ds_read_b64 v[138:139], v13 offset:4736
  v_mfma_f32_16x16x32_bf16 v[68:71], a[88:91], a[60:63], v[68:71]
  ds_read_b64 v[140:141], v13 offset:4744
  v_mfma_f32_16x16x32_bf16 v[80:83], a[92:95], a[56:59], v[80:83]
  ds_read_b128 a[84:87], v4 offset:27648
  ds_read_b64 v[142:143], v13 offset:4808
  v_mfma_f32_16x16x32_bf16 v[84:87], a[92:95], a[60:63], v[84:87]
  ds_read_b64 v[144:145], v13 offset:4816
  buffer_load_dwordx4 v1, s[36:39], s84 offen offset:2048 sc1 lds
  s_waitcnt lgkmcnt(13)
  v_mfma_f32_16x16x32_bf16 v[40:43], a[96:99], a[56:59], v[40:43]
  ds_read_b128 a[88:91], v4 offset:28672
  ds_read_b64 v[146:147], v14 offset:4736
  v_mfma_f32_16x16x32_bf16 v[44:47], a[96:99], a[60:63], v[44:47]
  v_mfma_f32_16x16x32_bf16 v[56:59], a[100:103], a[56:59], v[56:59]
  ds_read_b128 a[92:95], v4 offset:29696
  v_mfma_f32_16x16x32_bf16 v[60:63], a[100:103], a[60:63], v[60:63]
  s_waitcnt lgkmcnt(13)
  v_mfma_f32_16x16x32_bf16 v[160:163], v[112:115], v[128:131], 0
  s_waitcnt lgkmcnt(6)
  v_mfma_f32_16x16x32_bf16 v[172:175], v[112:115], v[138:141], 0
  buffer_load_dwordx4 v1, s[36:39], s84 offen offset:3072 sc1 lds
  v_mfma_f32_16x16x32_bf16 v[72:75], a[72:75], a[56:59], v[72:75]
  ds_read_b128 a[96:99], v4 offset:30720
  v_mfma_f32_16x16x32_bf16 v[152:155], v[104:107], v[128:131], 0
  v_mfma_f32_16x16x32_bf16 v[164:167], v[104:107], v[138:141], 0
  v_mfma_f32_16x16x32_bf16 v[76:79], a[72:75], a[60:63], v[76:79]
  v_mfma_f32_16x16x32_bf16 v[156:159], v[108:111], v[132:135], 0
  s_waitcnt lgkmcnt(4)
  v_mfma_f32_16x16x32_bf16 v[168:171], v[108:111], v[142:145], 0
  v_mfma_f32_16x16x32_bf16 v[88:91], a[76:79], a[56:59], v[88:91]
  ds_read_b128 a[100:103], v4 offset:31744
  v_mfma_f32_16x16x32_bf16 v[160:163], v[116:119], v[132:135], v[160:163]
  s_add_u32 s84, s69, 225280
  s_add_u32 m0, s65, 40960
  v_mfma_f32_16x16x32_bf16 v[92:95], a[76:79], a[60:63], v[92:95]
  v_mfma_f32_16x16x32_bf16 v[172:175], v[116:119], v[142:145], v[172:175]
  v_mfma_f32_16x16x16_bf16 v[152:155], v[120:121], v[136:137], v[152:155]
  buffer_load_dwordx4 v1, s[36:39], s84 offen sc1 lds
  v_mfma_f32_16x16x32_bf16 v[96:99], a[80:83], a[56:59], v[96:99]
  ds_read_b128 a[72:75], v4 offset:32768
  s_waitcnt lgkmcnt(4)
  v_mfma_f32_16x16x16_bf16 v[164:167], v[120:121], v[146:147], v[164:167]
  v_mfma_f32_16x16x16_bf16 v[156:159], v[122:123], v[136:137], v[156:159]
  v_mfma_f32_16x16x32_bf16 v[100:103], a[80:83], a[60:63], v[100:103]
  v_mfma_f32_16x16x16_bf16 v[168:171], v[122:123], v[146:147], v[168:171]
  v_mfma_f32_16x16x16_bf16 v[160:163], v[124:125], v[136:137], v[160:163]
  s_waitcnt vmcnt(15)
  v_mfma_f32_16x16x32_bf16 v[32:35], a[84:87], a[64:67], v[32:35]
  ds_read_b128 a[76:79], v4 offset:33792
  v_mfma_f32_16x16x16_bf16 v[172:175], v[124:125], v[146:147], v[172:175]
  s_waitcnt vmcnt(14)
  v_mfma_f32_16x16x32_bf16 v[36:39], a[84:87], a[68:71], v[36:39]
  buffer_load_dwordx4 v1, s[36:39], s84 offen offset:1024 sc1 lds
  s_waitcnt lgkmcnt(4)
  v_mfma_f32_16x16x32_bf16 v[48:51], a[88:91], a[64:67], v[48:51]
  ds_read_b128 a[80:83], v4 offset:34816
  v_mfma_f32_16x16x32_bf16 v[52:55], a[88:91], a[68:71], v[52:55]
  v_add_f32 v160, 0x358637bd, v160
  v_add_f32 v161, 0x358637bd, v161
  v_mfma_f32_16x16x32_bf16 v[64:67], a[92:95], a[64:67], v[64:67]
  ds_read_b128 a[84:87], v4 offset:35840
  v_rcp_f32 v160, v160
  v_mfma_f32_16x16x32_bf16 v[68:71], a[92:95], a[68:71], v[68:71]
  v_rcp_f32 v161, v161
  buffer_load_dwordx4 v1, s[36:39], s84 offen offset:2048 sc1 lds
  s_waitcnt lgkmcnt(4)
  v_mfma_f32_16x16x32_bf16 v[80:83], a[96:99], a[64:67], v[80:83]
  ds_read_b128 a[88:91], v4 offset:36864
  v_mul_f32 v152, v160, v152
  v_mfma_f32_16x16x32_bf16 v[84:87], a[96:99], a[68:71], v[84:87]
  v_mul_f32 v153, v160, v153
  v_mul_f32 v154, v160, v154
  v_mfma_f32_16x16x32_bf16 v[40:43], a[100:103], a[64:67], v[40:43]
  ds_read_b128 a[92:95], v4 offset:37888
  v_mul_f32 v155, v160, v155
  v_mfma_f32_16x16x32_bf16 v[44:47], a[100:103], a[68:71], v[44:47]
  v_mul_f32 v156, v161, v156
  buffer_load_dwordx4 v1, s[36:39], s84 offen offset:3072 sc1 lds
  s_waitcnt lgkmcnt(4)
  v_mfma_f32_16x16x32_bf16 v[56:59], a[72:75], a[64:67], v[56:59]
  ds_read_b128 a[96:99], v4 offset:38912
  v_mul_f32 v157, v161, v157
  v_mfma_f32_16x16x32_bf16 v[60:63], a[72:75], a[68:71], v[60:63]
  v_mul_f32 v158, v161, v158
  v_mul_f32 v159, v161, v159
  s_add_u32 s84, s69, 229376
  v_mfma_f32_16x16x32_bf16 v[72:75], a[76:79], a[64:67], v[72:75]
  ds_read_b128 a[100:103], v4 offset:39936
  v_cndmask_b32 v160, v161, v160, s[40:41]
  s_add_u32 m0, s65, 45056
  v_mfma_f32_16x16x32_bf16 v[76:79], a[76:79], a[68:71], v[76:79]
  v_cvt_pk_bf16_f32 v152, v152, v153
  buffer_load_dwordx4 v1, s[36:39], s84 offen sc1 lds
  s_waitcnt lgkmcnt(4)
  v_mfma_f32_16x16x32_bf16 v[88:91], a[80:83], a[64:67], v[88:91]
  ds_read_b128 a[72:75], v4 offset:40960
  v_cvt_pk_bf16_f32 v153, v154, v155
  v_mfma_f32_16x16x32_bf16 v[92:95], a[80:83], a[68:71], v[92:95]
  v_cvt_pk_bf16_f32 v154, v156, v157
  v_cvt_pk_bf16_f32 v155, v158, v159
  v_mfma_f32_16x16x32_bf16 v[96:99], a[84:87], a[64:67], v[96:99]
  ds_read_b128 a[76:79], v4 offset:41984
  v_mul_f32 v162, v160, v162
  s_add_u32 s15, s92, 12288
  v_mfma_f32_16x16x32_bf16 v[100:103], a[84:87], a[68:71], v[100:103]
  v_mul_f32 v163, v160, v163
  buffer_load_dwordx4 v[224:227], v1, s[36:39], s15 offen sc1
  s_waitcnt lgkmcnt(4)
  v_mfma_f32_16x16x32_bf16 v[32:35], a[88:91], v[176:179], v[32:35]
  ds_read_b128 a[80:83], v4 offset:43008
  v_cvt_pk_bf16_f32 v162, v162, v163
  v_mfma_f32_16x16x32_bf16 v[36:39], a[88:91], v[180:183], v[36:39]
  v_add_f32 v172, 0x358637bd, v172
  v_add_f32 v173, 0x358637bd, v173
  v_mfma_f32_16x16x32_bf16 v[48:51], a[92:95], v[176:179], v[48:51]
  ds_read_b128 a[84:87], v4 offset:44032
  v_rcp_f32 v172, v172
  v_mfma_f32_16x16x32_bf16 v[52:55], a[92:95], v[180:183], v[52:55]
  v_rcp_f32 v173, v173
  buffer_store_dwordx4 v[152:155], v1, s[36:39], s42 offen sc1
  s_waitcnt lgkmcnt(4)
  v_mfma_f32_16x16x32_bf16 v[64:67], a[96:99], v[176:179], v[64:67]
  ds_read_b128 a[88:91], v4 offset:45056
  v_mul_f32 v164, v172, v164
  v_mfma_f32_16x16x32_bf16 v[68:71], a[96:99], v[180:183], v[68:71]
  v_mul_f32 v165, v172, v165
  v_mul_f32 v166, v172, v166
  v_mfma_f32_16x16x32_bf16 v[80:83], a[100:103], v[176:179], v[80:83]
  ds_read_b128 a[92:95], v4 offset:46080
  v_mul_f32 v167, v172, v167
  v_mfma_f32_16x16x32_bf16 v[84:87], a[100:103], v[180:183], v[84:87]
  v_mul_f32 v168, v173, v168
  buffer_store_dword v162, v15, s[36:39], s44 offen sc1
  s_waitcnt lgkmcnt(4)
  v_mfma_f32_16x16x32_bf16 v[40:43], a[72:75], v[176:179], v[40:43]
  ds_read_b128 a[96:99], v4 offset:47104
  v_mul_f32 v169, v173, v169
  v_mfma_f32_16x16x32_bf16 v[44:47], a[72:75], v[180:183], v[44:47]
  v_mul_f32 v170, v173, v170
  v_mul_f32 v171, v173, v171
  buffer_load_dwordx4 v[228:231], v1, s[36:39], s15 offen offset:1024 sc1
  v_mfma_f32_16x16x32_bf16 v[56:59], a[76:79], v[176:179], v[56:59]
  ds_read_b128 a[100:103], v4 offset:48128
  v_cndmask_b32 v172, v173, v172, s[40:41]
  v_mfma_f32_16x16x32_bf16 v[60:63], a[76:79], v[180:183], v[60:63]
  v_cvt_pk_bf16_f32 v164, v164, v165
  s_waitcnt lgkmcnt(4)
  v_mfma_f32_16x16x32_bf16 v[72:75], a[80:83], v[176:179], v[72:75]
  ds_read_b128 a[72:75], v4 offset:49152
  v_cvt_pk_bf16_f32 v165, v166, v167
  v_mfma_f32_16x16x32_bf16 v[76:79], a[80:83], v[180:183], v[76:79]
  v_cvt_pk_bf16_f32 v166, v168, v169
  v_cvt_pk_bf16_f32 v167, v170, v171
  buffer_load_dwordx4 v[232:235], v1, s[36:39], s15 offen offset:2048 sc1
  v_mfma_f32_16x16x32_bf16 v[88:91], a[84:87], v[176:179], v[88:91]
  ds_read_b128 a[76:79], v4 offset:50176
  v_mul_f32 v174, v172, v174
  v_mfma_f32_16x16x32_bf16 v[92:95], a[84:87], v[180:183], v[92:95]
  v_mul_f32 v175, v172, v175
  s_waitcnt lgkmcnt(4)
  v_mfma_f32_16x16x32_bf16 v[96:99], a[88:91], v[176:179], v[96:99]
  ds_read_b128 a[80:83], v4 offset:51200
  v_cvt_pk_bf16_f32 v174, v174, v175
  v_mfma_f32_16x16x32_bf16 v[100:103], a[88:91], v[180:183], v[100:103]
  buffer_store_dwordx4 v[164:167], v1, s[36:39], s43 offen sc1
  v_mfma_f32_16x16x32_bf16 v[32:35], a[92:95], v[184:187], v[32:35]
  ds_read_b128 a[84:87], v4 offset:52224
  v_mfma_f32_16x16x32_bf16 v[36:39], a[92:95], v[188:191], v[36:39]
  s_waitcnt lgkmcnt(4)
  v_mfma_f32_16x16x32_bf16 v[48:51], a[96:99], v[184:187], v[48:51]
  ds_read_b128 a[88:91], v4 offset:53248
  v_mfma_f32_16x16x32_bf16 v[52:55], a[96:99], v[188:191], v[52:55]
  buffer_store_dword v174, v15, s[36:39], s45 offen sc1
  v_mfma_f32_16x16x32_bf16 v[64:67], a[100:103], v[184:187], v[64:67]
  ds_read_b128 a[92:95], v4 offset:54272
  v_mfma_f32_16x16x32_bf16 v[68:71], a[100:103], v[188:191], v[68:71]
  buffer_load_dwordx4 v[236:239], v1, s[36:39], s15 offen offset:3072 sc1
  s_waitcnt lgkmcnt(4)
  v_mfma_f32_16x16x32_bf16 v[80:83], a[72:75], v[184:187], v[80:83]
  s_waitcnt vmcnt(17)
  s_barrier
  ds_read_b128 a[96:99], v1
  v_mfma_f32_16x16x32_bf16 v[84:87], a[72:75], v[188:191], v[84:87]
  s_add_u32 s84, s69, 258048
  v_mfma_f32_16x16x32_bf16 v[40:43], a[76:79], v[184:187], v[40:43]
  ds_read_b128 a[100:103], v1 offset:1024
  s_add_u32 m0, s65, 73728
  v_mfma_f32_16x16x32_bf16 v[44:47], a[76:79], v[188:191], v[44:47]
  buffer_load_dwordx4 v1, s[36:39], s84 offen sc1 lds
  s_waitcnt lgkmcnt(4)
  v_mfma_f32_16x16x32_bf16 v[56:59], a[80:83], v[184:187], v[56:59]
  ds_read_b128 a[72:75], v1 offset:2048
  v_mfma_f32_16x16x32_bf16 v[60:63], a[80:83], v[188:191], v[60:63]
  v_mfma_f32_16x16x32_bf16 v[72:75], a[84:87], v[184:187], v[72:75]
  ds_read_b128 a[76:79], v1 offset:3072
  v_mfma_f32_16x16x32_bf16 v[76:79], a[84:87], v[188:191], v[76:79]
  buffer_load_dwordx4 v1, s[36:39], s84 offen offset:1024 sc1 lds
  s_waitcnt lgkmcnt(4)
  v_mfma_f32_16x16x32_bf16 v[88:91], a[88:91], v[184:187], v[88:91]
  ds_read_b128 a[80:83], v1 offset:4096
  v_mfma_f32_16x16x32_bf16 v[92:95], a[88:91], v[188:191], v[92:95]
  v_mfma_f32_16x16x32_bf16 v[96:99], a[92:95], v[184:187], v[96:99]
  ds_read_b128 a[84:87], v1 offset:5120
  v_mfma_f32_16x16x32_bf16 v[100:103], a[92:95], v[188:191], v[100:103]
  buffer_load_dwordx4 v1, s[36:39], s84 offen offset:2048 sc1 lds
  s_waitcnt lgkmcnt(4)
  v_mfma_f32_16x16x32_bf16 v[32:35], a[96:99], v[192:195], v[32:35]
  ds_read_b128 a[88:91], v1 offset:6144
  v_mfma_f32_16x16x32_bf16 v[36:39], a[96:99], v[196:199], v[36:39]
  v_mfma_f32_16x16x32_bf16 v[48:51], a[100:103], v[192:195], v[48:51]
  ds_read_b128 a[92:95], v1 offset:7168
  s_add_u32 s15, s92, 16384
  v_mfma_f32_16x16x32_bf16 v[52:55], a[100:103], v[196:199], v[52:55]
  buffer_load_dwordx4 v[240:243], v1, s[36:39], s15 offen sc1
  s_waitcnt lgkmcnt(4)
  v_mfma_f32_16x16x32_bf16 v[64:67], a[72:75], v[192:195], v[64:67]
  ds_read_b128 a[96:99], v1 offset:8192
  v_mfma_f32_16x16x32_bf16 v[68:71], a[72:75], v[196:199], v[68:71]
  v_mfma_f32_16x16x32_bf16 v[80:83], a[76:79], v[192:195], v[80:83]
  ds_read_b128 a[100:103], v1 offset:9216
  v_mfma_f32_16x16x32_bf16 v[84:87], a[76:79], v[196:199], v[84:87]
  buffer_load_dwordx4 v[244:247], v1, s[36:39], s15 offen offset:1024 sc1
  s_waitcnt lgkmcnt(4)
  v_mfma_f32_16x16x32_bf16 v[40:43], a[80:83], v[192:195], v[40:43]
  ds_read_b128 a[72:75], v1 offset:10240
  v_mfma_f32_16x16x32_bf16 v[44:47], a[80:83], v[196:199], v[44:47]
  v_mfma_f32_16x16x32_bf16 v[56:59], a[84:87], v[192:195], v[56:59]
  ds_read_b128 a[76:79], v1 offset:11264
  v_mfma_f32_16x16x32_bf16 v[60:63], a[84:87], v[196:199], v[60:63]
  buffer_load_dwordx4 v1, s[36:39], s84 offen offset:3072 sc1 lds
  s_waitcnt lgkmcnt(4)
  v_mfma_f32_16x16x32_bf16 v[72:75], a[88:91], v[192:195], v[72:75]
  ds_read_b128 a[80:83], v1 offset:12288
  v_mfma_f32_16x16x32_bf16 v[76:79], a[88:91], v[196:199], v[76:79]
  s_add_u32 s84, s69, 262144
  v_mfma_f32_16x16x32_bf16 v[88:91], a[92:95], v[192:195], v[88:91]
  ds_read_b128 a[84:87], v1 offset:13312
  s_add_u32 m0, s65, 77824
  v_mfma_f32_16x16x32_bf16 v[92:95], a[92:95], v[196:199], v[92:95]
  buffer_load_dwordx4 v1, s[36:39], s84 offen sc1 lds
  s_waitcnt lgkmcnt(4)
  v_mfma_f32_16x16x32_bf16 v[96:99], a[96:99], v[192:195], v[96:99]
  ds_read_b128 a[88:91], v1 offset:14336
  v_mfma_f32_16x16x32_bf16 v[100:103], a[96:99], v[196:199], v[100:103]
  v_mfma_f32_16x16x32_bf16 v[32:35], a[100:103], v[200:203], v[32:35]
  ds_read_b128 a[92:95], v1 offset:15360
  v_mfma_f32_16x16x32_bf16 v[36:39], a[100:103], v[204:207], v[36:39]
  buffer_load_dwordx4 v1, s[36:39], s84 offen offset:1024 sc1 lds
  s_waitcnt lgkmcnt(4)
  v_mfma_f32_16x16x32_bf16 v[48:51], a[72:75], v[200:203], v[48:51]
  ds_read_b128 a[96:99], v1 offset:16384
  v_mfma_f32_16x16x32_bf16 v[52:55], a[72:75], v[204:207], v[52:55]
  v_mfma_f32_16x16x32_bf16 v[64:67], a[76:79], v[200:203], v[64:67]
  ds_read_b128 a[100:103], v1 offset:17408
  v_mfma_f32_16x16x32_bf16 v[68:71], a[76:79], v[204:207], v[68:71]
  buffer_load_dwordx4 v1, s[36:39], s84 offen offset:2048 sc1 lds
  s_waitcnt lgkmcnt(4)
  v_mfma_f32_16x16x32_bf16 v[80:83], a[80:83], v[200:203], v[80:83]
  ds_read_b128 a[72:75], v1 offset:18432
  v_mfma_f32_16x16x32_bf16 v[84:87], a[80:83], v[204:207], v[84:87]
  v_mfma_f32_16x16x32_bf16 v[40:43], a[84:87], v[200:203], v[40:43]
  ds_read_b128 a[76:79], v1 offset:19456
  v_mfma_f32_16x16x32_bf16 v[44:47], a[84:87], v[204:207], v[44:47]
  buffer_load_dwordx4 a[4:7], v1, s[36:39], s93 offen offset:1024 sc1
  s_waitcnt lgkmcnt(4)
  v_mfma_f32_16x16x32_bf16 v[56:59], a[88:91], v[200:203], v[56:59]
  ds_read_b128 a[80:83], v1 offset:20480
  v_mfma_f32_16x16x32_bf16 v[60:63], a[88:91], v[204:207], v[60:63]
  v_mfma_f32_16x16x32_bf16 v[72:75], a[92:95], v[200:203], v[72:75]
  ds_read_b128 a[84:87], v1 offset:21504
  s_waitcnt vmcnt(11)
  v_mfma_f32_16x16x32_bf16 v[76:79], a[92:95], v[204:207], v[76:79]
  buffer_store_dword v7, v27, s[36:39], s94 offen sc1
  s_waitcnt lgkmcnt(4)
  v_mfma_f32_16x16x32_bf16 v[88:91], a[96:99], v[200:203], v[88:91]
  ds_read_b128 a[88:91], v1 offset:22528
  v_mfma_f32_16x16x32_bf16 v[92:95], a[96:99], v[204:207], v[92:95]
  buffer_load_dwordx4 v1, s[36:39], s84 offen offset:3072 sc1 lds
  v_mfma_f32_16x16x32_bf16 v[96:99], a[100:103], v[200:203], v[96:99]
  ds_read_b128 a[92:95], v1 offset:23552
  v_mfma_f32_16x16x32_bf16 v[100:103], a[100:103], v[204:207], v[100:103]
  s_add_u32 s84, s69, 266240
  s_waitcnt lgkmcnt(4)
  v_mfma_f32_16x16x32_bf16 v[32:35], a[72:75], v[208:211], v[32:35]
  ds_read_b128 a[96:99], v1 offset:24576
  s_lshl_b32 s40, s61, 7
  s_add_u32 m0, s65, 81920
  v_mfma_f32_16x16x32_bf16 v[36:39], a[72:75], v[212:215], v[36:39]
  s_and_b32 s41, s64, 1
  buffer_load_dwordx4 v1, s[36:39], s84 offen sc1 lds
  v_mfma_f32_16x16x32_bf16 v[48:51], a[76:79], v[208:211], v[48:51]
  ds_read_b128 a[100:103], v1 offset:25600
  s_lshl_b32 s42, s41, 6
  v_mfma_f32_16x16x32_bf16 v[52:55], a[76:79], v[212:215], v[52:55]
  s_waitcnt lgkmcnt(4)
  v_mfma_f32_16x16x32_bf16 v[64:67], a[80:83], v[208:211], v[64:67]
  ds_read_b128 a[72:75], v1 offset:26624
  s_add_u32 s40, s40, s42
  v_mfma_f32_16x16x32_bf16 v[68:71], a[80:83], v[212:215], v[68:71]
  s_add_u32 s40, s40, 163328
  buffer_load_dwordx4 a[8:11], v1, s[36:39], s93 offen offset:2048 sc1
  v_mfma_f32_16x16x32_bf16 v[80:83], a[84:87], v[208:211], v[80:83]
  ds_read_b128 a[76:79], v1 offset:27648
  v_mfma_f32_16x16x32_bf16 v[84:87], a[84:87], v[212:215], v[84:87]
  v_add_u32 v23, s40, v24
  s_waitcnt lgkmcnt(4)
  v_mfma_f32_16x16x32_bf16 v[40:43], a[88:91], v[208:211], v[40:43]
  ds_read_b128 a[80:83], v1 offset:28672
  v_xor_b32 v25, 64, v23
  v_mfma_f32_16x16x32_bf16 v[44:47], a[88:91], v[212:215], v[44:47]
  buffer_load_dwordx4 a[12:15], v1, s[36:39], s93 offen offset:3072 sc1
  v_mfma_f32_16x16x32_bf16 v[56:59], a[92:95], v[208:211], v[56:59]
  ds_read_b128 a[84:87], v1 offset:29696
  ds_read_b32 v114, v23
  v_mfma_f32_16x16x32_bf16 v[60:63], a[92:95], v[212:215], v[60:63]
  ds_read_b32 v115, v25
  s_waitcnt lgkmcnt(6)
  v_mfma_f32_16x16x32_bf16 v[72:75], a[96:99], v[208:211], v[72:75]
  ds_read_b128 a[88:91], v1 offset:30720
  s_add_u32 s16, s93, 4096
  v_mfma_f32_16x16x32_bf16 v[76:79], a[96:99], v[212:215], v[76:79]
  v_accvgpr_read_b32 v28, a250
  buffer_load_dwordx4 a[16:19], v1, s[36:39], s16 offen sc1
  v_mfma_f32_16x16x32_bf16 v[88:91], a[100:103], v[208:211], v[88:91]
  ds_read_b128 a[92:95], v1 offset:31744
  v_accvgpr_read_b32 v29, a251
  v_mfma_f32_16x16x32_bf16 v[92:95], a[100:103], v[212:215], v[92:95]
  s_waitcnt lgkmcnt(6)
  v_mfma_f32_16x16x32_bf16 v[96:99], a[72:75], v[208:211], v[96:99]
  ds_read_b128 a[96:99], v1 offset:32768
  s_cmp_eq_u32 s41, 0
  s_cselect_b64 s[42:43], -1, 0
  v_mfma_f32_16x16x32_bf16 v[100:103], a[72:75], v[212:215], v[100:103]
  v_cndmask_b32 v118, 0, v28, s[42:43]
  buffer_load_dwordx4 a[20:23], v1, s[36:39], s16 offen offset:1024 sc1
  v_mfma_f32_16x16x32_bf16 v[32:35], a[76:79], v[216:219], v[32:35]
  ds_read_b128 a[100:103], v1 offset:33792
  v_mfma_f32_16x16x32_bf16 v[36:39], a[76:79], v[220:223], v[36:39]
  v_cndmask_b32 v119, 0, v29, s[42:43]
  s_waitcnt lgkmcnt(6)
  v_mfma_f32_16x16x32_bf16 v[48:51], a[80:83], v[216:219], v[48:51]
  ds_read_b128 a[72:75], v1 offset:34816
  v_cndmask_b32 v120, v28, 0, s[42:43]
  v_mfma_f32_16x16x32_bf16 v[52:55], a[80:83], v[220:223], v[52:55]
  v_cndmask_b32 v121, v29, 0, s[42:43]
  buffer_load_dwordx4 a[24:27], v1, s[36:39], s16 offen offset:2048 sc1
  v_mfma_f32_16x16x32_bf16 v[64:67], a[84:87], v[216:219], v[64:67]
  ds_read_b128 a[76:79], v1 offset:35840
  v_mfma_f32_16x16x32_bf16 v[68:71], a[84:87], v[220:223], v[68:71]
  v_mov_b32 v122, v118
  s_waitcnt lgkmcnt(4)
  v_mfma_f32_16x16x32_bf16 v[80:83], a[88:91], v[216:219], v[80:83]
  s_barrier
  ds_read_b128 a[80:83], v1 offset:36864
  v_mfma_f32_16x16x32_bf16 v[84:87], a[88:91], v[220:223], v[84:87]
  v_mov_b32 v123, v119
  buffer_load_dwordx4 a[28:31], v1, s[36:39], s16 offen offset:3072 sc1
  v_mfma_f32_16x16x32_bf16 v[40:43], a[92:95], v[216:219], v[40:43]
  ds_read_b128 a[84:87], v1 offset:37888
  v_mfma_f32_16x16x32_bf16 v[44:47], a[92:95], v[220:223], v[44:47]
  v_mul_f32 v116, 0xbfb8aa3b, v114
  s_waitcnt lgkmcnt(4)
  v_mfma_f32_16x16x32_bf16 v[56:59], a[96:99], v[216:219], v[56:59]
  ds_read_b128 a[88:91], v1 offset:38912
  v_mul_f32 v117, 0xbfb8aa3b, v115
  v_mfma_f32_16x16x32_bf16 v[60:63], a[96:99], v[220:223], v[60:63]
  s_add_u32 s16, s93, 8192
  buffer_load_dwordx4 a[32:35], v1, s[36:39], s16 offen sc1
  v_mfma_f32_16x16x32_bf16 v[72:75], a[100:103], v[216:219], v[72:75]
  ds_read_b128 a[92:95], v1 offset:39936
  s_lshl2_add_u32 s40, s60, s62
  v_mfma_f32_16x16x32_bf16 v[76:79], a[100:103], v[220:223], v[76:79]
  s_lshl2_add_u32 s41, s40, s64
  s_waitcnt lgkmcnt(4)
  v_mfma_f32_16x16x32_bf16 v[88:91], a[72:75], v[216:219], v[88:91]
  ds_read_b128 a[96:99], v1 offset:40960
  v_mfma_f32_16x16x32_bf16 v[92:95], a[72:75], v[220:223], v[92:95]
  s_lshl2_add_u32 s40, s40, s61
  buffer_load_dwordx4 a[36:39], v1, s[36:39], s16 offen offset:1024 sc1
  v_mfma_f32_16x16x32_bf16 v[96:99], a[76:79], v[216:219], v[96:99]
  ds_read_b128 a[100:103], v1 offset:41984
  s_lshl2_add_u32 s44, s41, s61
  v_mfma_f32_16x16x32_bf16 v[100:103], a[76:79], v[220:223], v[100:103]
  s_waitcnt lgkmcnt(4)
  v_mfma_f32_16x16x32_bf16 v[32:35], a[80:83], v[224:227], v[32:35]
  ds_read_b128 a[72:75], v1 offset:43008
  s_mul_i32 s44, s44, 9216
  v_mfma_f32_16x16x32_bf16 v[36:39], a[80:83], v[228:231], v[36:39]
  s_add_u32 s44, s44, 41943040
  buffer_load_dwordx4 a[40:43], v1, s[36:39], s16 offen offset:2048 sc1
  v_mfma_f32_16x16x32_bf16 v[48:51], a[84:87], v[224:227], v[48:51]
L_pg8:
  s_cbranch_execz L_pgret
  ds_read_b128 a[76:79], v1 offset:44032
  v_mfma_f32_16x16x32_bf16 v[52:55], a[84:87], v[228:231], v[52:55]
  s_mul_i32 s45, s40, 36864
  s_waitcnt lgkmcnt(4)
  v_mfma_f32_16x16x32_bf16 v[64:67], a[88:91], v[224:227], v[64:67]
  ds_read_b128 a[80:83], v1 offset:45056
  s_add_u32 s45, s45, 41943040
  v_mfma_f32_16x16x32_bf16 v[68:71], a[88:91], v[228:231], v[68:71]
  s_lshl_b32 s41, s41, 7
  buffer_load_dwordx4 a[44:47], v1, s[36:39], s16 offen offset:3072 sc1
  v_mfma_f32_16x16x32_bf16 v[80:83], a[92:95], v[224:227], v[80:83]
  ds_read_b128 a[84:87], v1 offset:46080
  v_mfma_f32_16x16x32_bf16 v[84:87], a[92:95], v[228:231], v[84:87]
  s_lshl2_add_u32 s41, s61, s41
  s_waitcnt lgkmcnt(4)
  v_mfma_f32_16x16x32_bf16 v[40:43], a[96:99], v[224:227], v[40:43]
  ds_read_b128 a[88:91], v1 offset:47104
  s_add_u32 s94, s41, 24576
  v_mfma_f32_16x16x32_bf16 v[44:47], a[96:99], v[228:231], v[44:47]
  s_add_u32 s17, s93, 12288
  buffer_load_dwordx4 a[48:51], v1, s[36:39], s17 offen sc1
  v_mfma_f32_16x16x32_bf16 v[56:59], a[100:103], v[224:227], v[56:59]
  ds_read_b128 a[92:95], v1 offset:48128
  s_lshl_b32 s40, s40, 7
  v_mfma_f32_16x16x32_bf16 v[60:63], a[100:103], v[228:231], v[60:63]
  s_add_u32 s43, s40, 24576
  s_waitcnt lgkmcnt(4)
  v_mfma_f32_16x16x32_bf16 v[72:75], a[72:75], v[224:227], v[72:75]
  ds_read_b128 a[96:99], v1 offset:49152
  v_mfma_f32_16x16x32_bf16 v[76:79], a[72:75], v[228:231], v[76:79]
  s_lshl_b32 s40, s64, 10
  buffer_load_dwordx4 a[52:55], v1, s[36:39], s17 offen offset:1024 sc1
  v_mfma_f32_16x16x32_bf16 v[88:91], a[76:79], v[224:227], v[88:91]
  ds_read_b128 a[100:103], v1 offset:50176
  s_add_u32 s40, s40, 58368
  v_mfma_f32_16x16x32_bf16 v[92:95], a[76:79], v[228:231], v[92:95]
  s_waitcnt lgkmcnt(4)
  v_mfma_f32_16x16x32_bf16 v[96:99], a[80:83], v[224:227], v[96:99]
  ds_read_b128 a[72:75], v1 offset:51200
  v_add_u32 v23, s40, v1
  v_mfma_f32_16x16x32_bf16 v[100:103], a[80:83], v[228:231], v[100:103]
  s_movk_i32 s41, 9216
  buffer_load_dwordx4 a[56:59], v1, s[36:39], s17 offen offset:2048 sc1
  v_mfma_f32_16x16x32_bf16 v[32:35], a[84:87], v[232:235], v[32:35]
  ds_read_b128 a[76:79], v1 offset:52224
  s_waitcnt vmcnt(26)
  v_mfma_f32_16x16x32_bf16 v[36:39], a[84:87], v[236:239], v[36:39]
  s_cmp_eq_u32 s64, s61
  s_cmov_b32 s41, 0
  s_cmov_b32 s44, 1073741824
  s_waitcnt lgkmcnt(4)
  v_mfma_f32_16x16x32_bf16 v[48:51], a[88:91], v[232:235], v[48:51]
  ds_read_b128 a[80:83], v1 offset:53248
  s_add_u32 s41, s41, 57344
  v_mfma_f32_16x16x32_bf16 v[52:55], a[88:91], v[236:239], v[52:55]
  buffer_load_dwordx4 a[60:63], v1, s[36:39], s17 offen offset:3072 sc1
  v_mfma_f32_16x16x32_bf16 v[64:67], a[92:95], v[232:235], v[64:67]
  ds_read_b128 a[84:87], v1 offset:54272
  v_add_u32 v25, s41, v1
  v_mfma_f32_16x16x32_bf16 v[68:71], a[92:95], v[236:239], v[68:71]
  v_rcp_f32 v169, v114
  s_waitcnt lgkmcnt(4)
  v_mfma_f32_16x16x32_bf16 v[80:83], a[96:99], v[232:235], v[80:83]
  ds_read_b128 a[88:91], v4
  v_rcp_f32 v170, v115
  v_mfma_f32_16x16x32_bf16 v[84:87], a[96:99], v[236:239], v[84:87]
  s_add_u32 s17, s93, 16384
  buffer_load_dwordx4 a[64:67], v1, s[36:39], s17 offen sc1
  v_mfma_f32_16x16x32_bf16 v[40:43], a[100:103], v[232:235], v[40:43]
  ds_read_b128 a[92:95], v4 offset:1024
  s_mov_b32 s11, 0x10001
  v_mfma_f32_16x16x32_bf16 v[44:47], a[100:103], v[236:239], v[44:47]
  s_cmp_lt_u32 s64, 2
  s_cselect_b32 s12, s11, 0
  s_waitcnt lgkmcnt(4)
  v_mfma_f32_16x16x32_bf16 v[56:59], a[72:75], v[232:235], v[56:59]
  ds_read_b128 a[96:99], v4 offset:2048
  v_mfma_f32_16x16x32_bf16 v[60:63], a[72:75], v[236:239], v[60:63]
  v_and_b32 v28, 3, v0
  buffer_load_dwordx4 a[68:71], v1, s[36:39], s17 offen offset:1024 sc1
  v_mfma_f32_16x16x32_bf16 v[72:75], a[76:79], v[232:235], v[72:75]
  ds_read_b128 a[100:103], v4 offset:3072
  v_lshlrev_b32 v28, 3, v28
  v_mfma_f32_16x16x32_bf16 v[76:79], a[76:79], v[236:239], v[76:79]
  s_add_u32 s84, s69, 294912
  s_waitcnt lgkmcnt(4)
  v_mfma_f32_16x16x32_bf16 v[88:91], a[80:83], v[232:235], v[88:91]
  ds_read_b128 a[72:75], v4 offset:4096
  v_bfe_u32 v124, v7, v28, 2
  s_add_u32 m0, s65, 0
  v_mfma_f32_16x16x32_bf16 v[92:95], a[80:83], v[236:239], v[92:95]
  v_lshl_or_b32 v124, v124, 15, v124
  buffer_load_dwordx4 v1, s[36:39], s84 offen sc1 lds
  v_mfma_f32_16x16x32_bf16 v[96:99], a[84:87], v[232:235], v[96:99]
  ds_read_b128 a[76:79], v4 offset:5120
  v_mfma_f32_16x16x32_bf16 v[100:103], a[84:87], v[236:239], v[100:103]
  v_and_b32 v124, s11, v124
  s_waitcnt vmcnt(26) lgkmcnt(4)
  v_mfma_f32_16x16x32_bf16 v[32:35], a[88:91], v[240:243], v[32:35]
  ds_read_b128 a[80:83], v4 offset:6144
  v_xor_b32 v164, s11, v124
  s_waitcnt vmcnt(25)
  v_mfma_f32_16x16x32_bf16 v[36:39], a[88:91], v[244:247], v[36:39]
  buffer_load_dwordx4 v1, s[36:39], s84 offen offset:1024 sc1 lds
  v_mfma_f32_16x16x32_bf16 v[48:51], a[92:95], v[240:243], v[48:51]
  ds_read_b128 a[84:87], v4 offset:7168
  v_add_u32 v28, 2, v28
  v_mfma_f32_16x16x32_bf16 v[52:55], a[92:95], v[244:247], v[52:55]
  v_bfe_u32 v125, v7, v28, 2
  s_waitcnt lgkmcnt(4)
  v_mfma_f32_16x16x32_bf16 v[64:67], a[96:99], v[240:243], v[64:67]
  ds_read_b128 a[88:91], v4 offset:8192
  v_mfma_f32_16x16x32_bf16 v[68:71], a[96:99], v[244:247], v[68:71]
  v_lshl_or_b32 v125, v125, 15, v125
  buffer_load_dwordx4 v1, s[36:39], s84 offen offset:2048 sc1 lds
  v_mfma_f32_16x16x32_bf16 v[80:83], a[100:103], v[240:243], v[80:83]
  ds_read_b128 a[92:95], v4 offset:9216
  v_and_b32 v125, s11, v125
  v_mfma_f32_16x16x32_bf16 v[84:87], a[100:103], v[244:247], v[84:87]
  v_xor_b32 v165, s11, v125
  s_waitcnt lgkmcnt(4)
  v_mfma_f32_16x16x32_bf16 v[40:43], a[72:75], v[240:243], v[40:43]
  ds_read_b128 a[96:99], v4 offset:10240
  v_mfma_f32_16x16x32_bf16 v[44:47], a[72:75], v[244:247], v[44:47]
  v_add_u32 v28, 2, v28
  buffer_load_dwordx4 v1, s[36:39], s84 offen offset:3072 sc1 lds
  v_mfma_f32_16x16x32_bf16 v[56:59], a[76:79], v[240:243], v[56:59]
  ds_read_b128 a[100:103], v4 offset:11264
  v_bfe_u32 v126, v7, v28, 2
  v_mfma_f32_16x16x32_bf16 v[60:63], a[76:79], v[244:247], v[60:63]
  s_add_u32 s84, s69, 299008
  s_waitcnt lgkmcnt(4)
  v_mfma_f32_16x16x32_bf16 v[72:75], a[80:83], v[240:243], v[72:75]
  ds_read_b128 a[72:75], v4 offset:12288
  v_lshl_or_b32 v126, v126, 15, v126
  s_add_u32 m0, s65, 4096
  v_mfma_f32_16x16x32_bf16 v[76:79], a[80:83], v[244:247], v[76:79]
  v_and_b32 v126, s11, v126
  buffer_load_dwordx4 v1, s[36:39], s84 offen sc1 lds
  v_mfma_f32_16x16x32_bf16 v[88:91], a[84:87], v[240:243], v[88:91]
  ds_read_b128 a[76:79], v4 offset:13312
  v_mfma_f32_16x16x32_bf16 v[92:95], a[84:87], v[244:247], v[92:95]
  v_xor_b32 v166, s11, v126
  s_waitcnt lgkmcnt(4)
  v_mfma_f32_16x16x32_bf16 v[96:99], a[88:91], v[240:243], v[96:99]
  ds_read_b128 a[80:83], v4 offset:14336
  v_add_u32 v28, 2, v28
  v_mfma_f32_16x16x32_bf16 v[100:103], a[88:91], v[244:247], v[100:103]
  buffer_load_dwordx4 v1, s[36:39], s84 offen offset:1024 sc1 lds
  v_mfma_f32_16x16x32_bf16 v[32:35], a[92:95], a[0:3], v[32:35]
  ds_read_b128 a[84:87], v4 offset:15360
  v_bfe_u32 v127, v7, v28, 2
  s_waitcnt vmcnt(25)
  v_mfma_f32_16x16x32_bf16 v[36:39], a[92:95], a[4:7], v[36:39]
  v_lshl_or_b32 v127, v127, 15, v127
  s_waitcnt lgkmcnt(4)
  v_mfma_f32_16x16x32_bf16 v[48:51], a[96:99], a[0:3], v[48:51]
  ds_read_b128 a[88:91], v4 offset:16384
  v_mfma_f32_16x16x32_bf16 v[52:55], a[96:99], a[4:7], v[52:55]
  v_and_b32 v127, s11, v127
  buffer_load_dwordx4 v1, s[36:39], s84 offen offset:2048 sc1 lds
  v_mfma_f32_16x16x32_bf16 v[64:67], a[100:103], a[0:3], v[64:67]
  ds_read_b128 a[92:95], v4 offset:17408
  v_xor_b32 v167, s11, v127
  v_mfma_f32_16x16x32_bf16 v[68:71], a[100:103], a[4:7], v[68:71]
  s_waitcnt lgkmcnt(4)
  v_mfma_f32_16x16x32_bf16 v[80:83], a[72:75], a[0:3], v[80:83]
  s_waitcnt vmcnt(23)
  s_barrier
  ds_read_b128 a[96:99], v4 offset:18432
  v_mfma_f32_16x16x32_bf16 v[84:87], a[72:75], a[4:7], v[84:87]
  s_lshl_b32 s40, s64, 11
  buffer_load_dwordx4 v1, s[36:39], s84 offen offset:3072 sc1 lds
  v_mfma_f32_16x16x32_bf16 v[40:43], a[76:79], a[0:3], v[40:43]
  ds_read_b128 a[100:103], v4 offset:19456
  v_mfma_f32_16x16x32_bf16 v[44:47], a[76:79], a[4:7], v[44:47]
  s_add_u32 s40, s40, s45
  s_waitcnt lgkmcnt(4)
  v_mfma_f32_16x16x32_bf16 v[56:59], a[80:83], a[0:3], v[56:59]
  ds_read_b128 a[72:75], v4 offset:20480
  s_add_u32 s84, s69, 303104
  s_add_u32 m0, s65, 8192
  v_mfma_f32_16x16x32_bf16 v[60:63], a[80:83], a[4:7], v[60:63]
  s_add_u32 s41, s61, 1
  buffer_load_dwordx4 v1, s[36:39], s84 offen sc1 lds
  v_mfma_f32_16x16x32_bf16 v[72:75], a[84:87], a[0:3], v[72:75]
  ds_read_b128 a[76:79], v4 offset:21504
  v_mfma_f32_16x16x32_bf16 v[76:79], a[84:87], a[4:7], v[76:79]
  s_and_b32 s41, s41, 3
  s_waitcnt lgkmcnt(4)
  v_mfma_f32_16x16x32_bf16 v[88:91], a[88:91], a[0:3], v[88:91]
  ds_read_b128 a[80:83], v4 offset:22528
  s_add_u32 s10, s9, 0
  v_mfma_f32_16x16x32_bf16 v[92:95], a[88:91], a[4:7], v[92:95]
  s_mul_i32 s41, s41, 9216
  buffer_load_dwordx4 a[104:107], v1, s[36:39], s10 offen sc1
  v_mfma_f32_16x16x32_bf16 v[96:99], a[92:95], a[0:3], v[96:99]
  ds_read_b128 a[84:87], v4 offset:23552
  v_mfma_f32_16x16x32_bf16 v[100:103], a[92:95], a[4:7], v[100:103]
  s_add_u32 s41, s41, s40
  s_waitcnt vmcnt(25) lgkmcnt(4)
  v_mfma_f32_16x16x32_bf16 v[32:35], a[96:99], a[8:11], v[32:35]
  ds_read_b128 a[88:91], v4 offset:24576
  s_add_u32 s10, s9, 9216
  s_waitcnt vmcnt(24)
  v_mfma_f32_16x16x32_bf16 v[36:39], a[96:99], a[12:15], v[36:39]
  s_add_u32 s42, s61, 2
  buffer_load_dwordx4 a[108:111], v1, s[36:39], s10 offen sc1
  s_waitcnt vmcnt(24)
  v_mfma_f32_16x16x32_bf16 v[32:35], a[100:103], a[16:19], v[32:35]
  ds_read_b128 a[92:95], v4 offset:25600
  s_waitcnt vmcnt(23)
  v_mfma_f32_16x16x32_bf16 v[36:39], a[100:103], a[20:23], v[36:39]
  s_and_b32 s42, s42, 3
  s_waitcnt vmcnt(22) lgkmcnt(4)
  v_mfma_f32_16x16x32_bf16 v[32:35], a[72:75], a[24:27], v[32:35]
  ds_read_b128 a[96:99], v4 offset:26624
  s_add_u32 s10, s9, 18432
  s_waitcnt vmcnt(21)
  v_mfma_f32_16x16x32_bf16 v[36:39], a[72:75], a[28:31], v[36:39]
  s_mul_i32 s42, s42, 9216
  buffer_load_dwordx4 a[112:115], v1, s[36:39], s10 offen sc1
  s_waitcnt vmcnt(21)
  v_mfma_f32_16x16x32_bf16 v[32:35], a[76:79], a[32:35], v[32:35]
  ds_read_b128 a[100:103], v4 offset:27648
  s_waitcnt vmcnt(20)
  v_mfma_f32_16x16x32_bf16 v[36:39], a[76:79], a[36:39], v[36:39]
  s_add_u32 s42, s42, s40
  s_waitcnt vmcnt(19) lgkmcnt(4)
  v_mfma_f32_16x16x32_bf16 v[32:35], a[80:83], a[40:43], v[32:35]
  ds_read_b128 a[72:75], v4 offset:28672
  s_add_u32 m0, s8, 36864
  s_waitcnt vmcnt(18)
  v_mfma_f32_16x16x32_bf16 v[36:39], a[80:83], a[44:47], v[36:39]
  s_add_u32 s19, s61, 3
  buffer_load_dwordx4 v1, s[36:39], s88 offen sc1 lds
  s_waitcnt vmcnt(18)
  v_mfma_f32_16x16x32_bf16 v[32:35], a[84:87], a[48:51], v[32:35]
  ds_read_b128 a[76:79], v4 offset:29696
  s_waitcnt vmcnt(17)
  v_mfma_f32_16x16x32_bf16 v[36:39], a[84:87], a[52:55], v[36:39]
  s_and_b32 s19, s19, 3
  s_waitcnt vmcnt(16) lgkmcnt(4)
  v_mfma_f32_16x16x32_bf16 v[32:35], a[88:91], a[56:59], v[32:35]
  ds_read_b128 a[80:83], v4 offset:30720
  s_add_u32 s88, s88, 9216
  s_add_u32 m0, s8, 37888
  s_waitcnt vmcnt(15)
  v_mfma_f32_16x16x32_bf16 v[36:39], a[88:91], a[60:63], v[36:39]
  s_mul_i32 s19, s19, 9216
  buffer_load_dwordx4 v1, s[36:39], s88 offen sc1 lds
  s_waitcnt vmcnt(15)
  v_mfma_f32_16x16x32_bf16 v[32:35], a[92:95], a[64:67], v[32:35]
  ds_read_b128 a[84:87], v4 offset:31744
  s_waitcnt vmcnt(14)
  v_mfma_f32_16x16x32_bf16 v[36:39], a[92:95], a[68:71], v[36:39]
  s_add_u32 s19, s19, s40
  s_waitcnt lgkmcnt(4)
  v_mfma_f32_16x16x32_bf16 v[48:51], a[96:99], a[8:11], v[48:51]
  ds_read_b128 a[88:91], v4 offset:32768
  s_add_u32 s88, s88, 9216
  s_add_u32 m0, s8, 38912
  v_mfma_f32_16x16x32_bf16 v[52:55], a[96:99], a[12:15], v[52:55]
  buffer_load_dwordx4 v1, s[36:39], s88 offen sc1 lds
  v_mfma_f32_16x16x32_bf16 v[48:51], a[100:103], a[16:19], v[48:51]
  ds_read_b128 a[92:95], v4 offset:33792
  v_cvt_pk_bf16_f32 v32, v32, v33
  v_mfma_f32_16x16x32_bf16 v[52:55], a[100:103], a[20:23], v[52:55]
  v_cvt_pk_bf16_f32 v33, v34, v35
  s_waitcnt lgkmcnt(4)
  v_mfma_f32_16x16x32_bf16 v[48:51], a[72:75], a[24:27], v[48:51]
  ds_read_b128 a[96:99], v4 offset:34816
  v_cvt_pk_bf16_f32 v34, v36, v37
  v_mfma_f32_16x16x32_bf16 v[52:55], a[72:75], a[28:31], v[52:55]
  v_cvt_pk_bf16_f32 v35, v38, v39
  buffer_load_dword v31, v24, s[36:39], s95 offen sc1
  s_add_u32 s88, s88, 9216
  v_mfma_f32_16x16x32_bf16 v[48:51], a[76:79], a[32:35], v[48:51]
  ds_read_b128 a[100:103], v4 offset:35840
  v_bfi_b32 v32, s11, v124, v32
  s_add_u32 m0, s8, 39936
  v_mfma_f32_16x16x32_bf16 v[52:55], a[76:79], a[36:39], v[52:55]
  v_bfi_b32 v33, s11, v125, v33
  buffer_load_dwordx4 v1, s[36:39], s88 offen sc1 lds
  s_waitcnt lgkmcnt(4)
  v_mfma_f32_16x16x32_bf16 v[48:51], a[80:83], a[40:43], v[48:51]
  ds_read_b128 a[72:75], v4 offset:36864
  v_bfi_b32 v34, s11, v126, v34
  v_mfma_f32_16x16x32_bf16 v[52:55], a[80:83], a[44:47], v[52:55]
  v_bfi_b32 v35, s11, v127, v35
  v_mfma_f32_16x16x32_bf16 v[48:51], a[84:87], a[48:51], v[48:51]
  ds_read_b128 a[76:79], v4 offset:37888
  ds_write_b128 v25, v[32:35] offset:1024
  v_mfma_f32_16x16x32_bf16 v[52:55], a[84:87], a[52:55], v[52:55]
  buffer_store_dwordx4 v[32:35], v1, s[36:39], s44 offen sc1
  s_waitcnt lgkmcnt(5)
  v_mfma_f32_16x16x32_bf16 v[48:51], a[88:91], a[56:59], v[48:51]
  ds_read_b128 a[80:83], v4 offset:38912
  v_mfma_f32_16x16x32_bf16 v[52:55], a[88:91], a[60:63], v[52:55]
  s_add_u32 s88, s88, 9216
  v_mfma_f32_16x16x32_bf16 v[48:51], a[92:95], a[64:67], v[48:51]
  ds_read_b128 a[84:87], v4 offset:39936
  s_add_u32 m0, s8, 40960
  v_mfma_f32_16x16x32_bf16 v[52:55], a[92:95], a[68:71], v[52:55]
  buffer_load_dwordx4 v1, s[36:39], s88 offen sc1 lds
  s_waitcnt lgkmcnt(5)
  v_mfma_f32_16x16x32_bf16 v[64:67], a[96:99], a[8:11], v[64:67]
  ds_read_b128 a[88:91], v4 offset:40960
  v_mfma_f32_16x16x32_bf16 v[68:71], a[96:99], a[12:15], v[68:71]
  v_mfma_f32_16x16x32_bf16 v[64:67], a[100:103], a[16:19], v[64:67]
  ds_read_b128 a[92:95], v4 offset:41984
  v_cvt_pk_bf16_f32 v48, v48, v49
  s_add_u32 s10, s9, 27648
  v_mfma_f32_16x16x32_bf16 v[68:71], a[100:103], a[20:23], v[68:71]
  v_cvt_pk_bf16_f32 v49, v50, v51
  buffer_load_dwordx4 a[116:119], v1, s[36:39], s10 offen sc1
  s_waitcnt lgkmcnt(5)
  v_mfma_f32_16x16x32_bf16 v[64:67], a[72:75], a[24:27], v[64:67]
  ds_read_b128 a[96:99], v4 offset:43008
  v_cvt_pk_bf16_f32 v50, v52, v53
  v_mfma_f32_16x16x32_bf16 v[68:71], a[72:75], a[28:31], v[68:71]
  v_cvt_pk_bf16_f32 v51, v54, v55
  v_mfma_f32_16x16x32_bf16 v[64:67], a[76:79], a[32:35], v[64:67]
  ds_read_b128 a[100:103], v4 offset:44032
  v_bfi_b32 v48, s11, v124, v48
  s_add_u32 s10, s9, 36864
  v_mfma_f32_16x16x32_bf16 v[68:71], a[76:79], a[36:39], v[68:71]
  v_bfi_b32 v49, s11, v125, v49
  buffer_load_dwordx4 a[120:123], v1, s[36:39], s10 offen sc1
  s_waitcnt lgkmcnt(4)
  v_mfma_f32_16x16x32_bf16 v[64:67], a[80:83], a[40:43], v[64:67]
  ds_read_b128 a[72:75], v4 offset:45056
  v_bfi_b32 v50, s11, v126, v50
  v_mfma_f32_16x16x32_bf16 v[68:71], a[80:83], a[44:47], v[68:71]
  v_bfi_b32 v51, s11, v127, v51
  v_mfma_f32_16x16x32_bf16 v[64:67], a[84:87], a[48:51], v[64:67]
  ds_read_b128 a[76:79], v4 offset:46080
  ds_write_b128 v25, v[48:51] offset:2048
  v_mfma_f32_16x16x32_bf16 v[68:71], a[84:87], a[52:55], v[68:71]
  buffer_store_dwordx4 v[48:51], v1, s[36:39], s44 offen offset:2048 sc1
  s_waitcnt lgkmcnt(5)
  v_mfma_f32_16x16x32_bf16 v[64:67], a[88:91], a[56:59], v[64:67]
  ds_read_b128 a[80:83], v4 offset:47104
  v_mfma_f32_16x16x32_bf16 v[68:71], a[88:91], a[60:63], v[68:71]
  v_mfma_f32_16x16x32_bf16 v[64:67], a[92:95], a[64:67], v[64:67]
  ds_read_b128 a[84:87], v4 offset:48128
  s_waitcnt vmcnt(6)
  v_cmp_ne_u32 vcc, v7, v31
  s_cbranch_vccz L_ok7
  s_mov_b32 s83, 0x8000
L_spin7:
  buffer_load_dword v31, v24, s[36:39], s95 offen sc1
  s_waitcnt vmcnt(0)
  v_cmp_ne_u32 vcc, v7, v31
  s_cbranch_vccz L_ok7
  s_sub_u32 s83, s83, 1
  s_cbranch_scc0 L_spin7
  buffer_store_dword v1, off, s[32:35], 0 offset:32 sc1
  s_waitcnt vmcnt(0)
L_ok7:
  v_mfma_f32_16x16x32_bf16 v[68:71], a[92:95], a[68:71], v[68:71]
  s_add_u32 s10, s9, 46080
  buffer_load_dwordx4 a[124:127], v1, s[36:39], s10 offen sc1
  s_waitcnt lgkmcnt(5)
  v_mfma_f32_16x16x32_bf16 v[80:83], a[96:99], a[8:11], v[80:83]
  ds_read_b128 a[88:91], v4 offset:49152
  v_mfma_f32_16x16x32_bf16 v[84:87], a[96:99], a[12:15], v[84:87]
  v_mfma_f32_16x16x32_bf16 v[80:83], a[100:103], a[16:19], v[80:83]
  ds_read_b128 a[92:95], v4 offset:50176
  v_cvt_pk_bf16_f32 v64, v64, v65
  s_add_u32 m0, s65, 110592
  v_mfma_f32_16x16x32_bf16 v[84:87], a[100:103], a[20:23], v[84:87]
  v_cvt_pk_bf16_f32 v65, v66, v67
  buffer_load_dwordx4 v1, s[36:39], s86 offen sc1 lds
  s_waitcnt lgkmcnt(5)
  v_mfma_f32_16x16x32_bf16 v[80:83], a[72:75], a[24:27], v[80:83]
  ds_read_b128 a[96:99], v4 offset:51200
  v_cvt_pk_bf16_f32 v66, v68, v69
  v_mfma_f32_16x16x32_bf16 v[84:87], a[72:75], a[28:31], v[84:87]
  v_cvt_pk_bf16_f32 v67, v70, v71
  v_mfma_f32_16x16x32_bf16 v[80:83], a[76:79], a[32:35], v[80:83]
  ds_read_b128 a[100:103], v4 offset:52224
  v_bfi_b32 v64, s11, v124, v64
  v_mfma_f32_16x16x32_bf16 v[84:87], a[76:79], a[36:39], v[84:87]
  v_bfi_b32 v65, s11, v125, v65
  buffer_load_dwordx4 v1, s[36:39], s86 offen offset:1024 sc1 lds
  s_waitcnt lgkmcnt(4)
  v_mfma_f32_16x16x32_bf16 v[80:83], a[80:83], a[40:43], v[80:83]
  ds_read_b128 a[72:75], v4 offset:53248
  v_bfi_b32 v66, s11, v126, v66
  v_mfma_f32_16x16x32_bf16 v[84:87], a[80:83], a[44:47], v[84:87]
  v_bfi_b32 v67, s11, v127, v67
  v_mfma_f32_16x16x32_bf16 v[80:83], a[84:87], a[48:51], v[80:83]
  ds_read_b128 a[76:79], v4 offset:54272
  ds_write_b128 v25, v[64:67] offset:3072
  v_mfma_f32_16x16x32_bf16 v[84:87], a[84:87], a[52:55], v[84:87]
  s_add_u32 s18, s44, 4096
  buffer_store_dwordx4 v[64:67], v1, s[36:39], s18 offen sc1
  s_waitcnt lgkmcnt(5)
  v_mfma_f32_16x16x32_bf16 v[80:83], a[88:91], a[56:59], v[80:83]
  s_barrier
  ds_read_b128 a[80:83], v1
  v_mfma_f32_16x16x32_bf16 v[84:87], a[88:91], a[60:63], v[84:87]
  v_mfma_f32_16x16x32_bf16 v[80:83], a[92:95], a[64:67], v[80:83]
  ds_read_b128 a[84:87], v1 offset:1024
  v_mfma_f32_16x16x32_bf16 v[84:87], a[92:95], a[68:71], v[84:87]
  buffer_load_dwordx4 v1, s[36:39], s86 offen offset:2048 sc1 lds
  s_waitcnt lgkmcnt(5)
  v_mfma_f32_16x16x32_bf16 v[40:43], a[96:99], a[8:11], v[40:43]
  ds_read_b128 a[88:91], v1 offset:2048
  v_mfma_f32_16x16x32_bf16 v[44:47], a[96:99], a[12:15], v[44:47]
  v_mfma_f32_16x16x32_bf16 v[40:43], a[100:103], a[16:19], v[40:43]
  ds_read_b128 a[92:95], v1 offset:3072
  v_cvt_pk_bf16_f32 v80, v80, v81
  v_mfma_f32_16x16x32_bf16 v[44:47], a[100:103], a[20:23], v[44:47]
  v_cvt_pk_bf16_f32 v81, v82, v83
  buffer_load_dwordx4 v1, s[36:39], s86 offen offset:3072 sc1 lds
  s_waitcnt lgkmcnt(5)
  v_mfma_f32_16x16x32_bf16 v[40:43], a[72:75], a[24:27], v[40:43]
  ds_read_b128 a[96:99], v1 offset:4096
  v_cvt_pk_bf16_f32 v82, v84, v85
  v_mfma_f32_16x16x32_bf16 v[44:47], a[72:75], a[28:31], v[44:47]
  v_cvt_pk_bf16_f32 v83, v86, v87
  s_add_u32 s87, s86, 4096
  v_mfma_f32_16x16x32_bf16 v[40:43], a[76:79], a[32:35], v[40:43]
  ds_read_b128 a[100:103], v1 offset:5120
  v_bfi_b32 v80, s11, v124, v80
  s_add_u32 m0, s65, 114688
  v_mfma_f32_16x16x32_bf16 v[44:47], a[76:79], a[36:39], v[44:47]
  v_bfi_b32 v81, s11, v125, v81
  buffer_load_dwordx4 v1, s[36:39], s87 offen sc1 lds
  s_waitcnt lgkmcnt(4)
  v_mfma_f32_16x16x32_bf16 v[40:43], a[80:83], a[40:43], v[40:43]
  ds_read_b128 a[72:75], v1 offset:6144
  v_bfi_b32 v82, s11, v126, v82
  v_mfma_f32_16x16x32_bf16 v[44:47], a[80:83], a[44:47], v[44:47]
  v_bfi_b32 v83, s11, v127, v83
  v_mfma_f32_16x16x32_bf16 v[40:43], a[84:87], a[48:51], v[40:43]
  ds_read_b128 a[76:79], v1 offset:7168
  ds_write_b128 v25, v[80:83] offset:4096
  v_mfma_f32_16x16x32_bf16 v[44:47], a[84:87], a[52:55], v[44:47]
  buffer_store_dwordx4 v[80:83], v1, s[36:39], s18 offen offset:2048 sc1
  s_waitcnt lgkmcnt(5)
  v_mfma_f32_16x16x32_bf16 v[40:43], a[88:91], a[56:59], v[40:43]
  ds_read_b128 a[80:83], v1 offset:8192
  v_mfma_f32_16x16x32_bf16 v[44:47], a[88:91], a[60:63], v[44:47]
  v_mfma_f32_16x16x32_bf16 v[40:43], a[92:95], a[64:67], v[40:43]
  ds_read_b128 a[84:87], v1 offset:9216
  v_mfma_f32_16x16x32_bf16 v[44:47], a[92:95], a[68:71], v[44:47]
  buffer_load_dwordx4 v1, s[36:39], s87 offen offset:1024 sc1 lds
  s_waitcnt lgkmcnt(5)
  v_mfma_f32_16x16x32_bf16 v[56:59], a[96:99], a[8:11], v[56:59]
  ds_read_b128 a[88:91], v1 offset:10240
  v_mfma_f32_16x16x32_bf16 v[60:63], a[96:99], a[12:15], v[60:63]
  v_mfma_f32_16x16x32_bf16 v[56:59], a[100:103], a[16:19], v[56:59]
  ds_read_b128 a[92:95], v1 offset:11264
  v_cvt_pk_bf16_f32 v40, v40, v41
  v_mfma_f32_16x16x32_bf16 v[60:63], a[100:103], a[20:23], v[60:63]
  v_cvt_pk_bf16_f32 v41, v42, v43
  buffer_load_dwordx4 v1, s[36:39], s87 offen offset:2048 sc1 lds
  s_waitcnt lgkmcnt(5)
  v_mfma_f32_16x16x32_bf16 v[56:59], a[72:75], a[24:27], v[56:59]
  ds_read_b128 a[96:99], v1 offset:12288
  v_cvt_pk_bf16_f32 v42, v44, v45
  v_mfma_f32_16x16x32_bf16 v[60:63], a[72:75], a[28:31], v[60:63]
  v_cvt_pk_bf16_f32 v43, v46, v47
  v_mfma_f32_16x16x32_bf16 v[56:59], a[76:79], a[32:35], v[56:59]
  ds_read_b128 a[100:103], v1 offset:13312
  v_bfi_b32 v40, s11, v124, v40
  v_mfma_f32_16x16x32_bf16 v[60:63], a[76:79], a[36:39], v[60:63]
  v_bfi_b32 v41, s11, v125, v41
  buffer_load_dwordx4 v1, s[36:39], s87 offen offset:3072 sc1 lds
  s_waitcnt lgkmcnt(4)
  v_mfma_f32_16x16x32_bf16 v[56:59], a[80:83], a[40:43], v[56:59]
  ds_read_b128 a[72:75], v1 offset:14336
  v_bfi_b32 v42, s11, v126, v42
  v_mfma_f32_16x16x32_bf16 v[60:63], a[80:83], a[44:47], v[60:63]
  v_bfi_b32 v43, s11, v127, v43
  v_mfma_f32_16x16x32_bf16 v[56:59], a[84:87], a[48:51], v[56:59]
  ds_read_b128 a[76:79], v1 offset:15360
  ds_write_b128 v25, v[40:43] offset:5120
  v_mfma_f32_16x16x32_bf16 v[60:63], a[84:87], a[52:55], v[60:63]
  buffer_store_dwordx4 v[40:43], v1, s[36:39], s44 offen offset:1024 sc1
  s_waitcnt lgkmcnt(5)
  v_mfma_f32_16x16x32_bf16 v[56:59], a[88:91], a[56:59], v[56:59]
  ds_read_b128 a[80:83], v1 offset:16384
  v_mfma_f32_16x16x32_bf16 v[60:63], a[88:91], a[60:63], v[60:63]
  s_add_u32 s87, s86, 8192
  v_mfma_f32_16x16x32_bf16 v[56:59], a[92:95], a[64:67], v[56:59]
  ds_read_b128 a[84:87], v1 offset:17408
  s_add_u32 m0, s65, 118784
  v_mfma_f32_16x16x32_bf16 v[60:63], a[92:95], a[68:71], v[60:63]
  buffer_load_dwordx4 v1, s[36:39], s87 offen sc1 lds
  s_waitcnt lgkmcnt(5)
  v_mfma_f32_16x16x32_bf16 v[72:75], a[96:99], a[8:11], v[72:75]
  ds_read_b128 a[88:91], v1 offset:18432
  v_mfma_f32_16x16x32_bf16 v[76:79], a[96:99], a[12:15], v[76:79]
  v_mfma_f32_16x16x32_bf16 v[72:75], a[100:103], a[16:19], v[72:75]
  ds_read_b128 a[92:95], v1 offset:19456
  v_cvt_pk_bf16_f32 v56, v56, v57
  s_add_u32 s10, s9, 55296
  v_mfma_f32_16x16x32_bf16 v[76:79], a[100:103], a[20:23], v[76:79]
  v_cvt_pk_bf16_f32 v57, v58, v59
  buffer_load_dwordx4 a[128:131], v1, s[36:39], s10 offen sc1
  s_waitcnt lgkmcnt(5)
  v_mfma_f32_16x16x32_bf16 v[72:75], a[72:75], a[24:27], v[72:75]
  ds_read_b128 a[96:99], v1 offset:20480
  v_cvt_pk_bf16_f32 v58, v60, v61
  v_mfma_f32_16x16x32_bf16 v[76:79], a[72:75], a[28:31], v[76:79]
  v_cvt_pk_bf16_f32 v59, v62, v63
  v_mfma_f32_16x16x32_bf16 v[72:75], a[76:79], a[32:35], v[72:75]
  ds_read_b128 a[100:103], v1 offset:21504
  v_bfi_b32 v56, s11, v124, v56
  s_add_u32 s10, s9, 64512
  v_mfma_f32_16x16x32_bf16 v[76:79], a[76:79], a[36:39], v[76:79]
  v_bfi_b32 v57, s11, v125, v57
  buffer_load_dwordx4 a[132:135], v1, s[36:39], s10 offen sc1
  s_waitcnt lgkmcnt(4)
  v_mfma_f32_16x16x32_bf16 v[72:75], a[80:83], a[40:43], v[72:75]
  ds_read_b128 a[72:75], v1 offset:22528
  v_bfi_b32 v58, s11, v126, v58
  v_mfma_f32_16x16x32_bf16 v[76:79], a[80:83], a[44:47], v[76:79]
  v_bfi_b32 v59, s11, v127, v59
  v_mfma_f32_16x16x32_bf16 v[72:75], a[84:87], a[48:51], v[72:75]
  ds_read_b128 a[76:79], v1 offset:23552
  ds_write_b128 v25, v[56:59] offset:6144
  v_mfma_f32_16x16x32_bf16 v[76:79], a[84:87], a[52:55], v[76:79]
  buffer_store_dwordx4 v[56:59], v1, s[36:39], s44 offen offset:3072 sc1
  s_waitcnt lgkmcnt(5)
  v_mfma_f32_16x16x32_bf16 v[72:75], a[88:91], a[56:59], v[72:75]
  ds_read_b128 a[80:83], v1 offset:24576
  v_mfma_f32_16x16x32_bf16 v[76:79], a[88:91], a[60:63], v[76:79]
  v_mfma_f32_16x16x32_bf16 v[72:75], a[92:95], a[64:67], v[72:75]
  ds_read_b128 a[84:87], v1 offset:25600
  s_add_u32 s10, s9, 73728
  v_mfma_f32_16x16x32_bf16 v[76:79], a[92:95], a[68:71], v[76:79]
  buffer_load_dwordx4 a[136:139], v1, s[36:39], s10 offen sc1
  s_waitcnt lgkmcnt(5)
  v_mfma_f32_16x16x32_bf16 v[88:91], a[96:99], a[8:11], v[88:91]
  ds_read_b128 a[88:91], v1 offset:26624
  v_mfma_f32_16x16x32_bf16 v[92:95], a[96:99], a[12:15], v[92:95]
  v_mfma_f32_16x16x32_bf16 v[88:91], a[100:103], a[16:19], v[88:91]
  ds_read_b128 a[92:95], v1 offset:27648
  v_cvt_pk_bf16_f32 v72, v72, v73
  v_mfma_f32_16x16x32_bf16 v[92:95], a[100:103], a[20:23], v[92:95]
  v_cvt_pk_bf16_f32 v73, v74, v75
  buffer_load_dwordx4 v[104:107], v21, s[4:7], s96 offen
  s_waitcnt lgkmcnt(5)
  v_mfma_f32_16x16x32_bf16 v[88:91], a[72:75], a[24:27], v[88:91]
  ds_read_b128 a[96:99], v1 offset:28672
  v_cvt_pk_bf16_f32 v74, v76, v77
  v_mfma_f32_16x16x32_bf16 v[92:95], a[72:75], a[28:31], v[92:95]
  v_cvt_pk_bf16_f32 v75, v78, v79
  v_mfma_f32_16x16x32_bf16 v[88:91], a[76:79], a[32:35], v[88:91]
  ds_read_b128 a[100:103], v1 offset:29696
  v_bfi_b32 v72, s11, v124, v72
  v_mfma_f32_16x16x32_bf16 v[92:95], a[76:79], a[36:39], v[92:95]
  v_bfi_b32 v73, s11, v125, v73
  s_waitcnt lgkmcnt(4)
  v_mfma_f32_16x16x32_bf16 v[88:91], a[80:83], a[40:43], v[88:91]
  ds_read_b128 a[72:75], v1 offset:30720
  v_bfi_b32 v74, s11, v126, v74
  v_mfma_f32_16x16x32_bf16 v[92:95], a[80:83], a[44:47], v[92:95]
  v_bfi_b32 v75, s11, v127, v75
  v_mfma_f32_16x16x32_bf16 v[88:91], a[84:87], a[48:51], v[88:91]
  ds_read_b128 a[76:79], v1 offset:31744
  ds_write_b128 v25, v[72:75] offset:7168
  v_mfma_f32_16x16x32_bf16 v[92:95], a[84:87], a[52:55], v[92:95]
  buffer_load_dwordx4 v[108:111], v21, s[4:7], s89 offen
  s_waitcnt lgkmcnt(5)
  v_mfma_f32_16x16x32_bf16 v[88:91], a[88:91], a[56:59], v[88:91]
L_pg9:
  s_cbranch_execz L_pgret
  ds_read_b128 a[80:83], v1 offset:32768
  v_mfma_f32_16x16x32_bf16 v[92:95], a[88:91], a[60:63], v[92:95]
  v_mfma_f32_16x16x32_bf16 v[88:91], a[92:95], a[64:67], v[88:91]
  ds_read_b128 a[84:87], v1 offset:33792
  v_mfma_f32_16x16x32_bf16 v[92:95], a[92:95], a[68:71], v[92:95]
  s_waitcnt lgkmcnt(5)
  v_mfma_f32_16x16x32_bf16 v[96:99], a[96:99], a[8:11], v[96:99]
  ds_read_b128 a[88:91], v1 offset:34816
  v_mfma_f32_16x16x32_bf16 v[100:103], a[96:99], a[12:15], v[100:103]
  v_mfma_f32_16x16x32_bf16 v[96:99], a[100:103], a[16:19], v[96:99]
  ds_read_b128 a[92:95], v1 offset:35840
  v_cvt_pk_bf16_f32 v88, v88, v89
  v_mfma_f32_16x16x32_bf16 v[100:103], a[100:103], a[20:23], v[100:103]
  v_cvt_pk_bf16_f32 v89, v90, v91
  buffer_load_dwordx2 v[112:113], v22, s[4:7], s97 offen
  s_waitcnt lgkmcnt(5)
  v_mfma_f32_16x16x32_bf16 v[96:99], a[72:75], a[24:27], v[96:99]
  v_cvt_pk_bf16_f32 v90, v92, v93
  v_mfma_f32_16x16x32_bf16 v[100:103], a[72:75], a[28:31], v[100:103]
  v_cvt_pk_bf16_f32 v91, v94, v95
  v_mfma_f32_16x16x32_bf16 v[96:99], a[76:79], a[32:35], v[96:99]
  v_bfi_b32 v88, s11, v124, v88
  s_add_u32 s10, s9, 82944
  v_mfma_f32_16x16x32_bf16 v[100:103], a[76:79], a[36:39], v[100:103]
  v_bfi_b32 v89, s11, v125, v89
  buffer_load_dwordx4 a[140:143], v1, s[36:39], s10 offen sc1
  s_waitcnt lgkmcnt(2)
  v_mfma_f32_16x16x32_bf16 v[96:99], a[80:83], a[40:43], v[96:99]
  v_bfi_b32 v90, s11, v126, v90
  v_mfma_f32_16x16x32_bf16 v[100:103], a[80:83], a[44:47], v[100:103]
  v_bfi_b32 v91, s11, v127, v91
  v_mfma_f32_16x16x32_bf16 v[96:99], a[84:87], a[48:51], v[96:99]
  ds_write_b128 v25, v[88:91] offset:8192
  v_mfma_f32_16x16x32_bf16 v[100:103], a[84:87], a[52:55], v[100:103]
  buffer_store_dwordx4 v[72:75], v1, s[36:39], s18 offen offset:1024 sc1
  s_waitcnt lgkmcnt(1)
  v_mfma_f32_16x16x32_bf16 v[96:99], a[88:91], a[56:59], v[96:99]
  v_mfma_f32_16x16x32_bf16 v[100:103], a[88:91], a[60:63], v[100:103]
  v_mfma_f32_16x16x32_bf16 v[96:99], a[92:95], a[64:67], v[96:99]
  v_mfma_f32_16x16x32_bf16 v[100:103], a[92:95], a[68:71], v[100:103]
  buffer_store_dwordx4 v[88:91], v1, s[36:39], s18 offen offset:3072 sc1
  s_nop 5
  v_cvt_pk_bf16_f32 v96, v96, v97
  v_cvt_pk_bf16_f32 v97, v98, v99
  v_cvt_pk_bf16_f32 v98, v100, v101
  v_cvt_pk_bf16_f32 v99, v102, v103
  v_bfi_b32 v96, s11, v124, v96
  v_bfi_b32 v97, s11, v125, v97
  v_bfi_b32 v98, s11, v126, v98
  v_bfi_b32 v99, s11, v127, v99
  s_add_u32 s18, s44, 8192
  buffer_store_dwordx4 v[96:99], v1, s[36:39], s18 offen sc1
  ds_write_b128 v25, v[96:99]
  s_waitcnt vmcnt(11) lgkmcnt(0)
  s_barrier
  ds_read_b128 a[0:3], v19 offset:10240
  ds_read_b128 a[4:7], v20 offset:10240
  ds_read_b128 a[8:11], v1 offset:47104
  ds_read_b128 a[12:15], v19 offset:11264
  ds_read_b128 a[16:19], v20 offset:11264
  ds_read_b128 a[20:23], v1 offset:48128
  ds_read_b128 a[24:27], v19 offset:12288
  ds_read_b128 a[28:31], v20 offset:12288
  ds_read_b128 a[32:35], v1 offset:49152
  s_waitcnt lgkmcnt(8)
  v_mfma_f32_16x16x32_bf16 v[176:179], a[144:147], a[0:3], 0
  ds_read_b128 a[36:39], v19 offset:13312
  s_lshl_b32 s85, s64, 11
  v_mfma_f32_16x16x32_bf16 v[180:183], a[216:219], a[0:3], 0
  ds_read_b128 a[40:43], v20 offset:13312
  s_waitcnt lgkmcnt(9)
  v_mfma_f32_16x16x32_bf16 v[184:187], a[144:147], a[4:7], 0
  ds_read_b128 a[44:47], v1 offset:50176
  s_sub_u32 s85, 8192, s85
  buffer_load_dwordx4 v[152:155], v1, s[36:39], s41 offen sc1
  v_mfma_f32_16x16x32_bf16 v[188:191], a[216:219], a[4:7], 0
  s_waitcnt lgkmcnt(9)
  v_mfma_f32_16x16x32_bf16 v[192:195], a[8:11], a[0:3], 0
  s_cmp_lt_u32 s64, 2
  s_cselect_b32 s85, s85, 1073741824
  s_waitcnt lgkmcnt(8)
  v_mfma_f32_16x16x32_bf16 v[176:179], a[148:151], a[12:15], v[176:179]
  ds_read_b128 a[0:3], v19 offset:14336
  v_mfma_f32_16x16x32_bf16 v[180:183], a[220:223], a[12:15], v[180:183]
  ds_read_b128 a[4:7], v20 offset:14336
  s_add_u32 s86, s85, s41
  buffer_load_dwordx4 v[156:159], v1, s[36:39], s42 offen sc1
  s_waitcnt lgkmcnt(9)
  v_mfma_f32_16x16x32_bf16 v[184:187], a[148:151], a[16:19], v[184:187]
  ds_read_b128 a[8:11], v1 offset:51200
  v_mfma_f32_16x16x32_bf16 v[188:191], a[220:223], a[16:19], v[188:191]
  s_add_u32 s87, s85, s42
  s_waitcnt lgkmcnt(9)
  v_mfma_f32_16x16x32_bf16 v[192:195], a[20:23], a[12:15], v[192:195]
  s_waitcnt vmcnt(8)
  v_lshlrev_b32 v128, 16, v104
  s_waitcnt lgkmcnt(8)
  v_mfma_f32_16x16x32_bf16 v[176:179], a[152:155], a[24:27], v[176:179]
  ds_read_b128 a[12:15], v19 offset:15360
  s_add_u32 s88, s85, s19
  buffer_load_dwordx4 v[160:163], v1, s[36:39], s19 offen sc1
  v_mfma_f32_16x16x32_bf16 v[180:183], a[224:227], a[24:27], v[180:183]
  ds_read_b128 a[16:19], v20 offset:15360
  s_waitcnt lgkmcnt(9)
  v_mfma_f32_16x16x32_bf16 v[184:187], a[152:155], a[28:31], v[184:187]
  ds_read_b128 a[20:23], v1 offset:52224
  v_mfma_f32_16x16x32_bf16 v[188:191], a[224:227], a[28:31], v[188:191]
  v_and_b32 v129, 0xffff0000, v104
  s_waitcnt lgkmcnt(9)
  v_mfma_f32_16x16x32_bf16 v[192:195], a[32:35], a[24:27], v[192:195]
  ds_read_b128 v[148:151], v23
  s_waitcnt lgkmcnt(9)
  v_mfma_f32_16x16x32_bf16 v[176:179], a[156:159], a[36:39], v[176:179]
  ds_read_b128 a[24:27], v19 offset:16384
  v_mfma_f32_16x16x32_bf16 v[180:183], a[228:231], a[36:39], v[180:183]
  ds_read_b128 a[28:31], v20 offset:16384
  s_waitcnt lgkmcnt(10)
  v_mfma_f32_16x16x32_bf16 v[184:187], a[156:159], a[40:43], v[184:187]
  ds_read_b128 a[32:35], v1 offset:53248
  v_mfma_f32_16x16x32_bf16 v[188:191], a[228:231], a[40:43], v[188:191]
  v_lshlrev_b32 v130, 16, v105
  s_waitcnt lgkmcnt(10)
  v_mfma_f32_16x16x32_bf16 v[192:195], a[44:47], a[36:39], v[192:195]
  v_and_b32 v131, 0xffff0000, v105
  s_waitcnt lgkmcnt(9)
  v_mfma_f32_16x16x32_bf16 v[176:179], a[160:163], a[0:3], v[176:179]
  ds_read_b128 a[36:39], v19 offset:17408
  v_mfma_f32_16x16x32_bf16 v[180:183], a[232:235], a[0:3], v[180:183]
  ds_read_b128 a[40:43], v20 offset:17408
  s_waitcnt lgkmcnt(10)
  v_mfma_f32_16x16x32_bf16 v[184:187], a[160:163], a[4:7], v[184:187]
  ds_read_b128 a[44:47], v1 offset:54272
  v_mfma_f32_16x16x32_bf16 v[188:191], a[232:235], a[4:7], v[188:191]
  v_lshlrev_b32 v132, 16, v106
  s_waitcnt lgkmcnt(10)
  v_mfma_f32_16x16x32_bf16 v[192:195], a[8:11], a[0:3], v[192:195]
  v_and_b32 v133, 0xffff0000, v106
  s_waitcnt lgkmcnt(9)
  v_mfma_f32_16x16x32_bf16 v[176:179], a[164:167], a[12:15], v[176:179]
  ds_read_b128 a[0:3], v19
  v_mfma_f32_16x16x32_bf16 v[180:183], a[236:239], a[12:15], v[180:183]
  ds_read_b128 a[4:7], v20
  s_waitcnt lgkmcnt(10)
  v_mfma_f32_16x16x32_bf16 v[184:187], a[164:167], a[16:19], v[184:187]
  ds_read_b128 a[8:11], v1 offset:36864
  v_mfma_f32_16x16x32_bf16 v[188:191], a[236:239], a[16:19], v[188:191]
  v_lshlrev_b32 v134, 16, v107
  s_waitcnt lgkmcnt(10)
  v_mfma_f32_16x16x32_bf16 v[192:195], a[20:23], a[12:15], v[192:195]
  v_and_b32 v135, 0xffff0000, v107
  s_waitcnt lgkmcnt(8)
  v_mfma_f32_16x16x32_bf16 v[176:179], a[168:171], a[24:27], v[176:179]
  ds_read_b128 a[12:15], v19 offset:1024
  s_waitcnt vmcnt(8)
  v_lshlrev_b32 v136, 16, v108
  v_mfma_f32_16x16x32_bf16 v[180:183], a[240:243], a[24:27], v[180:183]
  ds_read_b128 a[16:19], v20 offset:1024
  s_waitcnt lgkmcnt(9)
  v_mfma_f32_16x16x32_bf16 v[184:187], a[168:171], a[28:31], v[184:187]
  ds_read_b128 a[20:23], v1 offset:37888
  v_and_b32 v137, 0xffff0000, v108
  v_mfma_f32_16x16x32_bf16 v[188:191], a[240:243], a[28:31], v[188:191]
  s_waitcnt lgkmcnt(9)
  v_mfma_f32_16x16x32_bf16 v[192:195], a[32:35], a[24:27], v[192:195]
  v_lshlrev_b32 v138, 16, v109
  s_waitcnt lgkmcnt(8)
  v_mfma_f32_16x16x32_bf16 v[176:179], a[172:175], a[36:39], v[176:179]
  ds_read_b128 a[24:27], v19 offset:2048
  v_mfma_f32_16x16x32_bf16 v[180:183], a[244:247], a[36:39], v[180:183]
  ds_read_b128 a[28:31], v20 offset:2048
  v_and_b32 v139, 0xffff0000, v109
  s_waitcnt lgkmcnt(9)
  v_mfma_f32_16x16x32_bf16 v[184:187], a[172:175], a[40:43], v[184:187]
  ds_read_b128 a[32:35], v1 offset:38912
  v_mfma_f32_16x16x32_bf16 v[188:191], a[244:247], a[40:43], v[188:191]
  v_lshlrev_b32 v140, 16, v110
  s_waitcnt lgkmcnt(9)
  v_mfma_f32_16x16x32_bf16 v[192:195], a[44:47], a[36:39], v[192:195]
  s_waitcnt lgkmcnt(8)
  v_mfma_f32_16x16x32_bf16 v[176:179], a[104:107], a[0:3], v[176:179]
  ds_read_b128 a[36:39], v19 offset:3072
  v_and_b32 v141, 0xffff0000, v110
  v_mfma_f32_16x16x32_bf16 v[180:183], a[176:179], a[0:3], v[180:183]
  ds_read_b128 a[40:43], v20 offset:3072
  s_waitcnt lgkmcnt(9)
  v_mfma_f32_16x16x32_bf16 v[184:187], a[104:107], a[4:7], v[184:187]
  ds_read_b128 a[44:47], v1 offset:39936
  v_lshlrev_b32 v142, 16, v111
  v_mfma_f32_16x16x32_bf16 v[188:191], a[176:179], a[4:7], v[188:191]
  s_waitcnt lgkmcnt(9)
  v_mfma_f32_16x16x32_bf16 v[192:195], a[8:11], a[0:3], v[192:195]
  v_and_b32 v143, 0xffff0000, v111
  s_waitcnt lgkmcnt(8)
  v_mfma_f32_16x16x32_bf16 v[176:179], a[108:111], a[12:15], v[176:179]
  ds_read_b128 a[0:3], v19 offset:4096
  v_mfma_f32_16x16x32_bf16 v[180:183], a[180:183], a[12:15], v[180:183]
  ds_read_b128 a[4:7], v20 offset:4096
  s_waitcnt vmcnt(7)
  v_lshlrev_b32 v144, 16, v112
  s_waitcnt lgkmcnt(9)
  v_mfma_f32_16x16x32_bf16 v[184:187], a[108:111], a[16:19], v[184:187]
  ds_read_b128 a[8:11], v1 offset:40960
  v_mfma_f32_16x16x32_bf16 v[188:191], a[180:183], a[16:19], v[188:191]
  v_and_b32 v145, 0xffff0000, v112
  s_waitcnt lgkmcnt(9)
  v_mfma_f32_16x16x32_bf16 v[192:195], a[20:23], a[12:15], v[192:195]
  s_waitcnt lgkmcnt(8)
  v_mfma_f32_16x16x32_bf16 v[176:179], a[112:115], a[24:27], v[176:179]
  ds_read_b128 a[12:15], v19 offset:5120
  v_lshlrev_b32 v146, 16, v113
  v_mfma_f32_16x16x32_bf16 v[180:183], a[184:187], a[24:27], v[180:183]
  ds_read_b128 a[16:19], v20 offset:5120
  s_waitcnt lgkmcnt(9)
  v_mfma_f32_16x16x32_bf16 v[184:187], a[112:115], a[28:31], v[184:187]
  ds_read_b128 a[20:23], v1 offset:41984
  v_and_b32 v147, 0xffff0000, v113
  v_mfma_f32_16x16x32_bf16 v[188:191], a[184:187], a[28:31], v[188:191]
  s_waitcnt lgkmcnt(9)
  v_mfma_f32_16x16x32_bf16 v[192:195], a[32:35], a[24:27], v[192:195]
  s_waitcnt lgkmcnt(8)
  v_mfma_f32_16x16x32_bf16 v[176:179], a[116:119], a[36:39], v[176:179]
  ds_read_b128 a[24:27], v19 offset:6144
  v_mfma_f32_16x16x32_bf16 v[180:183], a[188:191], a[36:39], v[180:183]
  ds_read_b128 a[28:31], v20 offset:6144
  v_xor_b32 v148, v124, v148
  s_waitcnt lgkmcnt(9)
  v_mfma_f32_16x16x32_bf16 v[184:187], a[116:119], a[40:43], v[184:187]
  ds_read_b128 a[32:35], v1 offset:43008
  s_waitcnt vmcnt(2)
  v_xor_b32 v152, v164, v152
  v_mfma_f32_16x16x32_bf16 v[188:191], a[188:191], a[40:43], v[188:191]
  v_xor_b32 v149, v125, v149
  v_xor_b32 v153, v165, v153
  s_waitcnt lgkmcnt(9)
  v_mfma_f32_16x16x32_bf16 v[192:195], a[44:47], a[36:39], v[192:195]
  v_xor_b32 v150, v126, v150
  v_xor_b32 v154, v166, v154
  s_waitcnt lgkmcnt(8)
  v_mfma_f32_16x16x32_bf16 v[176:179], a[120:123], a[0:3], v[176:179]
  ds_read_b128 a[36:39], v19 offset:7168
  v_xor_b32 v151, v127, v151
  v_mfma_f32_16x16x32_bf16 v[180:183], a[192:195], a[0:3], v[180:183]
  ds_read_b128 a[40:43], v20 offset:7168
  v_xor_b32 v155, v167, v155
  s_waitcnt lgkmcnt(9)
  v_mfma_f32_16x16x32_bf16 v[184:187], a[120:123], a[4:7], v[184:187]
  ds_read_b128 a[44:47], v1 offset:44032
  v_mfma_f32_16x16x32_bf16 v[208:211], v[120:123], v[148:151], 0
  v_mfma_f32_16x16x32_bf16 v[188:191], a[192:195], a[4:7], v[188:191]
  v_mfma_f32_16x16x32_bf16 v[200:203], v[118:121], v[148:151], 0
  s_waitcnt vmcnt(1)
  v_xor_b32 v156, v124, v156
  s_waitcnt lgkmcnt(9)
  v_mfma_f32_16x16x32_bf16 v[192:195], a[8:11], a[0:3], v[192:195]
  v_mfma_f32_16x16x32_bf16 v[208:211], v[120:123], v[152:155], v[208:211]
  s_waitcnt vmcnt(0)
  v_xor_b32 v160, v164, v160
  s_waitcnt lgkmcnt(8)
  v_mfma_f32_16x16x32_bf16 v[176:179], a[124:127], a[12:15], v[176:179]
  ds_read_b128 a[0:3], v19 offset:8192
  v_mfma_f32_16x16x32_bf16 v[200:203], v[118:121], v[152:155], v[200:203]
  v_mfma_f32_16x16x32_bf16 v[180:183], a[196:199], a[12:15], v[180:183]
  ds_read_b128 a[4:7], v20 offset:8192
  buffer_load_dwordx4 v[224:227], v1, s[36:39], s41 offen offset:1024 sc1
  v_bitop3_b32 v168, v148, v152, v148 bitop3:0xfb
  v_bitop3_b32 v168, v149, v153, v168 bitop3:0xfb
  v_xor_b32 v157, v125, v157
  s_waitcnt lgkmcnt(9)
  v_mfma_f32_16x16x32_bf16 v[184:187], a[124:127], a[16:19], v[184:187]
  ds_read_b128 a[8:11], v1 offset:45056
  v_bitop3_b32 v168, v150, v154, v168 bitop3:0xfb
  v_bitop3_b32 v168, v151, v155, v168 bitop3:0xfb
  v_xor_b32 v161, v165, v161
  v_xor_b32 v158, v126, v158
  v_mfma_f32_16x16x32_bf16 v[188:191], a[196:199], a[16:19], v[188:191]
  v_xor_b32 v162, v166, v162
  v_xor_b32 v159, v127, v159
  v_xor_b32 v163, v167, v163
  s_waitcnt lgkmcnt(9)
  v_mfma_f32_16x16x32_bf16 v[192:195], a[20:23], a[12:15], v[192:195]
  v_mfma_f32_16x16x32_bf16 v[208:211], v[120:123], v[156:159], v[208:211]
  s_waitcnt lgkmcnt(8)
  v_mfma_f32_16x16x32_bf16 v[176:179], a[128:131], a[24:27], v[176:179]
  ds_read_b128 a[12:15], v19 offset:9216
  buffer_load_dwordx4 v[228:231], v1, s[36:39], s42 offen offset:1024 sc1
  v_mfma_f32_16x16x32_bf16 v[200:203], v[118:121], v[156:159], v[200:203]
  v_mfma_f32_16x16x32_bf16 v[180:183], a[200:203], a[24:27], v[180:183]
  ds_read_b128 a[16:19], v20 offset:9216
  v_mfma_f32_16x16x32_bf16 v[208:211], v[120:123], v[160:163], v[208:211]
  s_waitcnt lgkmcnt(9)
  v_mfma_f32_16x16x32_bf16 v[184:187], a[128:131], a[28:31], v[184:187]
  ds_read_b128 a[20:23], v1 offset:46080
  v_mfma_f32_16x16x32_bf16 v[200:203], v[118:121], v[160:163], v[200:203]
  v_mfma_f32_16x16x32_bf16 v[188:191], a[200:203], a[28:31], v[188:191]
  v_bitop3_b32 v168, v156, v160, v168 bitop3:0xfb
  v_bitop3_b32 v168, v157, v161, v168 bitop3:0xfb
  v_bitop3_b32 v168, v158, v162, v168 bitop3:0xfb
  s_waitcnt lgkmcnt(9)
  v_mfma_f32_16x16x32_bf16 v[192:195], a[32:35], a[24:27], v[192:195]
  buffer_load_dwordx4 v[232:235], v1, s[36:39], s19 offen offset:1024 sc1
  v_bitop3_b32 v168, v159, v163, v168 bitop3:0xfb
  s_waitcnt lgkmcnt(8)
  v_mfma_f32_16x16x32_bf16 v[176:179], a[132:135], a[36:39], v[176:179]
  v_mfma_f32_16x16x32_bf16 v[180:183], a[204:207], a[36:39], v[180:183]
  s_waitcnt lgkmcnt(7)
  v_mfma_f32_16x16x32_bf16 v[184:187], a[132:135], a[40:43], v[184:187]
  v_mul_f32 v88, v117, v208
  v_mul_f32 v89, v117, v209
  v_mul_f32 v90, v117, v210
  v_mul_f32 v91, v117, v211
  v_mul_f32 v80, v116, v200
  v_mfma_f32_16x16x32_bf16 v[188:191], a[204:207], a[40:43], v[188:191]
  ds_read_b128 v[220:223], v23 offset:4096
  v_mul_f32 v81, v116, v201
  v_mul_f32 v82, v116, v202
  v_mul_f32 v83, v116, v203
  v_exp_f32 v88, v88
  s_waitcnt lgkmcnt(7)
  v_mfma_f32_16x16x32_bf16 v[192:195], a[44:47], a[36:39], v[192:195]
  v_exp_f32 v89, v89
  v_exp_f32 v90, v90
  v_exp_f32 v91, v91
  s_waitcnt lgkmcnt(6)
  v_mfma_f32_16x16x32_bf16 v[176:179], a[136:139], a[0:3], v[176:179]
  buffer_load_dwordx4 v[240:243], v1, s[36:39], s86 offen sc1
  v_exp_f32 v80, v80
  v_exp_f32 v81, v81
  v_mfma_f32_16x16x32_bf16 v[180:183], a[208:211], a[0:3], v[180:183]
  v_exp_f32 v82, v82
  v_exp_f32 v83, v83
  v_fma_f32 v88, v88, v170, v170
  s_waitcnt lgkmcnt(5)
  v_mfma_f32_16x16x32_bf16 v[184:187], a[136:139], a[4:7], v[184:187]
  v_fma_f32 v89, v89, v170, v170
  v_fma_f32 v90, v90, v170, v170
  v_fma_f32 v91, v91, v170, v170
  v_fma_f32 v80, v80, v169, v169
  v_fma_f32 v81, v81, v169, v169
  v_mfma_f32_16x16x32_bf16 v[188:191], a[208:211], a[4:7], v[188:191]
  v_fma_f32 v82, v82, v169, v169
  v_fma_f32 v83, v83, v169, v169
  v_rcp_f32 v88, v88
  v_rcp_f32 v89, v89
  s_waitcnt lgkmcnt(4)
  v_mfma_f32_16x16x32_bf16 v[192:195], a[8:11], a[0:3], v[192:195]
  buffer_load_dwordx4 v[244:247], v1, s[36:39], s87 offen sc1
  v_rcp_f32 v90, v90
  v_rcp_f32 v91, v91
  s_waitcnt lgkmcnt(3)
  v_mfma_f32_16x16x32_bf16 v[176:179], a[140:143], a[12:15], v[176:179]
  v_rcp_f32 v80, v80
  v_rcp_f32 v81, v81
  v_rcp_f32 v82, v82
  v_mfma_f32_16x16x32_bf16 v[180:183], a[212:215], a[12:15], v[180:183]
  v_rcp_f32 v83, v83
  v_mul_f32 v208, v208, v88
  v_mul_f32 v209, v209, v89
  v_mul_f32 v210, v210, v90
  s_waitcnt lgkmcnt(2)
  v_mfma_f32_16x16x32_bf16 v[184:187], a[140:143], a[16:19], v[184:187]
  v_mul_f32 v211, v211, v91
  v_mul_f32 v200, v200, v80
  v_mul_f32 v201, v201, v81
  v_mul_f32 v202, v202, v82
  v_mul_f32 v203, v203, v83
  v_mfma_f32_16x16x32_bf16 v[188:191], a[212:215], a[16:19], v[188:191]
  buffer_load_dwordx4 v[248:251], v1, s[36:39], s88 offen sc1
  s_waitcnt lgkmcnt(1)
  v_mfma_f32_16x16x32_bf16 v[192:195], a[20:23], a[12:15], v[192:195]
  ds_read_b128 v[236:239], v1 offset:57344
  s_waitcnt lgkmcnt(1)
  v_xor_b32 v220, v124, v220
  s_waitcnt vmcnt(5)
  v_xor_b32 v224, v164, v224
  v_xor_b32 v221, v125, v221
  v_xor_b32 v225, v165, v225
  v_xor_b32 v222, v126, v222
  v_xor_b32 v226, v166, v226
  v_xor_b32 v223, v127, v223
  v_xor_b32 v227, v167, v227
  s_nop 0
  v_mfma_f32_16x16x32_bf16 v[212:215], v[120:123], v[220:223], 0
  v_bitop3_b32 v168, v220, v224, v168 bitop3:0xfb
  v_bitop3_b32 v168, v221, v225, v168 bitop3:0xfb
  v_mfma_f32_16x16x32_bf16 v[204:207], v[118:121], v[220:223], 0
  v_bitop3_b32 v168, v222, v226, v168 bitop3:0xfb
  v_bitop3_b32 v168, v223, v227, v168 bitop3:0xfb
  v_mfma_f32_16x16x32_bf16 v[212:215], v[120:123], v[224:227], v[212:215]
  s_waitcnt vmcnt(4)
  v_xor_b32 v228, v124, v228
  s_waitcnt vmcnt(3)
  v_xor_b32 v232, v164, v232
  v_xor_b32 v229, v125, v229
  v_xor_b32 v233, v165, v233
  v_mfma_f32_16x16x32_bf16 v[204:207], v[118:121], v[224:227], v[204:207]
  v_xor_b32 v230, v126, v230
  v_xor_b32 v234, v166, v234
  v_xor_b32 v231, v127, v231
  v_xor_b32 v235, v167, v235
  s_nop 0
  v_mfma_f32_16x16x32_bf16 v[212:215], v[120:123], v[228:231], v[212:215]
  v_bitop3_b32 v168, v228, v232, v168 bitop3:0xfb
  v_bitop3_b32 v168, v229, v233, v168 bitop3:0xfb
  v_mfma_f32_16x16x32_bf16 v[204:207], v[118:121], v[228:231], v[204:207]
  v_bitop3_b32 v168, v230, v234, v168 bitop3:0xfb
  v_bitop3_b32 v168, v231, v235, v168 bitop3:0xfb
  v_mfma_f32_16x16x32_bf16 v[212:215], v[120:123], v[232:235], v[212:215]
  v_and_b32 v168, s11, v168
  v_cmp_ne_u32 vcc, 0, v168
  v_mfma_f32_16x16x32_bf16 v[204:207], v[118:121], v[232:235], v[204:207]
  s_cbranch_vccz L_ok8
  s_mov_b32 s83, 0x8000
  s_mov_b32 s15, 0
  v_bitop3_b32 v168, v152, v153, v154 bitop3:0x80
  v_bitop3_b32 v168, v168, v155, s11 bitop3:0x2a
  v_cmp_ne_u32 vcc, 0, v168
  s_cbranch_vccz L_e8_0
  buffer_load_dwordx4 v[152:155], v1, s[36:39], s41 offen sc1
  s_bitset1_b32 s15, 0
L_e8_0:
  v_bitop3_b32 v168, v156, v157, v158 bitop3:0xfe
  v_bitop3_b32 v168, v168, v159, s11 bitop3:0xa8
  v_cmp_ne_u32 vcc, 0, v168
  s_cbranch_vccz L_e8_1
  buffer_load_dwordx4 v[156:159], v1, s[36:39], s42 offen sc1
  s_bitset1_b32 s15, 1
L_e8_1:
  v_bitop3_b32 v168, v160, v161, v162 bitop3:0x80
  v_bitop3_b32 v168, v168, v163, s11 bitop3:0x2a
  v_cmp_ne_u32 vcc, 0, v168
  s_cbranch_vccz L_e8_2
  buffer_load_dwordx4 v[160:163], v1, s[36:39], s19 offen sc1
  s_bitset1_b32 s15, 2
L_e8_2:
  v_bitop3_b32 v168, v224, v225, v226 bitop3:0x80
  v_bitop3_b32 v168, v168, v227, s11 bitop3:0x2a
  v_cmp_ne_u32 vcc, 0, v168
  s_cbranch_vccz L_e8_3
  buffer_load_dwordx4 v[224:227], v1, s[36:39], s41 offen offset:1024 sc1
  s_bitset1_b32 s15, 3
L_e8_3:
  v_bitop3_b32 v168, v228, v229, v230 bitop3:0xfe
  v_bitop3_b32 v168, v168, v231, s11 bitop3:0xa8
  v_cmp_ne_u32 vcc, 0, v168
  s_cbranch_vccz L_e8_4
  buffer_load_dwordx4 v[228:231], v1, s[36:39], s42 offen offset:1024 sc1
  s_bitset1_b32 s15, 4
L_e8_4:
  v_bitop3_b32 v168, v232, v233, v234 bitop3:0x80
  v_bitop3_b32 v168, v168, v235, s11 bitop3:0x2a
  v_cmp_ne_u32 vcc, 0, v168
  s_cbranch_vccz L_e8_5
  buffer_load_dwordx4 v[232:235], v1, s[36:39], s19 offen offset:1024 sc1
  s_bitset1_b32 s15, 5
L_e8_5:
  s_mov_b32 s16, s15
L_spin8:
  s_waitcnt vmcnt(0)
  s_bitcmp1_b32 s15, 0
  s_cbranch_scc0 L_s8_0
  v_xor_b32 v152, v164, v152
  v_xor_b32 v153, v165, v153
  v_xor_b32 v154, v166, v154
  v_xor_b32 v155, v167, v155
  v_bitop3_b32 v168, v152, v153, v154 bitop3:0x80
  v_bitop3_b32 v168, v168, v155, s11 bitop3:0x2a
  v_cmp_ne_u32 vcc, 0, v168
  s_bitset0_b32 s15, 0
  s_cbranch_vccz L_s8_0
  buffer_load_dwordx4 v[152:155], v1, s[36:39], s41 offen sc1
  s_bitset1_b32 s15, 0
L_s8_0:
  s_bitcmp1_b32 s15, 1
  s_cbranch_scc0 L_s8_1
  v_xor_b32 v156, v124, v156
  v_xor_b32 v157, v125, v157
  v_xor_b32 v158, v126, v158
  v_xor_b32 v159, v127, v159
  v_bitop3_b32 v168, v156, v157, v158 bitop3:0xfe
  v_bitop3_b32 v168, v168, v159, s11 bitop3:0xa8
  v_cmp_ne_u32 vcc, 0, v168
  s_bitset0_b32 s15, 1
  s_cbranch_vccz L_s8_1
  buffer_load_dwordx4 v[156:159], v1, s[36:39], s42 offen sc1
  s_bitset1_b32 s15, 1
L_s8_1:
  s_bitcmp1_b32 s15, 2
  s_cbranch_scc0 L_s8_2
  v_xor_b32 v160, v164, v160
  v_xor_b32 v161, v165, v161
  v_xor_b32 v162, v166, v162
  v_xor_b32 v163, v167, v163
  v_bitop3_b32 v168, v160, v161, v162 bitop3:0x80
  v_bitop3_b32 v168, v168, v163, s11 bitop3:0x2a
  v_cmp_ne_u32 vcc, 0, v168
  s_bitset0_b32 s15, 2
  s_cbranch_vccz L_s8_2
  buffer_load_dwordx4 v[160:163], v1, s[36:39], s19 offen sc1
  s_bitset1_b32 s15, 2
L_s8_2:
  s_bitcmp1_b32 s15, 3
  s_cbranch_scc0 L_s8_3
  v_xor_b32 v224, v164, v224
  v_xor_b32 v225, v165, v225
  v_xor_b32 v226, v166, v226
  v_xor_b32 v227, v167, v227
  v_bitop3_b32 v168, v224, v225, v226 bitop3:0x80
  v_bitop3_b32 v168, v168, v227, s11 bitop3:0x2a
  v_cmp_ne_u32 vcc, 0, v168
  s_bitset0_b32 s15, 3
  s_cbranch_vccz L_s8_3
  buffer_load_dwordx4 v[224:227], v1, s[36:39], s41 offen offset:1024 sc1
  s_bitset1_b32 s15, 3
L_s8_3:
  s_bitcmp1_b32 s15, 4
  s_cbranch_scc0 L_s8_4
  v_xor_b32 v228, v124, v228
  v_xor_b32 v229, v125, v229
  v_xor_b32 v230, v126, v230
  v_xor_b32 v231, v127, v231
  v_bitop3_b32 v168, v228, v229, v230 bitop3:0xfe
  v_bitop3_b32 v168, v168, v231, s11 bitop3:0xa8
  v_cmp_ne_u32 vcc, 0, v168
  s_bitset0_b32 s15, 4
  s_cbranch_vccz L_s8_4
  buffer_load_dwordx4 v[228:231], v1, s[36:39], s42 offen offset:1024 sc1
  s_bitset1_b32 s15, 4
L_s8_4:
  s_bitcmp1_b32 s15, 5
  s_cbranch_scc0 L_s8_5
  v_xor_b32 v232, v164, v232
  v_xor_b32 v233, v165, v233
  v_xor_b32 v234, v166, v234
  v_xor_b32 v235, v167, v235
  v_bitop3_b32 v168, v232, v233, v234 bitop3:0x80
  v_bitop3_b32 v168, v168, v235, s11 bitop3:0x2a
  v_cmp_ne_u32 vcc, 0, v168
  s_bitset0_b32 s15, 5
  s_cbranch_vccz L_s8_5
  buffer_load_dwordx4 v[232:235], v1, s[36:39], s19 offen offset:1024 sc1
  s_bitset1_b32 s15, 5
L_s8_5:
  s_cmp_eq_u32 s15, 0
  s_cbranch_scc1 L_got8
  s_sub_u32 s83, s83, 1
  s_cbranch_scc0 L_spin8
  buffer_store_dword v1, off, s[32:35], 0 offset:36 sc1
  s_waitcnt vmcnt(0)
L_got8:
  s_bitcmp1_b32 s16, 3
  s_cbranch_scc0 L_a8_3
  buffer_load_dwordx4 v[240:243], v1, s[36:39], s86 offen sc1
L_a8_3:
  s_bitcmp1_b32 s16, 4
  s_cbranch_scc0 L_a8_4
  buffer_load_dwordx4 v[244:247], v1, s[36:39], s87 offen sc1
L_a8_4:
  s_bitcmp1_b32 s16, 5
  s_cbranch_scc0 L_a8_5
  buffer_load_dwordx4 v[248:251], v1, s[36:39], s88 offen sc1
L_a8_5:
  s_and_b32 s17, s16, 7
  s_cbranch_scc0 L_x8
  v_mfma_f32_16x16x32_bf16 v[208:211], v[120:123], v[148:151], 0
  v_mfma_f32_16x16x32_bf16 v[200:203], v[118:121], v[148:151], 0
  v_mfma_f32_16x16x32_bf16 v[208:211], v[120:123], v[152:155], v[208:211]
  v_mfma_f32_16x16x32_bf16 v[200:203], v[118:121], v[152:155], v[200:203]
  v_mfma_f32_16x16x32_bf16 v[208:211], v[120:123], v[156:159], v[208:211]
  v_mfma_f32_16x16x32_bf16 v[200:203], v[118:121], v[156:159], v[200:203]
  v_mfma_f32_16x16x32_bf16 v[208:211], v[120:123], v[160:163], v[208:211]
  v_mfma_f32_16x16x32_bf16 v[200:203], v[118:121], v[160:163], v[200:203]
  s_nop 6
  v_mul_f32 v88, v117, v208
  v_mul_f32 v89, v117, v209
  v_mul_f32 v90, v117, v210
  v_mul_f32 v91, v117, v211
  v_mul_f32 v80, v116, v200
  v_mul_f32 v81, v116, v201
  v_mul_f32 v82, v116, v202
  v_mul_f32 v83, v116, v203
  v_exp_f32 v88, v88
  v_exp_f32 v89, v89
  v_exp_f32 v90, v90
  v_exp_f32 v91, v91
  v_exp_f32 v80, v80
  v_exp_f32 v81, v81
  v_exp_f32 v82, v82
  v_exp_f32 v83, v83
  v_fma_f32 v88, v88, v170, v170
  v_fma_f32 v89, v89, v170, v170
  v_fma_f32 v90, v90, v170, v170
  v_fma_f32 v91, v91, v170, v170
  v_fma_f32 v80, v80, v169, v169
  v_fma_f32 v81, v81, v169, v169
  v_fma_f32 v82, v82, v169, v169
  v_fma_f32 v83, v83, v169, v169
  v_rcp_f32 v88, v88
  v_rcp_f32 v89, v89
  v_rcp_f32 v90, v90
  v_rcp_f32 v91, v91
  v_rcp_f32 v80, v80
  v_rcp_f32 v81, v81
  v_rcp_f32 v82, v82
  v_rcp_f32 v83, v83
  v_mul_f32 v208, v208, v88
  v_mul_f32 v209, v209, v89
  v_mul_f32 v210, v210, v90
  v_mul_f32 v211, v211, v91
  v_mul_f32 v200, v200, v80
  v_mul_f32 v201, v201, v81
  v_mul_f32 v202, v202, v82
  v_mul_f32 v203, v203, v83
L_x8:
  v_mfma_f32_16x16x32_bf16 v[212:215], v[120:123], v[220:223], 0
  v_mfma_f32_16x16x32_bf16 v[204:207], v[118:121], v[220:223], 0
  v_mfma_f32_16x16x32_bf16 v[212:215], v[120:123], v[224:227], v[212:215]
  v_mfma_f32_16x16x32_bf16 v[204:207], v[118:121], v[224:227], v[204:207]
  v_mfma_f32_16x16x32_bf16 v[212:215], v[120:123], v[228:231], v[212:215]
  v_mfma_f32_16x16x32_bf16 v[204:207], v[118:121], v[228:231], v[204:207]
  v_mfma_f32_16x16x32_bf16 v[212:215], v[120:123], v[232:235], v[212:215]
  v_mfma_f32_16x16x32_bf16 v[204:207], v[118:121], v[232:235], v[204:207]
L_ok8:
  s_nop 6
  v_mul_f32 v92, v117, v212
  v_mul_f32 v93, v117, v213
  v_mul_f32 v94, v117, v214
  v_mul_f32 v95, v117, v215
  v_mul_f32 v84, v116, v204
  v_mul_f32 v85, v116, v205
  v_mul_f32 v86, v116, v206
  v_mul_f32 v87, v116, v207
  v_exp_f32 v92, v92
  v_exp_f32 v93, v93
  v_exp_f32 v94, v94
  v_exp_f32 v95, v95
  v_exp_f32 v84, v84
  v_exp_f32 v85, v85
  v_exp_f32 v86, v86
  v_exp_f32 v87, v87
  v_fma_f32 v92, v92, v170, v170
  v_fma_f32 v93, v93, v170, v170
  v_fma_f32 v94, v94, v170, v170
  v_fma_f32 v95, v95, v170, v170
  v_fma_f32 v84, v84, v169, v169
  v_fma_f32 v85, v85, v169, v169
  v_fma_f32 v86, v86, v169, v169
  v_fma_f32 v87, v87, v169, v169
  v_rcp_f32 v92, v92
  v_rcp_f32 v93, v93
  v_rcp_f32 v94, v94
  v_rcp_f32 v95, v95
  v_rcp_f32 v84, v84
  v_rcp_f32 v85, v85
  v_rcp_f32 v86, v86
  v_rcp_f32 v87, v87
  v_mul_f32 v212, v212, v92
  v_mul_f32 v213, v213, v93
  v_mul_f32 v214, v214, v94
  v_mul_f32 v215, v215, v95
  v_mul_f32 v204, v204, v84
  v_mul_f32 v205, v205, v85
  v_mul_f32 v206, v206, v86
  v_mul_f32 v207, v207, v87
  v_fma_f32 v208, v208, v184, v136
  v_fma_f32 v209, v209, v185, v137
  v_fma_f32 v210, v210, v186, v138
  v_fma_f32 v211, v211, v187, v139
  v_fma_f32 v212, v212, v188, v140
  v_fma_f32 v213, v213, v189, v141
  v_fma_f32 v214, v214, v190, v142
  v_fma_f32 v215, v215, v191, v143
  v_cvt_pk_bf16_f32 v108, v208, v209
  v_cvt_pk_bf16_f32 v109, v210, v211
  v_cvt_pk_bf16_f32 v110, v212, v213
  v_cvt_pk_bf16_f32 v111, v214, v215
  buffer_store_dwordx4 v[108:111], v21, s[28:31], s89 offen
  v_fma_f32 v200, v200, v176, v128
  v_fma_f32 v201, v201, v177, v129
  v_fma_f32 v202, v202, v178, v130
  v_fma_f32 v203, v203, v179, v131
  v_fma_f32 v204, v204, v180, v132
  v_fma_f32 v205, v205, v181, v133
  v_fma_f32 v206, v206, v182, v134
  v_fma_f32 v207, v207, v183, v135
  v_cvt_pk_bf16_f32 v104, v200, v201
  v_cvt_pk_bf16_f32 v105, v202, v203
  v_cvt_pk_bf16_f32 v106, v204, v205
  v_cvt_pk_bf16_f32 v107, v206, v207
  buffer_store_dwordx4 v[104:107], v21, s[28:31], s96 offen
L_pg10:
  s_cbranch_execz L_pgret
  s_waitcnt vmcnt(2) lgkmcnt(0)
  v_xor_b32 v236, v124, v236
  v_xor_b32 v240, v164, v240
  v_xor_b32 v237, v125, v237
  v_xor_b32 v241, v165, v241
  v_xor_b32 v238, v126, v238
  v_xor_b32 v242, v166, v242
  v_xor_b32 v239, v127, v239
  v_xor_b32 v243, v167, v243
  s_nop 0
  v_mfma_f32_16x16x32_bf16 v[216:219], v[118:121], v[236:239], 0
  v_xor_b32 v244, v124, v244
  v_xor_b32 v248, v164, v248
  v_xor_b32 v245, v125, v245
  v_xor_b32 v249, v165, v249
  v_mfma_f32_16x16x32_bf16 v[216:219], v[118:121], v[240:243], v[216:219]
  v_xor_b32 v246, v126, v246
  v_xor_b32 v250, v166, v250
  v_xor_b32 v247, v127, v247
  v_xor_b32 v251, v167, v251
  v_bitop3_b32 v168, v236, v240, v236 bitop3:0xfb
  v_bitop3_b32 v168, v237, v241, v168 bitop3:0xfb
  v_mfma_f32_16x16x32_bf16 v[216:219], v[118:121], v[244:247], v[216:219]
  v_bitop3_b32 v168, v238, v242, v168 bitop3:0xfb
  v_bitop3_b32 v168, v239, v243, v168 bitop3:0xfb
  v_bitop3_b32 v168, v244, v248, v168 bitop3:0xfb
  v_bitop3_b32 v168, v245, v249, v168 bitop3:0xfb
  v_mfma_f32_16x16x32_bf16 v[216:219], v[118:121], v[248:251], v[216:219]
  v_bitop3_b32 v168, v246, v250, v168 bitop3:0xfb
  v_bitop3_b32 v168, v247, v251, v168 bitop3:0xfb
  v_and_b32 v168, s12, v168
  v_cmp_ne_u32 vcc, 0, v168
  s_cbranch_vccz L_ok9
  s_mov_b32 s83, 0x8000
  s_mov_b32 s15, 0
  v_bitop3_b32 v168, v240, v241, v242 bitop3:0x80
  v_bitop3_b32 v168, v168, v243, s12 bitop3:0x2a
  v_cmp_ne_u32 vcc, 0, v168
  s_cbranch_vccz L_e9_0
  buffer_load_dwordx4 v[240:243], v1, s[36:39], s86 offen sc1
  s_bitset1_b32 s15, 0
L_e9_0:
  v_bitop3_b32 v168, v244, v245, v246 bitop3:0xfe
  v_bitop3_b32 v168, v168, v247, s12 bitop3:0xa8
  v_cmp_ne_u32 vcc, 0, v168
  s_cbranch_vccz L_e9_1
  buffer_load_dwordx4 v[244:247], v1, s[36:39], s87 offen sc1
  s_bitset1_b32 s15, 1
L_e9_1:
  v_bitop3_b32 v168, v248, v249, v250 bitop3:0x80
  v_bitop3_b32 v168, v168, v251, s12 bitop3:0x2a
  v_cmp_ne_u32 vcc, 0, v168
  s_cbranch_vccz L_e9_2
  buffer_load_dwordx4 v[248:251], v1, s[36:39], s88 offen sc1
  s_bitset1_b32 s15, 2
L_e9_2:
  s_mov_b32 s16, s15
L_spin9:
  s_waitcnt vmcnt(0)
  s_bitcmp1_b32 s15, 0
  s_cbranch_scc0 L_s9_0
  v_xor_b32 v240, v164, v240
  v_xor_b32 v241, v165, v241
  v_xor_b32 v242, v166, v242
  v_xor_b32 v243, v167, v243
  v_bitop3_b32 v168, v240, v241, v242 bitop3:0x80
  v_bitop3_b32 v168, v168, v243, s12 bitop3:0x2a
  v_cmp_ne_u32 vcc, 0, v168
  s_bitset0_b32 s15, 0
  s_cbranch_vccz L_s9_0
  buffer_load_dwordx4 v[240:243], v1, s[36:39], s86 offen sc1
  s_bitset1_b32 s15, 0
L_s9_0:
  s_bitcmp1_b32 s15, 1
  s_cbranch_scc0 L_s9_1
  v_xor_b32 v244, v124, v244
  v_xor_b32 v245, v125, v245
  v_xor_b32 v246, v126, v246
  v_xor_b32 v247, v127, v247
  v_bitop3_b32 v168, v244, v245, v246 bitop3:0xfe
  v_bitop3_b32 v168, v168, v247, s12 bitop3:0xa8
  v_cmp_ne_u32 vcc, 0, v168
  s_bitset0_b32 s15, 1
  s_cbranch_vccz L_s9_1
  buffer_load_dwordx4 v[244:247], v1, s[36:39], s87 offen sc1
  s_bitset1_b32 s15, 1
L_s9_1:
  s_bitcmp1_b32 s15, 2
  s_cbranch_scc0 L_s9_2
  v_xor_b32 v248, v164, v248
  v_xor_b32 v249, v165, v249
  v_xor_b32 v250, v166, v250
  v_xor_b32 v251, v167, v251
  v_bitop3_b32 v168, v248, v249, v250 bitop3:0x80
  v_bitop3_b32 v168, v168, v251, s12 bitop3:0x2a
  v_cmp_ne_u32 vcc, 0, v168
  s_bitset0_b32 s15, 2
  s_cbranch_vccz L_s9_2
  buffer_load_dwordx4 v[248:251], v1, s[36:39], s88 offen sc1
  s_bitset1_b32 s15, 2
L_s9_2:
  s_cmp_eq_u32 s15, 0
  s_cbranch_scc1 L_got9
  s_sub_u32 s83, s83, 1
  s_cbranch_scc0 L_spin9
  buffer_store_dword v1, off, s[32:35], 0 offset:48 sc1
  s_waitcnt vmcnt(0)
L_got9:
  v_mfma_f32_16x16x32_bf16 v[216:219], v[118:121], v[236:239], 0
  v_mfma_f32_16x16x32_bf16 v[216:219], v[118:121], v[240:243], v[216:219]
  v_mfma_f32_16x16x32_bf16 v[216:219], v[118:121], v[244:247], v[216:219]
  v_mfma_f32_16x16x32_bf16 v[216:219], v[118:121], v[248:251], v[216:219]
L_ok9:
  s_nop 7
  v_mul_f32 v96, v116, v216
  v_mul_f32 v97, v116, v217
  v_mul_f32 v98, v116, v218
  v_mul_f32 v99, v116, v219
  v_exp_f32 v96, v96
  v_exp_f32 v97, v97
  v_exp_f32 v98, v98
  v_exp_f32 v99, v99
  v_fma_f32 v96, v96, v169, v169
  v_fma_f32 v97, v97, v169, v169
  v_fma_f32 v98, v98, v169, v169
  v_fma_f32 v99, v99, v169, v169
  v_rcp_f32 v96, v96
  v_rcp_f32 v97, v97
  v_rcp_f32 v98, v98
  v_rcp_f32 v99, v99
  v_mul_f32 v216, v216, v96
  v_mul_f32 v217, v217, v97
  v_mul_f32 v218, v218, v98
  v_mul_f32 v219, v219, v99
  v_fma_f32 v216, v216, v192, v144
  v_fma_f32 v217, v217, v193, v145
  v_fma_f32 v218, v218, v194, v146
  v_fma_f32 v219, v219, v195, v147
  v_cvt_pk_bf16_f32 v112, v216, v217
  v_cvt_pk_bf16_f32 v113, v218, v219
  buffer_store_dwordx2 v[112:113], v22, s[28:31], s97 offen
L_end:
s_endpgm
.section .rodata,"a"
.p2align 6
.amdhsa_kernel recurrent_scan__linear_kernel_hedgehog__dense_activation_relu__prompt_kernel
  .amdhsa_next_free_vgpr 512
  .amdhsa_next_free_sgpr 102
  .amdhsa_accum_offset 256
  .amdhsa_group_segment_fixed_size 0
  .amdhsa_kernarg_size 80
  .amdhsa_user_sgpr_count 2
  .amdhsa_user_sgpr_kernarg_segment_ptr 1
  .amdhsa_system_sgpr_workgroup_id_x 1
.end_amdhsa_kernel
```
